```python
import torch

def _softmax(x, axis=-1):
    return torch.softmax(x, dim=axis)
def _gelu(x):
    return torch.nn.functional.gelu(x, approximate="tanh")
def _silu(x):
    return torch.nn.functional.silu(x)
def _sigmoid(x):
    return torch.sigmoid(x)
def _layernorm(x, axis=-1, eps=1e-5):
    m = x.mean(dim=axis, keepdim=True)
    v = x.var(dim=axis, keepdim=True, unbiased=False)
    return (x - m) / torch.sqrt(v + eps)
def _scatter_add(tgt, idx, src, axis=0):
    return tgt.clone().index_add_(axis, idx, src)
def _segment_sum(src, seg, n):
    out = torch.zeros((n,) + src.shape[1:], dtype=src.dtype)
    return out.index_add_(0, seg, src)
def _pad(x, pw):
    flat = tuple(v for pair in reversed(pw) for v in pair)
    return torch.nn.functional.pad(x, flat)

kernel_name = 'standalone__mha_block_cached__near_ridge'

def setup_inputs():

    _w = (lambda a: (lambda t: t.to(torch.bfloat16) if t.is_floating_point() else t)(torch.as_tensor(a)))
    B, Sq, D = 16, 112, 448
    H, Sk, Dh = 16, 512, 256
    return {
        "x": _w((lambda *s: torch.randn(*s, dtype=torch.bfloat16) * 0.8)(B, Sq, D)),
        "k_cache": _w((lambda *s: torch.randn(*s, dtype=torch.bfloat16) * 0.8)(B, H, Sk, Dh)),
        "v_cache": _w((lambda *s: torch.randn(*s, dtype=torch.bfloat16) * 0.05)(B, H, Sk, Dh)),
        "wq": _w((lambda *s: torch.randn(*s, dtype=torch.bfloat16) * 0.8)(D, H * Dh) * (D ** -0.5)),
        "wo": _w((lambda *s: torch.randn(*s, dtype=torch.bfloat16) * 0.05)(H * Dh, D) * ((H * Dh) ** -0.5)),
    }

def reference(x, k_cache, v_cache, wq, wo):
    B, Sq, D = x.shape
    H, Dh = 16, 256
    q = (lambda x, *d: x.permute(*d))((x @ wq).reshape(B, Sq, H, Dh), 0, 2, 1, 3)
    scores = torch.einsum("bhqd,bhkd->bhqk", q, k_cache) * (Dh ** -0.5)
    p = _softmax(scores, axis=-1)
    o = torch.einsum("bhqk,bhkd->bhqd", p, v_cache)
    return (lambda x, *d: x.permute(*d))(o, 0, 2, 1, 3).reshape(B, Sq, H * Dh) @ wo
```

```asm
; @launch grid=(256,1,1) block=(256,1,1) lds=163840
.amdgcn_target "amdgcn-amd-amdhsa--gfx950"
.text
.globl standalone__mha_block_cached__near_ridge_kernel
.p2align 8
.type standalone__mha_block_cached__near_ridge_kernel,@function
standalone__mha_block_cached__near_ridge_kernel:
s_cmp_ge_u32 s2, 256
s_cbranch_scc1 L_end
s_load_dwordx16 s[64:79], s[0:1], 0
s_getpc_b64 s[56:57]
L_pc:
s_lshr_b32 s7, s2, 3
s_lshl_b32 s7, s7, 7
v_lshlrev_b32 v1, 12, v0
v_add_u32 v1, s7, v1
v_mov_b32 v3, s57
v_add_co_u32 v2, vcc, s56, v1
s_nop 1
v_addc_co_u32 v3, vcc, 0, v3, vcc
v_cmp_gt_u32 vcc, L_code_end-L_pc-4, v1
s_and_saveexec_b64 s[50:51], vcc
s_cbranch_execz L_notouch
global_load_dword v254, v[2:3], off
L_notouch:
s_mov_b64 exec, s[50:51]
v_lshrrev_b32 v1, 6, v0
v_and_b32 v255, 63, v0
v_readfirstlane_b32 s3, v1
s_and_b32 s7, s2, 7
s_lshr_b32 s46, s2, 3
s_lshr_b32 s4, s7, 2
s_lshl_b32 s4, s4, 3
s_lshr_b32 s47, s46, 2
s_add_u32 s4, s4, s47
s_and_b32 s5, s7, 3
s_lshl_b32 s5, s5, 2
s_and_b32 s47, s46, 3
s_add_u32 s5, s5, s47
s_lshl_b32 s6, s3, 12
s_and_b32 s7, s5, 3
s_lshl_b32 s7, s7, 1
s_add_u32 s7, s7, s4
s_mul_i32 s46, s7, 43
s_lshr_b32 s46, s46, 8
s_mul_i32 s46, s46, 6
s_sub_u32 s7, s7, s46
s_add_u32 s43, s7, 1
s_mov_b32 s40, 0
s_mov_b32 s41, 0
s_and_b32 s7, s4, 3
s_lshl_b32 s42, s7, 7
v_lshrrev_b32 v3, 3, v255
v_and_b32 v4, 7, v255
v_lshrrev_b32 v5, 4, v255
v_lshrrev_b32 v6, 5, v255
v_and_b32 v7, 31, v255
s_lshl_b32 s7, s3, 5
v_add_u32 v8, s7, v3
v_mul_u32_u24 v8, 896, v8
v_add_u32 v9, 0, v5
v_and_b32 v9, 7, v9
v_xor_b32 v9, v4, v9
v_lshl_add_u32 v9, v9, 4, v8
v_add_u32 v208, 0, v9
v_add_u32 v9, 4, v5
v_and_b32 v9, 7, v9
v_xor_b32 v9, v4, v9
v_lshl_add_u32 v9, v9, 4, v8
v_add_u32 v209, 6144, v9
v_add_u32 v9, 8, v5
v_and_b32 v9, 7, v9
v_xor_b32 v9, v4, v9
v_lshl_add_u32 v9, v9, 4, v8
v_add_u32 v210, 12288, v9
v_add_u32 v9, 12, v5
v_and_b32 v9, 7, v9
v_xor_b32 v9, v4, v9
v_lshl_add_u32 v9, v9, 4, v8
v_add_u32 v211, 18432, v9
s_lshl_b32 s7, s3, 3
v_add_u32 v8, s7, v6
v_lshlrev_b32 v10, 13, v8
v_add_u32 v9, 0, v6
v_and_b32 v9, 3, v9
v_lshlrev_b32 v9, 2, v9
v_xor_b32 v9, v7, v9
v_lshl_add_u32 v9, v9, 4, v10
v_add_u32 v212, 0, v9
v_add_u32 v9, 2, v6
v_and_b32 v9, 3, v9
v_lshlrev_b32 v9, 2, v9
v_xor_b32 v9, v7, v9
v_lshl_add_u32 v9, v9, 4, v10
v_add_u32 v213, 15360, v9
v_add_u32 v9, 4, v6
v_and_b32 v9, 3, v9
v_lshlrev_b32 v9, 2, v9
v_xor_b32 v9, v7, v9
v_lshl_add_u32 v9, v9, 4, v10
v_add_u32 v214, 30720, v9
v_add_u32 v9, 6, v6
v_and_b32 v9, 3, v9
v_lshlrev_b32 v9, 2, v9
v_xor_b32 v9, v7, v9
v_lshl_add_u32 v9, v9, 4, v10
v_add_u32 v215, 46080, v9
v_lshlrev_b32 v10, 9, v8
v_add_u32 v9, 0, v8
v_and_b32 v9, 15, v9
v_xor_b32 v9, v7, v9
v_lshl_add_u32 v224, v9, 4, v10
v_add_u32 v9, 2, v8
v_and_b32 v9, 15, v9
v_xor_b32 v9, v7, v9
v_lshl_add_u32 v225, v9, 4, v10
v_add_u32 v9, 4, v8
v_and_b32 v9, 15, v9
v_xor_b32 v9, v7, v9
v_lshl_add_u32 v226, v9, 4, v10
v_add_u32 v9, 6, v8
v_and_b32 v9, 15, v9
v_xor_b32 v9, v7, v9
v_lshl_add_u32 v227, v9, 4, v10
s_waitcnt lgkmcnt(0)
s_mul_i32 s7, s4, 100352
s_add_u32 s8, s64, s7
s_addc_u32 s9, s65, 0
s_mov_b32 s10, 100352
s_mov_b32 s11, 0x20000
s_lshl_b32 s7, s5, 9
s_add_u32 s12, s70, s7
s_addc_u32 s13, s71, 0
s_sub_u32 s14, 3670016, s7
s_mov_b32 s15, 0x20000
s_lshl_b32 s7, s4, 4
s_add_u32 s7, s7, s5
s_lshl_b32 s7, s7, 18
s_add_u32 s16, s66, s7
s_addc_u32 s17, s67, 0
s_mov_b32 s18, 262144
s_mov_b32 s19, 0x20000
s_add_u32 s20, s68, s7
s_addc_u32 s21, s69, 0
s_mov_b32 s22, 262144
s_mov_b32 s23, 0x20000
s_add_u32 m0, s6, 0
s_nop 0
buffer_load_dwordx4 v208, s[8:11], s40 offen offset:0 lds
buffer_load_dwordx4 v209, s[8:11], s40 offen offset:1024 lds
buffer_load_dwordx4 v210, s[8:11], s40 offen offset:2048 lds
buffer_load_dwordx4 v211, s[8:11], s40 offen offset:3072 lds
s_lshl_b32 s40, s43, 7
s_add_u32 m0, s6, 16384
s_nop 0
buffer_load_dwordx4 v212, s[12:15], s41 offen offset:0 lds
buffer_load_dwordx4 v213, s[12:15], s41 offen offset:1024 lds
buffer_load_dwordx4 v214, s[12:15], s41 offen offset:2048 lds
buffer_load_dwordx4 v215, s[12:15], s41 offen offset:3072 lds
s_add_u32 s41, s41, 262144
s_cmp_eq_u32 s41, 3670016
s_cselect_b32 s41, 524288, s41
s_add_u32 m0, s6, 32768
s_nop 0
buffer_load_dwordx4 v212, s[12:15], s41 offen offset:0 lds
buffer_load_dwordx4 v213, s[12:15], s41 offen offset:1024 lds
buffer_load_dwordx4 v214, s[12:15], s41 offen offset:2048 lds
buffer_load_dwordx4 v215, s[12:15], s41 offen offset:3072 lds
s_lshl_b32 s41, s43, 19
s_mul_i32 s7, s5, 229376
s_add_u32 s24, s72, s7
s_addc_u32 s25, s73, 0
s_mov_b32 s26, 229376
s_mov_b32 s27, 0x20000
s_mul_i32 s7, s4, 1835008
s_add_u32 s7, s7, 0
s_add_u32 s28, s78, s7
s_addc_u32 s29, s79, 0
s_mov_b32 s30, 1835008
s_mov_b32 s31, 0x20000
s_mul_i32 s7, s4, 100352
s_add_u32 s32, s74, s7
s_addc_u32 s33, s75, 0
s_mov_b32 s34, 100352
s_mov_b32 s35, 0x20000
s_lshl_b32 s7, s4, 15
s_add_u32 s7, s7, 67108864
s_add_u32 s36, s78, s7
s_addc_u32 s37, s79, 0
s_mov_b32 s38, 32768
s_mov_b32 s39, 0x20000
s_mov_b32 s45, 0x3db8aa3b
s_mov_b32 s60, 0x3db8aa3b
s_mov_b32 s61, 0x3db8aa3b
s_lshl_b32 s7, s3, 5
v_add_u32 v8, s7, v3
v_lshlrev_b32 v8, 9, v8
v_and_b32 v9, 1, v5
v_lshlrev_b32 v9, 2, v9
v_xor_b32 v9, v4, v9
v_lshl_add_u32 v9, v9, 4, v8
v_add_u32 v228, 0, v9
v_add_u32 v229, 3072, v9
v_add_u32 v230, 6144, v9
v_add_u32 v231, 9216, v9
s_lshl_b32 s7, s3, 8
v_add_u32 v8, s7, v255
s_mov_b32 s46, 1171
v_add_u32 v9, 0, v8
v_mul_u32_u24 v10, s46, v9
v_lshrrev_b32 v10, 16, v10
v_mul_u32_u24 v11, 56, v10
v_sub_u32 v11, v9, v11
v_lshrrev_b32 v12, 1, v10
v_and_b32 v12, 1, v12
v_lshlrev_b32 v12, 2, v12
v_xor_b32 v11, v11, v12
v_mul_u32_u24 v10, 896, v10
v_lshl_add_u32 v11, v11, 4, v10
v_subrev_u32 v11, 0, v11
v_cmp_gt_u32 vcc, 896, v9
v_mov_b32 v12, 0x40000000
s_nop 0
v_cndmask_b32 v232, v12, v11, vcc
v_add_u32 v9, 64, v8
v_mul_u32_u24 v10, s46, v9
v_lshrrev_b32 v10, 16, v10
v_mul_u32_u24 v11, 56, v10
v_sub_u32 v11, v9, v11
v_lshrrev_b32 v12, 1, v10
v_and_b32 v12, 1, v12
v_lshlrev_b32 v12, 2, v12
v_xor_b32 v11, v11, v12
v_mul_u32_u24 v10, 896, v10
v_lshl_add_u32 v11, v11, 4, v10
v_subrev_u32 v11, 1024, v11
v_cmp_gt_u32 vcc, 896, v9
v_mov_b32 v12, 0x40000000
s_nop 0
v_cndmask_b32 v233, v12, v11, vcc
v_add_u32 v9, 128, v8
v_mul_u32_u24 v10, s46, v9
v_lshrrev_b32 v10, 16, v10
v_mul_u32_u24 v11, 56, v10
v_sub_u32 v11, v9, v11
v_lshrrev_b32 v12, 1, v10
v_and_b32 v12, 1, v12
v_lshlrev_b32 v12, 2, v12
v_xor_b32 v11, v11, v12
v_mul_u32_u24 v10, 896, v10
v_lshl_add_u32 v11, v11, 4, v10
v_subrev_u32 v11, 2048, v11
v_cmp_gt_u32 vcc, 896, v9
v_mov_b32 v12, 0x40000000
s_nop 0
v_cndmask_b32 v234, v12, v11, vcc
v_add_u32 v9, 192, v8
v_mul_u32_u24 v10, s46, v9
v_lshrrev_b32 v10, 16, v10
v_mul_u32_u24 v11, 56, v10
v_sub_u32 v11, v9, v11
v_lshrrev_b32 v12, 1, v10
v_and_b32 v12, 1, v12
v_lshlrev_b32 v12, 2, v12
v_xor_b32 v11, v11, v12
v_mul_u32_u24 v10, 896, v10
v_lshl_add_u32 v11, v11, 4, v10
v_subrev_u32 v11, 3072, v11
v_cmp_gt_u32 vcc, 896, v9
v_mov_b32 v12, 0x40000000
s_nop 0
v_cndmask_b32 v235, v12, v11, vcc
v_and_b32 v8, 1, v5
v_lshrrev_b32 v9, 2, v255
v_and_b32 v9, 3, v9
v_and_b32 v10, 3, v255
v_and_b32 v11, 1, v10
v_lshrrev_b32 v12, 1, v10
v_lshl_add_u32 v13, v6, 3, v9
v_lshlrev_b32 v13, 9, v13
v_lshl_add_u32 v14, v8, 1, v11
v_lshl_add_u32 v13, v14, 4, v13
v_lshl_add_u32 v13, v12, 3, v13
v_xor_b32 v14, 0, v9
v_lshl_add_u32 v220, v14, 6, v13
v_xor_b32 v14, 1, v9
v_lshl_add_u32 v221, v14, 6, v13
v_xor_b32 v14, 2, v9
v_lshl_add_u32 v222, v14, 6, v13
v_xor_b32 v14, 3, v9
v_lshl_add_u32 v223, v14, 6, v13
s_mov_b32 s46, 112
s_lshl_b32 s7, s3, 5
v_add_u32 v13, s7, v7
v_cmp_gt_u32_e64 s[62:63], s46, v13
v_lshrrev_b32 v14, 1, v13
v_and_b32 v14, 7, v14
v_lshlrev_b32 v13, 7, v13
v_add_u32 v15, 0, v6
v_xor_b32 v15, v15, v14
v_lshl_add_u32 v216, v15, 4, v13
v_add_u32 v15, 2, v6
v_xor_b32 v15, v15, v14
v_lshl_add_u32 v217, v15, 4, v13
v_add_u32 v15, 4, v6
v_xor_b32 v15, v15, v14
v_lshl_add_u32 v218, v15, 4, v13
v_add_u32 v15, 6, v6
v_xor_b32 v15, v15, v14
v_lshl_add_u32 v219, v15, 4, v13
v_lshlrev_b32 v13, 9, v7
v_and_b32 v14, 15, v7
v_add_u32 v15, 0, v6
v_xor_b32 v15, v15, v14
v_lshl_add_u32 v236, v15, 4, v13
v_add_u32 v15, 2, v6
v_xor_b32 v15, v15, v14
v_lshl_add_u32 v237, v15, 4, v13
v_add_u32 v15, 4, v6
v_xor_b32 v15, v15, v14
v_lshl_add_u32 v238, v15, 4, v13
v_add_u32 v15, 6, v6
v_xor_b32 v15, v15, v14
v_lshl_add_u32 v239, v15, 4, v13
v_add_u32 v15, 8, v6
v_xor_b32 v15, v15, v14
v_lshl_add_u32 v240, v15, 4, v13
v_add_u32 v15, 10, v6
v_xor_b32 v15, v15, v14
v_lshl_add_u32 v241, v15, 4, v13
v_add_u32 v15, 12, v6
v_xor_b32 v15, v15, v14
v_lshl_add_u32 v242, v15, 4, v13
v_add_u32 v15, 14, v6
v_xor_b32 v15, v15, v14
v_lshl_add_u32 v243, v15, 4, v13
v_lshl_add_u32 v13, v6, 2, v9
v_lshrrev_b32 v14, 1, v9
v_lshl_add_u32 v15, v8, 1, v12
v_lshlrev_b32 v16, 7, v13
v_lshl_add_u32 v16, v15, 4, v16
v_lshl_add_u32 v16, v11, 3, v16
v_xor_b32 v17, 0, v14
v_lshl_add_u32 v244, v17, 6, v16
v_xor_b32 v17, 1, v14
v_lshl_add_u32 v245, v17, 6, v16
v_mul_u32_u24 v16, 896, v13
v_lshl_add_u32 v15, v8, 1, v11
v_lshl_add_u32 v16, v15, 4, v16
v_lshl_add_u32 v16, v12, 3, v16
v_xor_b32 v17, 0, v14
v_lshl_add_u32 v246, v17, 6, v16
v_xor_b32 v17, 1, v14
v_lshl_add_u32 v247, v17, 6, v16
s_add_u32 s7, s42, 0
s_and_b32 s68, s7, 511
s_mul_i32 s72, s68, 448
s_add_u32 s7, s42, 128
s_and_b32 s69, s7, 511
s_mul_i32 s73, s69, 448
s_add_u32 s7, s42, 256
s_and_b32 s70, s7, 511
s_mul_i32 s74, s70, 448
s_add_u32 s7, s42, 384
s_and_b32 s71, s7, 511
s_mul_i32 s75, s71, 448
v_add_u32 v128, 0x10000, v220
v_add_u32 v132, 0x20000, v220
v_add_u32 v129, 0x10000, v221
v_add_u32 v133, 0x20000, v221
v_add_u32 v130, 0x10000, v222
v_add_u32 v134, 0x20000, v222
v_add_u32 v131, 0x10000, v223
v_add_u32 v135, 0x20000, v223
v_add_u32 v136, 0x10000, v216
v_add_u32 v140, 0x20000, v216
v_add_u32 v137, 0x10000, v217
v_add_u32 v141, 0x20000, v217
v_add_u32 v138, 0x10000, v218
v_add_u32 v142, 0x20000, v218
v_add_u32 v139, 0x10000, v219
v_add_u32 v143, 0x20000, v219
v_add_u32 v160, 0x10000, v236
v_add_u32 v168, 0x20000, v236
v_add_u32 v161, 0x10000, v237
v_add_u32 v169, 0x20000, v237
v_add_u32 v162, 0x10000, v238
v_add_u32 v170, 0x20000, v238
v_add_u32 v163, 0x10000, v239
v_add_u32 v171, 0x20000, v239
v_add_u32 v164, 0x10000, v240
v_add_u32 v172, 0x20000, v240
v_add_u32 v165, 0x10000, v241
v_add_u32 v173, 0x20000, v241
v_add_u32 v166, 0x10000, v242
v_add_u32 v174, 0x20000, v242
v_add_u32 v167, 0x10000, v243
v_add_u32 v175, 0x20000, v243
s_cmp_lg_u32 s5, 0
s_cbranch_scc1 L_nononce
s_cmp_lg_u32 s3, 0
s_cbranch_scc1 L_nononce
s_memrealtime s[56:57]
s_waitcnt lgkmcnt(0)
s_or_b32 s56, s56, 1
v_mov_b32 v13, s56
v_mov_b32 v14, s4
v_lshlrev_b32 v14, 2, v14
v_add_u32 v14, 128, v14
s_mov_b64 s[50:51], exec
s_mov_b64 exec, 1
global_store_dword v14, v13, s[76:77] sc1
s_mov_b64 exec, s[50:51]
L_nononce:
s_add_u32 m0, s6, 49152
s_nop 0
buffer_load_dwordx4 v212, s[12:15], s41 offen offset:0 lds
buffer_load_dwordx4 v213, s[12:15], s41 offen offset:1024 lds
buffer_load_dwordx4 v214, s[12:15], s41 offen offset:2048 lds
buffer_load_dwordx4 v215, s[12:15], s41 offen offset:3072 lds
s_add_u32 s41, s41, 262144
s_cmp_eq_u32 s41, 3670016
s_cselect_b32 s41, 524288, s41
s_add_u32 m0, s6, 65536
s_nop 0
buffer_load_dwordx4 v208, s[8:11], s40 offen offset:0 lds
buffer_load_dwordx4 v209, s[8:11], s40 offen offset:1024 lds
buffer_load_dwordx4 v210, s[8:11], s40 offen offset:2048 lds
buffer_load_dwordx4 v211, s[8:11], s40 offen offset:3072 lds
s_add_u32 s40, s40, 128
s_cmp_eq_u32 s40, 896
s_cselect_b32 s40, 128, s40
s_mov_b32 s47, 0x47800000
s_waitcnt vmcnt(12)
s_barrier
ds_read_b128 a[64:67], v216 offset:0
ds_read_b64_tr_b16 a[224:225], v220 offset:16384
ds_read_b64_tr_b16 a[226:227], v220 offset:18432
ds_read_b64_tr_b16 a[228:229], v221 offset:16384
ds_read_b64_tr_b16 a[230:231], v221 offset:18432
ds_read_b64_tr_b16 a[232:233], v222 offset:16384
ds_read_b64_tr_b16 a[234:235], v222 offset:18432
ds_read_b64_tr_b16 a[236:237], v223 offset:16384
ds_read_b64_tr_b16 a[238:239], v223 offset:18432
ds_read_b64_tr_b16 a[240:241], v220 offset:16640
ds_read_b64_tr_b16 a[242:243], v220 offset:18688
ds_read_b64_tr_b16 a[244:245], v221 offset:16640
ds_read_b64_tr_b16 a[246:247], v221 offset:18688
ds_read_b64_tr_b16 a[248:249], v222 offset:16640
ds_read_b64_tr_b16 a[250:251], v222 offset:18688
s_waitcnt lgkmcnt(10)
v_mfma_f32_32x32x16_bf16 v[0:15], a[224:227], a[64:67], 0
ds_read_b64_tr_b16 a[252:253], v223 offset:16640
ds_read_b64_tr_b16 a[254:255], v223 offset:18688
s_add_u32 m0, s6, 81920
s_nop 0
buffer_load_dwordx4 v212, s[12:15], s41 offen offset:0 lds
v_mfma_f32_32x32x16_bf16 v[16:31], a[228:231], a[64:67], 0
ds_read_b128 a[68:71], v217 offset:0
ds_read_b64_tr_b16 a[224:225], v220 offset:24576
ds_read_b64_tr_b16 a[226:227], v220 offset:26624
s_waitcnt lgkmcnt(11)
v_mfma_f32_32x32x16_bf16 v[32:47], a[232:235], a[64:67], 0
ds_read_b64_tr_b16 a[228:229], v221 offset:24576
ds_read_b64_tr_b16 a[230:231], v221 offset:26624
buffer_load_dwordx4 v213, s[12:15], s41 offen offset:1024 lds
v_mfma_f32_32x32x16_bf16 v[48:63], a[236:239], a[64:67], 0
ds_read_b64_tr_b16 a[232:233], v222 offset:24576
ds_read_b64_tr_b16 a[234:235], v222 offset:26624
s_waitcnt lgkmcnt(11)
v_mfma_f32_32x32x16_bf16 v[64:79], a[240:243], a[64:67], 0
ds_read_b64_tr_b16 a[236:237], v223 offset:24576
ds_read_b64_tr_b16 a[238:239], v223 offset:26624
buffer_load_dwordx4 v214, s[12:15], s41 offen offset:2048 lds
v_mfma_f32_32x32x16_bf16 v[80:95], a[244:247], a[64:67], 0
ds_read_b64_tr_b16 a[240:241], v220 offset:24832
ds_read_b64_tr_b16 a[242:243], v220 offset:26880
s_waitcnt lgkmcnt(11)
v_mfma_f32_32x32x16_bf16 v[96:111], a[248:251], a[64:67], 0
ds_read_b64_tr_b16 a[244:245], v221 offset:24832
ds_read_b64_tr_b16 a[246:247], v221 offset:26880
buffer_load_dwordx4 v215, s[12:15], s41 offen offset:3072 lds
s_add_u32 s41, s41, 262144
s_cmp_eq_u32 s41, 3670016
s_cselect_b32 s41, 524288, s41
v_mfma_f32_32x32x16_bf16 v[112:127], a[252:255], a[64:67], 0
ds_read_b64_tr_b16 a[248:249], v222 offset:24832
ds_read_b64_tr_b16 a[250:251], v222 offset:26880
s_waitcnt lgkmcnt(10)
v_mfma_f32_32x32x16_bf16 v[0:15], a[224:227], a[68:71], v[0:15]
ds_read_b64_tr_b16 a[252:253], v223 offset:24832
ds_read_b64_tr_b16 a[254:255], v223 offset:26880
s_add_u32 m0, s6, 98304
s_mov_b32 s44, 0
buffer_load_dwordx4 v224, s[16:19], s44 offen offset:0 nt lds
v_mfma_f32_32x32x16_bf16 v[16:31], a[228:231], a[68:71], v[16:31]
ds_read_b128 a[72:75], v218 offset:0
s_waitcnt lgkmcnt(9)
v_mfma_f32_32x32x16_bf16 v[32:47], a[232:235], a[68:71], v[32:47]
buffer_load_dwordx4 v225, s[16:19], s44 offen offset:1024 nt lds
v_mfma_f32_32x32x16_bf16 v[48:63], a[236:239], a[68:71], v[48:63]
s_waitcnt lgkmcnt(5)
v_mfma_f32_32x32x16_bf16 v[64:79], a[240:243], a[68:71], v[64:79]
buffer_load_dwordx4 v226, s[16:19], s44 offen offset:2048 nt lds
v_mfma_f32_32x32x16_bf16 v[80:95], a[244:247], a[68:71], v[80:95]
s_waitcnt lgkmcnt(1)
v_mfma_f32_32x32x16_bf16 v[96:111], a[248:251], a[68:71], v[96:111]
buffer_load_dwordx4 v227, s[16:19], s44 offen offset:3072 nt lds
v_mfma_f32_32x32x16_bf16 v[112:127], a[252:255], a[68:71], v[112:127]
s_waitcnt vmcnt(8)
s_barrier
ds_read_b64_tr_b16 a[224:225], v220 offset:32768
ds_read_b64_tr_b16 a[226:227], v220 offset:34816
ds_read_b64_tr_b16 a[228:229], v221 offset:32768
ds_read_b64_tr_b16 a[230:231], v221 offset:34816
ds_read_b64_tr_b16 a[232:233], v222 offset:32768
ds_read_b64_tr_b16 a[234:235], v222 offset:34816
ds_read_b64_tr_b16 a[236:237], v223 offset:32768
ds_read_b64_tr_b16 a[238:239], v223 offset:34816
ds_read_b64_tr_b16 a[240:241], v220 offset:33024
ds_read_b64_tr_b16 a[242:243], v220 offset:35072
ds_read_b64_tr_b16 a[244:245], v221 offset:33024
ds_read_b64_tr_b16 a[246:247], v221 offset:35072
ds_read_b64_tr_b16 a[248:249], v222 offset:33024
ds_read_b64_tr_b16 a[250:251], v222 offset:35072
s_waitcnt lgkmcnt(10)
v_mfma_f32_32x32x16_bf16 v[0:15], a[224:227], a[72:75], v[0:15]
ds_read_b64_tr_b16 a[252:253], v223 offset:33024
ds_read_b64_tr_b16 a[254:255], v223 offset:35072
s_add_u32 m0, s6, 114688
s_nop 0
buffer_load_dwordx4 v212, s[12:15], s41 offen offset:0 lds
v_mfma_f32_32x32x16_bf16 v[16:31], a[228:231], a[72:75], v[16:31]
ds_read_b128 a[76:79], v219 offset:0
ds_read_b64_tr_b16 a[224:225], v220 offset:40960
ds_read_b64_tr_b16 a[226:227], v220 offset:43008
s_waitcnt lgkmcnt(11)
v_mfma_f32_32x32x16_bf16 v[32:47], a[232:235], a[72:75], v[32:47]
ds_read_b64_tr_b16 a[228:229], v221 offset:40960
ds_read_b64_tr_b16 a[230:231], v221 offset:43008
buffer_load_dwordx4 v213, s[12:15], s41 offen offset:1024 lds
v_mfma_f32_32x32x16_bf16 v[48:63], a[236:239], a[72:75], v[48:63]
ds_read_b64_tr_b16 a[232:233], v222 offset:40960
ds_read_b64_tr_b16 a[234:235], v222 offset:43008
s_waitcnt lgkmcnt(11)
v_mfma_f32_32x32x16_bf16 v[64:79], a[240:243], a[72:75], v[64:79]
ds_read_b64_tr_b16 a[236:237], v223 offset:40960
ds_read_b64_tr_b16 a[238:239], v223 offset:43008
buffer_load_dwordx4 v214, s[12:15], s41 offen offset:2048 lds
v_mfma_f32_32x32x16_bf16 v[80:95], a[244:247], a[72:75], v[80:95]
ds_read_b64_tr_b16 a[240:241], v220 offset:41216
ds_read_b64_tr_b16 a[242:243], v220 offset:43264
s_waitcnt lgkmcnt(11)
v_mfma_f32_32x32x16_bf16 v[96:111], a[248:251], a[72:75], v[96:111]
ds_read_b64_tr_b16 a[244:245], v221 offset:41216
ds_read_b64_tr_b16 a[246:247], v221 offset:43264
buffer_load_dwordx4 v215, s[12:15], s41 offen offset:3072 lds
s_add_u32 s41, s41, 262144
s_cmp_eq_u32 s41, 3670016
s_cselect_b32 s41, 524288, s41
v_mfma_f32_32x32x16_bf16 v[112:127], a[252:255], a[72:75], v[112:127]
ds_read_b64_tr_b16 a[248:249], v222 offset:41216
ds_read_b64_tr_b16 a[250:251], v222 offset:43264
s_waitcnt lgkmcnt(10)
v_mfma_f32_32x32x16_bf16 v[0:15], a[224:227], a[76:79], v[0:15]
ds_read_b64_tr_b16 a[252:253], v223 offset:41216
ds_read_b64_tr_b16 a[254:255], v223 offset:43264
s_add_u32 m0, s6, 131072
s_nop 0
buffer_load_dwordx4 v208, s[8:11], s40 offen offset:0 lds
v_mfma_f32_32x32x16_bf16 v[16:31], a[228:231], a[76:79], v[16:31]
ds_read_b128 a[64:67], v136 offset:0
ds_read_b64_tr_b16 a[224:225], v220 offset:49152
ds_read_b64_tr_b16 a[226:227], v220 offset:51200
s_waitcnt lgkmcnt(11)
v_mfma_f32_32x32x16_bf16 v[32:47], a[232:235], a[76:79], v[32:47]
ds_read_b64_tr_b16 a[228:229], v221 offset:49152
ds_read_b64_tr_b16 a[230:231], v221 offset:51200
buffer_load_dwordx4 v209, s[8:11], s40 offen offset:1024 lds
v_mfma_f32_32x32x16_bf16 v[48:63], a[236:239], a[76:79], v[48:63]
ds_read_b64_tr_b16 a[232:233], v222 offset:49152
ds_read_b64_tr_b16 a[234:235], v222 offset:51200
s_waitcnt lgkmcnt(11)
v_mfma_f32_32x32x16_bf16 v[64:79], a[240:243], a[76:79], v[64:79]
ds_read_b64_tr_b16 a[236:237], v223 offset:49152
ds_read_b64_tr_b16 a[238:239], v223 offset:51200
buffer_load_dwordx4 v210, s[8:11], s40 offen offset:2048 lds
v_mfma_f32_32x32x16_bf16 v[80:95], a[244:247], a[76:79], v[80:95]
ds_read_b64_tr_b16 a[240:241], v220 offset:49408
ds_read_b64_tr_b16 a[242:243], v220 offset:51456
s_waitcnt lgkmcnt(11)
v_mfma_f32_32x32x16_bf16 v[96:111], a[248:251], a[76:79], v[96:111]
ds_read_b64_tr_b16 a[244:245], v221 offset:49408
ds_read_b64_tr_b16 a[246:247], v221 offset:51456
buffer_load_dwordx4 v211, s[8:11], s40 offen offset:3072 lds
s_add_u32 s40, s40, 128
s_cmp_eq_u32 s40, 896
s_cselect_b32 s40, 128, s40
v_mfma_f32_32x32x16_bf16 v[112:127], a[252:255], a[76:79], v[112:127]
ds_read_b64_tr_b16 a[248:249], v222 offset:49408
ds_read_b64_tr_b16 a[250:251], v222 offset:51456
s_waitcnt vmcnt(12)
s_barrier
s_waitcnt lgkmcnt(10)
v_mfma_f32_32x32x16_bf16 v[0:15], a[224:227], a[64:67], v[0:15]
ds_read_b64_tr_b16 a[252:253], v223 offset:49408
ds_read_b64_tr_b16 a[254:255], v223 offset:51456
s_add_u32 m0, s6, 147456
s_nop 0
buffer_load_dwordx4 v212, s[12:15], s41 offen offset:0 lds
v_mfma_f32_32x32x16_bf16 v[16:31], a[228:231], a[64:67], v[16:31]
ds_read_b128 a[68:71], v137 offset:0
ds_read_b64_tr_b16 a[224:225], v220 offset:57344
ds_read_b64_tr_b16 a[226:227], v220 offset:59392
s_waitcnt lgkmcnt(11)
v_mfma_f32_32x32x16_bf16 v[32:47], a[232:235], a[64:67], v[32:47]
ds_read_b64_tr_b16 a[228:229], v221 offset:57344
ds_read_b64_tr_b16 a[230:231], v221 offset:59392
buffer_load_dwordx4 v213, s[12:15], s41 offen offset:1024 lds
v_mfma_f32_32x32x16_bf16 v[48:63], a[236:239], a[64:67], v[48:63]
ds_read_b64_tr_b16 a[232:233], v222 offset:57344
ds_read_b64_tr_b16 a[234:235], v222 offset:59392
s_waitcnt lgkmcnt(11)
v_mfma_f32_32x32x16_bf16 v[64:79], a[240:243], a[64:67], v[64:79]
ds_read_b64_tr_b16 a[236:237], v223 offset:57344
ds_read_b64_tr_b16 a[238:239], v223 offset:59392
buffer_load_dwordx4 v214, s[12:15], s41 offen offset:2048 lds
v_mfma_f32_32x32x16_bf16 v[80:95], a[244:247], a[64:67], v[80:95]
ds_read_b64_tr_b16 a[240:241], v220 offset:57600
ds_read_b64_tr_b16 a[242:243], v220 offset:59648
s_waitcnt lgkmcnt(11)
v_mfma_f32_32x32x16_bf16 v[96:111], a[248:251], a[64:67], v[96:111]
ds_read_b64_tr_b16 a[244:245], v221 offset:57600
ds_read_b64_tr_b16 a[246:247], v221 offset:59648
buffer_load_dwordx4 v215, s[12:15], s41 offen offset:3072 lds
s_add_u32 s41, s41, 262144
s_cmp_eq_u32 s41, 3670016
s_cselect_b32 s41, 524288, s41
v_mfma_f32_32x32x16_bf16 v[112:127], a[252:255], a[64:67], v[112:127]
ds_read_b64_tr_b16 a[248:249], v222 offset:57600
ds_read_b64_tr_b16 a[250:251], v222 offset:59648
s_waitcnt lgkmcnt(10)
v_mfma_f32_32x32x16_bf16 v[0:15], a[224:227], a[68:71], v[0:15]
ds_read_b64_tr_b16 a[252:253], v223 offset:57600
ds_read_b64_tr_b16 a[254:255], v223 offset:59648
s_add_u32 m0, s6, 16384
s_mov_b32 s44, 16384
buffer_load_dwordx4 v224, s[16:19], s44 offen offset:0 nt lds
v_mfma_f32_32x32x16_bf16 v[16:31], a[228:231], a[68:71], v[16:31]
ds_read_b128 a[72:75], v138 offset:0
ds_read_b64_tr_b16 a[224:225], v128 offset:16384
ds_read_b64_tr_b16 a[226:227], v128 offset:18432
s_waitcnt lgkmcnt(11)
v_mfma_f32_32x32x16_bf16 v[32:47], a[232:235], a[68:71], v[32:47]
ds_read_b64_tr_b16 a[228:229], v129 offset:16384
ds_read_b64_tr_b16 a[230:231], v129 offset:18432
buffer_load_dwordx4 v225, s[16:19], s44 offen offset:1024 nt lds
v_mfma_f32_32x32x16_bf16 v[48:63], a[236:239], a[68:71], v[48:63]
ds_read_b64_tr_b16 a[232:233], v130 offset:16384
ds_read_b64_tr_b16 a[234:235], v130 offset:18432
s_waitcnt lgkmcnt(11)
v_mfma_f32_32x32x16_bf16 v[64:79], a[240:243], a[68:71], v[64:79]
ds_read_b64_tr_b16 a[236:237], v131 offset:16384
ds_read_b64_tr_b16 a[238:239], v131 offset:18432
buffer_load_dwordx4 v226, s[16:19], s44 offen offset:2048 nt lds
v_mfma_f32_32x32x16_bf16 v[80:95], a[244:247], a[68:71], v[80:95]
ds_read_b64_tr_b16 a[240:241], v128 offset:16640
ds_read_b64_tr_b16 a[242:243], v128 offset:18688
s_waitcnt lgkmcnt(11)
v_mfma_f32_32x32x16_bf16 v[96:111], a[248:251], a[68:71], v[96:111]
ds_read_b64_tr_b16 a[244:245], v129 offset:16640
ds_read_b64_tr_b16 a[246:247], v129 offset:18688
buffer_load_dwordx4 v227, s[16:19], s44 offen offset:3072 nt lds
v_mfma_f32_32x32x16_bf16 v[112:127], a[252:255], a[68:71], v[112:127]
ds_read_b64_tr_b16 a[248:249], v130 offset:16640
ds_read_b64_tr_b16 a[250:251], v130 offset:18688
s_waitcnt vmcnt(8)
s_barrier
s_waitcnt lgkmcnt(10)
v_mfma_f32_32x32x16_bf16 v[0:15], a[224:227], a[72:75], v[0:15]
ds_read_b64_tr_b16 a[252:253], v131 offset:16640
ds_read_b64_tr_b16 a[254:255], v131 offset:18688
s_add_u32 m0, s6, 0
s_nop 0
buffer_load_dwordx4 v212, s[12:15], s41 offen offset:0 lds
v_mfma_f32_32x32x16_bf16 v[16:31], a[228:231], a[72:75], v[16:31]
ds_read_b128 a[76:79], v139 offset:0
ds_read_b64_tr_b16 a[224:225], v128 offset:24576
ds_read_b64_tr_b16 a[226:227], v128 offset:26624
s_waitcnt lgkmcnt(11)
v_mfma_f32_32x32x16_bf16 v[32:47], a[232:235], a[72:75], v[32:47]
ds_read_b64_tr_b16 a[228:229], v129 offset:24576
ds_read_b64_tr_b16 a[230:231], v129 offset:26624
buffer_load_dwordx4 v213, s[12:15], s41 offen offset:1024 lds
v_mfma_f32_32x32x16_bf16 v[48:63], a[236:239], a[72:75], v[48:63]
ds_read_b64_tr_b16 a[232:233], v130 offset:24576
ds_read_b64_tr_b16 a[234:235], v130 offset:26624
s_waitcnt lgkmcnt(11)
v_mfma_f32_32x32x16_bf16 v[64:79], a[240:243], a[72:75], v[64:79]
ds_read_b64_tr_b16 a[236:237], v131 offset:24576
ds_read_b64_tr_b16 a[238:239], v131 offset:26624
buffer_load_dwordx4 v214, s[12:15], s41 offen offset:2048 lds
v_mfma_f32_32x32x16_bf16 v[80:95], a[244:247], a[72:75], v[80:95]
ds_read_b64_tr_b16 a[240:241], v128 offset:24832
ds_read_b64_tr_b16 a[242:243], v128 offset:26880
s_waitcnt lgkmcnt(11)
v_mfma_f32_32x32x16_bf16 v[96:111], a[248:251], a[72:75], v[96:111]
ds_read_b64_tr_b16 a[244:245], v129 offset:24832
ds_read_b64_tr_b16 a[246:247], v129 offset:26880
buffer_load_dwordx4 v215, s[12:15], s41 offen offset:3072 lds
s_add_u32 s41, s41, 262144
s_cmp_eq_u32 s41, 3670016
s_cselect_b32 s41, 524288, s41
v_mfma_f32_32x32x16_bf16 v[112:127], a[252:255], a[72:75], v[112:127]
ds_read_b64_tr_b16 a[248:249], v130 offset:24832
ds_read_b64_tr_b16 a[250:251], v130 offset:26880
s_waitcnt lgkmcnt(10)
v_mfma_f32_32x32x16_bf16 v[0:15], a[224:227], a[76:79], v[0:15]
ds_read_b64_tr_b16 a[252:253], v131 offset:24832
ds_read_b64_tr_b16 a[254:255], v131 offset:26880
s_add_u32 m0, s6, 32768
s_nop 0
buffer_load_dwordx4 v208, s[8:11], s40 offen offset:0 lds
v_mfma_f32_32x32x16_bf16 v[16:31], a[228:231], a[76:79], v[16:31]
ds_read_b128 a[64:67], v140 offset:0
ds_read_b64_tr_b16 a[224:225], v128 offset:49152
ds_read_b64_tr_b16 a[226:227], v128 offset:51200
s_waitcnt lgkmcnt(11)
v_mfma_f32_32x32x16_bf16 v[32:47], a[232:235], a[76:79], v[32:47]
ds_read_b64_tr_b16 a[228:229], v129 offset:49152
ds_read_b64_tr_b16 a[230:231], v129 offset:51200
buffer_load_dwordx4 v209, s[8:11], s40 offen offset:1024 lds
v_mfma_f32_32x32x16_bf16 v[48:63], a[236:239], a[76:79], v[48:63]
ds_read_b64_tr_b16 a[232:233], v130 offset:49152
ds_read_b64_tr_b16 a[234:235], v130 offset:51200
s_waitcnt lgkmcnt(11)
v_mfma_f32_32x32x16_bf16 v[64:79], a[240:243], a[76:79], v[64:79]
ds_read_b64_tr_b16 a[236:237], v131 offset:49152
ds_read_b64_tr_b16 a[238:239], v131 offset:51200
buffer_load_dwordx4 v210, s[8:11], s40 offen offset:2048 lds
v_mfma_f32_32x32x16_bf16 v[80:95], a[244:247], a[76:79], v[80:95]
ds_read_b64_tr_b16 a[240:241], v128 offset:49408
ds_read_b64_tr_b16 a[242:243], v128 offset:51456
s_waitcnt lgkmcnt(11)
v_mfma_f32_32x32x16_bf16 v[96:111], a[248:251], a[76:79], v[96:111]
ds_read_b64_tr_b16 a[244:245], v129 offset:49408
ds_read_b64_tr_b16 a[246:247], v129 offset:51456
buffer_load_dwordx4 v211, s[8:11], s40 offen offset:3072 lds
s_add_u32 s40, s40, 128
s_cmp_eq_u32 s40, 896
s_cselect_b32 s40, 128, s40
v_mfma_f32_32x32x16_bf16 v[112:127], a[252:255], a[76:79], v[112:127]
ds_read_b64_tr_b16 a[248:249], v130 offset:49408
ds_read_b64_tr_b16 a[250:251], v130 offset:51456
s_waitcnt vmcnt(12)
s_barrier
s_waitcnt lgkmcnt(10)
v_mfma_f32_32x32x16_bf16 v[0:15], a[224:227], a[64:67], v[0:15]
ds_read_b64_tr_b16 a[252:253], v131 offset:49408
ds_read_b64_tr_b16 a[254:255], v131 offset:51456
s_add_u32 m0, s6, 49152
s_nop 0
buffer_load_dwordx4 v212, s[12:15], s41 offen offset:0 lds
v_mfma_f32_32x32x16_bf16 v[16:31], a[228:231], a[64:67], v[16:31]
ds_read_b128 a[68:71], v141 offset:0
ds_read_b64_tr_b16 a[224:225], v128 offset:57344
ds_read_b64_tr_b16 a[226:227], v128 offset:59392
s_waitcnt lgkmcnt(11)
v_mfma_f32_32x32x16_bf16 v[32:47], a[232:235], a[64:67], v[32:47]
ds_read_b64_tr_b16 a[228:229], v129 offset:57344
ds_read_b64_tr_b16 a[230:231], v129 offset:59392
buffer_load_dwordx4 v213, s[12:15], s41 offen offset:1024 lds
v_mfma_f32_32x32x16_bf16 v[48:63], a[236:239], a[64:67], v[48:63]
ds_read_b64_tr_b16 a[232:233], v130 offset:57344
ds_read_b64_tr_b16 a[234:235], v130 offset:59392
s_waitcnt lgkmcnt(11)
v_mfma_f32_32x32x16_bf16 v[64:79], a[240:243], a[64:67], v[64:79]
ds_read_b64_tr_b16 a[236:237], v131 offset:57344
ds_read_b64_tr_b16 a[238:239], v131 offset:59392
buffer_load_dwordx4 v214, s[12:15], s41 offen offset:2048 lds
v_mfma_f32_32x32x16_bf16 v[80:95], a[244:247], a[64:67], v[80:95]
ds_read_b64_tr_b16 a[240:241], v128 offset:57600
ds_read_b64_tr_b16 a[242:243], v128 offset:59648
s_waitcnt lgkmcnt(11)
v_mfma_f32_32x32x16_bf16 v[96:111], a[248:251], a[64:67], v[96:111]
ds_read_b64_tr_b16 a[244:245], v129 offset:57600
ds_read_b64_tr_b16 a[246:247], v129 offset:59648
buffer_load_dwordx4 v215, s[12:15], s41 offen offset:3072 lds
s_add_u32 s41, s41, 262144
s_cmp_eq_u32 s41, 3670016
s_cselect_b32 s41, 524288, s41
v_mfma_f32_32x32x16_bf16 v[112:127], a[252:255], a[64:67], v[112:127]
ds_read_b64_tr_b16 a[248:249], v130 offset:57600
ds_read_b64_tr_b16 a[250:251], v130 offset:59648
s_waitcnt lgkmcnt(10)
v_mfma_f32_32x32x16_bf16 v[0:15], a[224:227], a[68:71], v[0:15]
ds_read_b64_tr_b16 a[252:253], v131 offset:57600
ds_read_b64_tr_b16 a[254:255], v131 offset:59648
s_add_u32 m0, s6, 65536
s_mov_b32 s44, 32768
buffer_load_dwordx4 v224, s[16:19], s44 offen offset:0 nt lds
v_mfma_f32_32x32x16_bf16 v[16:31], a[228:231], a[68:71], v[16:31]
ds_read_b128 a[72:75], v142 offset:0
ds_read_b64_tr_b16 a[224:225], v132 offset:16384
ds_read_b64_tr_b16 a[226:227], v132 offset:18432
s_waitcnt lgkmcnt(11)
v_mfma_f32_32x32x16_bf16 v[32:47], a[232:235], a[68:71], v[32:47]
ds_read_b64_tr_b16 a[228:229], v133 offset:16384
ds_read_b64_tr_b16 a[230:231], v133 offset:18432
buffer_load_dwordx4 v225, s[16:19], s44 offen offset:1024 nt lds
v_mfma_f32_32x32x16_bf16 v[48:63], a[236:239], a[68:71], v[48:63]
ds_read_b64_tr_b16 a[232:233], v134 offset:16384
ds_read_b64_tr_b16 a[234:235], v134 offset:18432
s_waitcnt lgkmcnt(11)
v_mfma_f32_32x32x16_bf16 v[64:79], a[240:243], a[68:71], v[64:79]
ds_read_b64_tr_b16 a[236:237], v135 offset:16384
ds_read_b64_tr_b16 a[238:239], v135 offset:18432
buffer_load_dwordx4 v226, s[16:19], s44 offen offset:2048 nt lds
v_mfma_f32_32x32x16_bf16 v[80:95], a[244:247], a[68:71], v[80:95]
ds_read_b64_tr_b16 a[240:241], v132 offset:16640
ds_read_b64_tr_b16 a[242:243], v132 offset:18688
s_waitcnt lgkmcnt(11)
v_mfma_f32_32x32x16_bf16 v[96:111], a[248:251], a[68:71], v[96:111]
ds_read_b64_tr_b16 a[244:245], v133 offset:16640
ds_read_b64_tr_b16 a[246:247], v133 offset:18688
buffer_load_dwordx4 v227, s[16:19], s44 offen offset:3072 nt lds
v_mfma_f32_32x32x16_bf16 v[112:127], a[252:255], a[68:71], v[112:127]
ds_read_b64_tr_b16 a[248:249], v134 offset:16640
ds_read_b64_tr_b16 a[250:251], v134 offset:18688
s_waitcnt vmcnt(8)
s_barrier
s_waitcnt lgkmcnt(10)
v_mfma_f32_32x32x16_bf16 v[0:15], a[224:227], a[72:75], v[0:15]
ds_read_b64_tr_b16 a[252:253], v135 offset:16640
ds_read_b64_tr_b16 a[254:255], v135 offset:18688
s_add_u32 m0, s6, 81920
s_nop 0
buffer_load_dwordx4 v212, s[12:15], s41 offen offset:0 lds
v_mfma_f32_32x32x16_bf16 v[16:31], a[228:231], a[72:75], v[16:31]
ds_read_b128 a[76:79], v143 offset:0
ds_read_b64_tr_b16 a[224:225], v132 offset:24576
ds_read_b64_tr_b16 a[226:227], v132 offset:26624
s_waitcnt lgkmcnt(11)
v_mfma_f32_32x32x16_bf16 v[32:47], a[232:235], a[72:75], v[32:47]
ds_read_b64_tr_b16 a[228:229], v133 offset:24576
ds_read_b64_tr_b16 a[230:231], v133 offset:26624
buffer_load_dwordx4 v213, s[12:15], s41 offen offset:1024 lds
v_mfma_f32_32x32x16_bf16 v[48:63], a[236:239], a[72:75], v[48:63]
ds_read_b64_tr_b16 a[232:233], v134 offset:24576
ds_read_b64_tr_b16 a[234:235], v134 offset:26624
s_waitcnt lgkmcnt(11)
v_mfma_f32_32x32x16_bf16 v[64:79], a[240:243], a[72:75], v[64:79]
ds_read_b64_tr_b16 a[236:237], v135 offset:24576
ds_read_b64_tr_b16 a[238:239], v135 offset:26624
buffer_load_dwordx4 v214, s[12:15], s41 offen offset:2048 lds
v_mfma_f32_32x32x16_bf16 v[80:95], a[244:247], a[72:75], v[80:95]
ds_read_b64_tr_b16 a[240:241], v132 offset:24832
ds_read_b64_tr_b16 a[242:243], v132 offset:26880
s_waitcnt lgkmcnt(11)
v_mfma_f32_32x32x16_bf16 v[96:111], a[248:251], a[72:75], v[96:111]
ds_read_b64_tr_b16 a[244:245], v133 offset:24832
ds_read_b64_tr_b16 a[246:247], v133 offset:26880
buffer_load_dwordx4 v215, s[12:15], s41 offen offset:3072 lds
s_add_u32 s41, s41, 262144
s_cmp_eq_u32 s41, 3670016
s_cselect_b32 s41, 524288, s41
v_mfma_f32_32x32x16_bf16 v[112:127], a[252:255], a[72:75], v[112:127]
ds_read_b64_tr_b16 a[248:249], v134 offset:24832
ds_read_b64_tr_b16 a[250:251], v134 offset:26880
s_waitcnt lgkmcnt(10)
v_mfma_f32_32x32x16_bf16 v[0:15], a[224:227], a[76:79], v[0:15]
ds_read_b64_tr_b16 a[252:253], v135 offset:24832
ds_read_b64_tr_b16 a[254:255], v135 offset:26880
s_add_u32 m0, s6, 114688
s_nop 0
buffer_load_dwordx4 v208, s[8:11], s40 offen offset:0 lds
v_mfma_f32_32x32x16_bf16 v[16:31], a[228:231], a[76:79], v[16:31]
ds_read_b128 a[64:67], v216 offset:32768
ds_read_b64_tr_b16 a[224:225], v220 offset:0
ds_read_b64_tr_b16 a[226:227], v220 offset:2048
s_waitcnt lgkmcnt(11)
v_mfma_f32_32x32x16_bf16 v[32:47], a[232:235], a[76:79], v[32:47]
ds_read_b64_tr_b16 a[228:229], v221 offset:0
ds_read_b64_tr_b16 a[230:231], v221 offset:2048
buffer_load_dwordx4 v209, s[8:11], s40 offen offset:1024 lds
v_mfma_f32_32x32x16_bf16 v[48:63], a[236:239], a[76:79], v[48:63]
ds_read_b64_tr_b16 a[232:233], v222 offset:0
ds_read_b64_tr_b16 a[234:235], v222 offset:2048
s_waitcnt lgkmcnt(11)
v_mfma_f32_32x32x16_bf16 v[64:79], a[240:243], a[76:79], v[64:79]
ds_read_b64_tr_b16 a[236:237], v223 offset:0
ds_read_b64_tr_b16 a[238:239], v223 offset:2048
buffer_load_dwordx4 v210, s[8:11], s40 offen offset:2048 lds
v_mfma_f32_32x32x16_bf16 v[80:95], a[244:247], a[76:79], v[80:95]
ds_read_b64_tr_b16 a[240:241], v220 offset:256
ds_read_b64_tr_b16 a[242:243], v220 offset:2304
s_waitcnt lgkmcnt(11)
v_mfma_f32_32x32x16_bf16 v[96:111], a[248:251], a[76:79], v[96:111]
ds_read_b64_tr_b16 a[244:245], v221 offset:256
ds_read_b64_tr_b16 a[246:247], v221 offset:2304
buffer_load_dwordx4 v211, s[8:11], s40 offen offset:3072 lds
s_add_u32 s40, s40, 128
s_cmp_eq_u32 s40, 896
s_cselect_b32 s40, 128, s40
v_mfma_f32_32x32x16_bf16 v[112:127], a[252:255], a[76:79], v[112:127]
ds_read_b64_tr_b16 a[248:249], v222 offset:256
ds_read_b64_tr_b16 a[250:251], v222 offset:2304
s_waitcnt vmcnt(12)
s_barrier
s_waitcnt lgkmcnt(10)
v_mfma_f32_32x32x16_bf16 v[0:15], a[224:227], a[64:67], v[0:15]
ds_read_b64_tr_b16 a[252:253], v223 offset:256
ds_read_b64_tr_b16 a[254:255], v223 offset:2304
s_add_u32 m0, s6, 131072
s_nop 0
buffer_load_dwordx4 v212, s[12:15], s41 offen offset:0 lds
v_mfma_f32_32x32x16_bf16 v[16:31], a[228:231], a[64:67], v[16:31]
ds_read_b128 a[68:71], v217 offset:32768
ds_read_b64_tr_b16 a[224:225], v220 offset:8192
ds_read_b64_tr_b16 a[226:227], v220 offset:10240
s_waitcnt lgkmcnt(11)
v_mfma_f32_32x32x16_bf16 v[32:47], a[232:235], a[64:67], v[32:47]
ds_read_b64_tr_b16 a[228:229], v221 offset:8192
ds_read_b64_tr_b16 a[230:231], v221 offset:10240
buffer_load_dwordx4 v213, s[12:15], s41 offen offset:1024 lds
v_mfma_f32_32x32x16_bf16 v[48:63], a[236:239], a[64:67], v[48:63]
ds_read_b64_tr_b16 a[232:233], v222 offset:8192
ds_read_b64_tr_b16 a[234:235], v222 offset:10240
s_waitcnt lgkmcnt(11)
v_mfma_f32_32x32x16_bf16 v[64:79], a[240:243], a[64:67], v[64:79]
ds_read_b64_tr_b16 a[236:237], v223 offset:8192
ds_read_b64_tr_b16 a[238:239], v223 offset:10240
buffer_load_dwordx4 v214, s[12:15], s41 offen offset:2048 lds
v_mfma_f32_32x32x16_bf16 v[80:95], a[244:247], a[64:67], v[80:95]
ds_read_b64_tr_b16 a[240:241], v220 offset:8448
ds_read_b64_tr_b16 a[242:243], v220 offset:10496
s_waitcnt lgkmcnt(11)
v_mfma_f32_32x32x16_bf16 v[96:111], a[248:251], a[64:67], v[96:111]
ds_read_b64_tr_b16 a[244:245], v221 offset:8448
ds_read_b64_tr_b16 a[246:247], v221 offset:10496
buffer_load_dwordx4 v215, s[12:15], s41 offen offset:3072 lds
s_add_u32 s41, s41, 262144
s_cmp_eq_u32 s41, 3670016
s_cselect_b32 s41, 524288, s41
v_mfma_f32_32x32x16_bf16 v[112:127], a[252:255], a[64:67], v[112:127]
ds_read_b64_tr_b16 a[248:249], v222 offset:8448
ds_read_b64_tr_b16 a[250:251], v222 offset:10496
s_waitcnt lgkmcnt(10)
v_mfma_f32_32x32x16_bf16 v[0:15], a[224:227], a[68:71], v[0:15]
ds_read_b64_tr_b16 a[252:253], v223 offset:8448
ds_read_b64_tr_b16 a[254:255], v223 offset:10496
s_add_u32 m0, s6, 147456
s_mov_b32 s44, 49152
buffer_load_dwordx4 v224, s[16:19], s44 offen offset:0 nt lds
v_mfma_f32_32x32x16_bf16 v[16:31], a[228:231], a[68:71], v[16:31]
ds_read_b128 a[72:75], v218 offset:32768
ds_read_b64_tr_b16 a[224:225], v220 offset:49152
ds_read_b64_tr_b16 a[226:227], v220 offset:51200
s_waitcnt lgkmcnt(11)
v_mfma_f32_32x32x16_bf16 v[32:47], a[232:235], a[68:71], v[32:47]
ds_read_b64_tr_b16 a[228:229], v221 offset:49152
ds_read_b64_tr_b16 a[230:231], v221 offset:51200
buffer_load_dwordx4 v225, s[16:19], s44 offen offset:1024 nt lds
v_mfma_f32_32x32x16_bf16 v[48:63], a[236:239], a[68:71], v[48:63]
ds_read_b64_tr_b16 a[232:233], v222 offset:49152
ds_read_b64_tr_b16 a[234:235], v222 offset:51200
s_waitcnt lgkmcnt(11)
v_mfma_f32_32x32x16_bf16 v[64:79], a[240:243], a[68:71], v[64:79]
ds_read_b64_tr_b16 a[236:237], v223 offset:49152
ds_read_b64_tr_b16 a[238:239], v223 offset:51200
buffer_load_dwordx4 v226, s[16:19], s44 offen offset:2048 nt lds
v_mfma_f32_32x32x16_bf16 v[80:95], a[244:247], a[68:71], v[80:95]
ds_read_b64_tr_b16 a[240:241], v220 offset:49408
ds_read_b64_tr_b16 a[242:243], v220 offset:51456
s_waitcnt lgkmcnt(11)
v_mfma_f32_32x32x16_bf16 v[96:111], a[248:251], a[68:71], v[96:111]
ds_read_b64_tr_b16 a[244:245], v221 offset:49408
ds_read_b64_tr_b16 a[246:247], v221 offset:51456
buffer_load_dwordx4 v227, s[16:19], s44 offen offset:3072 nt lds
v_mfma_f32_32x32x16_bf16 v[112:127], a[252:255], a[68:71], v[112:127]
ds_read_b64_tr_b16 a[248:249], v222 offset:49408
ds_read_b64_tr_b16 a[250:251], v222 offset:51456
s_waitcnt vmcnt(8)
s_barrier
s_waitcnt lgkmcnt(10)
v_mfma_f32_32x32x16_bf16 v[0:15], a[224:227], a[72:75], v[0:15]
ds_read_b64_tr_b16 a[252:253], v223 offset:49408
ds_read_b64_tr_b16 a[254:255], v223 offset:51456
s_add_u32 m0, s6, 0
s_nop 0
buffer_load_dwordx4 v212, s[12:15], s41 offen offset:0 lds
v_mfma_f32_32x32x16_bf16 v[16:31], a[228:231], a[72:75], v[16:31]
ds_read_b128 a[76:79], v219 offset:32768
ds_read_b64_tr_b16 a[224:225], v220 offset:57344
ds_read_b64_tr_b16 a[226:227], v220 offset:59392
s_waitcnt lgkmcnt(11)
v_mfma_f32_32x32x16_bf16 v[32:47], a[232:235], a[72:75], v[32:47]
ds_read_b64_tr_b16 a[228:229], v221 offset:57344
ds_read_b64_tr_b16 a[230:231], v221 offset:59392
v_mfma_f32_32x32x16_bf16 v[48:63], a[236:239], a[72:75], v[48:63]
ds_read_b64_tr_b16 a[232:233], v222 offset:57344
ds_read_b64_tr_b16 a[234:235], v222 offset:59392
s_waitcnt lgkmcnt(11)
v_mfma_f32_32x32x16_bf16 v[64:79], a[240:243], a[72:75], v[64:79]
ds_read_b64_tr_b16 a[236:237], v223 offset:57344
ds_read_b64_tr_b16 a[238:239], v223 offset:59392
buffer_load_dwordx4 v213, s[12:15], s41 offen offset:1024 lds
v_mfma_f32_32x32x16_bf16 v[80:95], a[244:247], a[72:75], v[80:95]
ds_read_b64_tr_b16 a[240:241], v220 offset:57600
ds_read_b64_tr_b16 a[242:243], v220 offset:59648
s_waitcnt lgkmcnt(11)
v_mfma_f32_32x32x16_bf16 v[96:111], a[248:251], a[72:75], v[96:111]
ds_read_b64_tr_b16 a[244:245], v221 offset:57600
ds_read_b64_tr_b16 a[246:247], v221 offset:59648
v_mfma_f32_32x32x16_bf16 v[112:127], a[252:255], a[72:75], v[112:127]
ds_read_b64_tr_b16 a[248:249], v222 offset:57600
ds_read_b64_tr_b16 a[250:251], v222 offset:59648
s_waitcnt lgkmcnt(10)
v_mfma_f32_32x32x16_bf16 v[0:15], a[224:227], a[76:79], v[0:15]
ds_read_b64_tr_b16 a[252:253], v223 offset:57600
ds_read_b64_tr_b16 a[254:255], v223 offset:59648
buffer_load_dwordx4 v214, s[12:15], s41 offen offset:2048 lds
v_mfma_f32_32x32x16_bf16 v[16:31], a[228:231], a[76:79], v[16:31]
ds_read_b128 a[64:67], v136 offset:49152
ds_read_b64_tr_b16 a[224:225], v128 offset:16384
ds_read_b64_tr_b16 a[226:227], v128 offset:18432
s_waitcnt lgkmcnt(11)
v_mfma_f32_32x32x16_bf16 v[32:47], a[232:235], a[76:79], v[32:47]
ds_read_b64_tr_b16 a[228:229], v129 offset:16384
ds_read_b64_tr_b16 a[230:231], v129 offset:18432
v_mfma_f32_32x32x16_bf16 v[48:63], a[236:239], a[76:79], v[48:63]
ds_read_b64_tr_b16 a[232:233], v130 offset:16384
ds_read_b64_tr_b16 a[234:235], v130 offset:18432
s_waitcnt lgkmcnt(11)
v_mfma_f32_32x32x16_bf16 v[64:79], a[240:243], a[76:79], v[64:79]
ds_read_b64_tr_b16 a[236:237], v131 offset:16384
ds_read_b64_tr_b16 a[238:239], v131 offset:18432
buffer_load_dwordx4 v215, s[12:15], s41 offen offset:3072 lds
s_add_u32 s41, s41, 262144
s_cmp_eq_u32 s41, 3670016
s_cselect_b32 s41, 524288, s41
v_mfma_f32_32x32x16_bf16 v[80:95], a[244:247], a[76:79], v[80:95]
ds_read_b64_tr_b16 a[240:241], v128 offset:16640
ds_read_b64_tr_b16 a[242:243], v128 offset:18688
s_waitcnt lgkmcnt(11)
v_mfma_f32_32x32x16_bf16 v[96:111], a[248:251], a[76:79], v[96:111]
ds_read_b64_tr_b16 a[244:245], v129 offset:16640
ds_read_b64_tr_b16 a[246:247], v129 offset:18688
v_mfma_f32_32x32x16_bf16 v[112:127], a[252:255], a[76:79], v[112:127]
ds_read_b64_tr_b16 a[248:249], v130 offset:16640
ds_read_b64_tr_b16 a[250:251], v130 offset:18688
s_waitcnt vmcnt(8)
s_barrier
s_waitcnt lgkmcnt(10)
v_mfma_f32_32x32x16_bf16 v[0:15], a[224:227], a[64:67], v[0:15]
ds_read_b64_tr_b16 a[252:253], v131 offset:16640
ds_read_b64_tr_b16 a[254:255], v131 offset:18688
s_add_u32 m0, s6, 32768
s_nop 0
buffer_load_dwordx4 v208, s[8:11], s40 offen offset:0 lds
v_mfma_f32_32x32x16_bf16 v[16:31], a[228:231], a[64:67], v[16:31]
ds_read_b128 a[68:71], v137 offset:49152
ds_read_b64_tr_b16 a[224:225], v128 offset:24576
ds_read_b64_tr_b16 a[226:227], v128 offset:26624
s_waitcnt lgkmcnt(11)
v_mfma_f32_32x32x16_bf16 v[32:47], a[232:235], a[64:67], v[32:47]
ds_read_b64_tr_b16 a[228:229], v129 offset:24576
ds_read_b64_tr_b16 a[230:231], v129 offset:26624
buffer_load_dwordx4 v209, s[8:11], s40 offen offset:1024 lds
v_mfma_f32_32x32x16_bf16 v[48:63], a[236:239], a[64:67], v[48:63]
ds_read_b64_tr_b16 a[232:233], v130 offset:24576
ds_read_b64_tr_b16 a[234:235], v130 offset:26624
s_waitcnt lgkmcnt(11)
v_mfma_f32_32x32x16_bf16 v[64:79], a[240:243], a[64:67], v[64:79]
ds_read_b64_tr_b16 a[236:237], v131 offset:24576
ds_read_b64_tr_b16 a[238:239], v131 offset:26624
buffer_load_dwordx4 v210, s[8:11], s40 offen offset:2048 lds
v_mfma_f32_32x32x16_bf16 v[80:95], a[244:247], a[64:67], v[80:95]
ds_read_b64_tr_b16 a[240:241], v128 offset:24832
ds_read_b64_tr_b16 a[242:243], v128 offset:26880
s_waitcnt lgkmcnt(11)
v_mfma_f32_32x32x16_bf16 v[96:111], a[248:251], a[64:67], v[96:111]
ds_read_b64_tr_b16 a[244:245], v129 offset:24832
ds_read_b64_tr_b16 a[246:247], v129 offset:26880
buffer_load_dwordx4 v211, s[8:11], s40 offen offset:3072 lds
s_add_u32 s40, s40, 128
s_cmp_eq_u32 s40, 896
s_cselect_b32 s40, 128, s40
v_mfma_f32_32x32x16_bf16 v[112:127], a[252:255], a[64:67], v[112:127]
ds_read_b64_tr_b16 a[248:249], v130 offset:24832
ds_read_b64_tr_b16 a[250:251], v130 offset:26880
s_waitcnt lgkmcnt(10)
v_mfma_f32_32x32x16_bf16 v[0:15], a[224:227], a[68:71], v[0:15]
ds_read_b64_tr_b16 a[252:253], v131 offset:24832
ds_read_b64_tr_b16 a[254:255], v131 offset:26880
s_add_u32 m0, s6, 49152
s_nop 0
buffer_load_dwordx4 v212, s[12:15], s41 offen offset:0 lds
v_mfma_f32_32x32x16_bf16 v[16:31], a[228:231], a[68:71], v[16:31]
ds_read_b128 a[72:75], v138 offset:49152
ds_read_b64_tr_b16 a[224:225], v132 offset:0
ds_read_b64_tr_b16 a[226:227], v132 offset:2048
s_waitcnt lgkmcnt(11)
v_mfma_f32_32x32x16_bf16 v[32:47], a[232:235], a[68:71], v[32:47]
ds_read_b64_tr_b16 a[228:229], v133 offset:0
ds_read_b64_tr_b16 a[230:231], v133 offset:2048
buffer_load_dwordx4 v213, s[12:15], s41 offen offset:1024 lds
v_mfma_f32_32x32x16_bf16 v[48:63], a[236:239], a[68:71], v[48:63]
ds_read_b64_tr_b16 a[232:233], v134 offset:0
ds_read_b64_tr_b16 a[234:235], v134 offset:2048
s_waitcnt lgkmcnt(11)
v_mfma_f32_32x32x16_bf16 v[64:79], a[240:243], a[68:71], v[64:79]
ds_read_b64_tr_b16 a[236:237], v135 offset:0
ds_read_b64_tr_b16 a[238:239], v135 offset:2048
buffer_load_dwordx4 v214, s[12:15], s41 offen offset:2048 lds
v_mfma_f32_32x32x16_bf16 v[80:95], a[244:247], a[68:71], v[80:95]
ds_read_b64_tr_b16 a[240:241], v132 offset:256
ds_read_b64_tr_b16 a[242:243], v132 offset:2304
s_waitcnt lgkmcnt(11)
v_mfma_f32_32x32x16_bf16 v[96:111], a[248:251], a[68:71], v[96:111]
ds_read_b64_tr_b16 a[244:245], v133 offset:256
ds_read_b64_tr_b16 a[246:247], v133 offset:2304
buffer_load_dwordx4 v215, s[12:15], s41 offen offset:3072 lds
s_add_u32 s41, s41, 262144
s_cmp_eq_u32 s41, 3670016
s_cselect_b32 s41, 524288, s41
v_mfma_f32_32x32x16_bf16 v[112:127], a[252:255], a[68:71], v[112:127]
ds_read_b64_tr_b16 a[248:249], v134 offset:256
ds_read_b64_tr_b16 a[250:251], v134 offset:2304
s_waitcnt vmcnt(4)
s_barrier
s_waitcnt lgkmcnt(10)
v_mfma_f32_32x32x16_bf16 v[0:15], a[224:227], a[72:75], v[0:15]
ds_read_b64_tr_b16 a[252:253], v135 offset:256
ds_read_b64_tr_b16 a[254:255], v135 offset:2304
s_add_u32 m0, s6, 81920
s_nop 0
buffer_load_dwordx4 v212, s[12:15], s41 offen offset:0 lds
v_mfma_f32_32x32x16_bf16 v[16:31], a[228:231], a[72:75], v[16:31]
ds_read_b128 a[76:79], v139 offset:49152
ds_read_b64_tr_b16 a[224:225], v132 offset:8192
ds_read_b64_tr_b16 a[226:227], v132 offset:10240
s_waitcnt lgkmcnt(11)
v_mfma_f32_32x32x16_bf16 v[32:47], a[232:235], a[72:75], v[32:47]
ds_read_b64_tr_b16 a[228:229], v133 offset:8192
ds_read_b64_tr_b16 a[230:231], v133 offset:10240
v_mfma_f32_32x32x16_bf16 v[48:63], a[236:239], a[72:75], v[48:63]
ds_read_b64_tr_b16 a[232:233], v134 offset:8192
ds_read_b64_tr_b16 a[234:235], v134 offset:10240
s_waitcnt lgkmcnt(11)
v_mfma_f32_32x32x16_bf16 v[64:79], a[240:243], a[72:75], v[64:79]
ds_read_b64_tr_b16 a[236:237], v135 offset:8192
ds_read_b64_tr_b16 a[238:239], v135 offset:10240
buffer_load_dwordx4 v213, s[12:15], s41 offen offset:1024 lds
v_mfma_f32_32x32x16_bf16 v[80:95], a[244:247], a[72:75], v[80:95]
ds_read_b64_tr_b16 a[240:241], v132 offset:8448
ds_read_b64_tr_b16 a[242:243], v132 offset:10496
s_waitcnt lgkmcnt(11)
v_mfma_f32_32x32x16_bf16 v[96:111], a[248:251], a[72:75], v[96:111]
ds_read_b64_tr_b16 a[244:245], v133 offset:8448
ds_read_b64_tr_b16 a[246:247], v133 offset:10496
v_mfma_f32_32x32x16_bf16 v[112:127], a[252:255], a[72:75], v[112:127]
ds_read_b64_tr_b16 a[248:249], v134 offset:8448
ds_read_b64_tr_b16 a[250:251], v134 offset:10496
s_waitcnt lgkmcnt(10)
v_mfma_f32_32x32x16_bf16 v[0:15], a[224:227], a[76:79], v[0:15]
ds_read_b64_tr_b16 a[252:253], v135 offset:8448
ds_read_b64_tr_b16 a[254:255], v135 offset:10496
buffer_load_dwordx4 v214, s[12:15], s41 offen offset:2048 lds
v_mfma_f32_32x32x16_bf16 v[16:31], a[228:231], a[76:79], v[16:31]
ds_read_b128 a[64:67], v216 offset:32768
ds_read_b64_tr_b16 a[224:225], v220 offset:0
ds_read_b64_tr_b16 a[226:227], v220 offset:2048
s_waitcnt lgkmcnt(11)
v_mfma_f32_32x32x16_bf16 v[32:47], a[232:235], a[76:79], v[32:47]
ds_read_b64_tr_b16 a[228:229], v221 offset:0
ds_read_b64_tr_b16 a[230:231], v221 offset:2048
v_mfma_f32_32x32x16_bf16 v[48:63], a[236:239], a[76:79], v[48:63]
ds_read_b64_tr_b16 a[232:233], v222 offset:0
ds_read_b64_tr_b16 a[234:235], v222 offset:2048
s_waitcnt lgkmcnt(11)
v_mfma_f32_32x32x16_bf16 v[64:79], a[240:243], a[76:79], v[64:79]
ds_read_b64_tr_b16 a[236:237], v223 offset:0
ds_read_b64_tr_b16 a[238:239], v223 offset:2048
buffer_load_dwordx4 v215, s[12:15], s41 offen offset:3072 lds
s_add_u32 s41, s41, 262144
s_cmp_eq_u32 s41, 3670016
s_cselect_b32 s41, 524288, s41
v_mfma_f32_32x32x16_bf16 v[80:95], a[244:247], a[76:79], v[80:95]
ds_read_b64_tr_b16 a[240:241], v220 offset:256
ds_read_b64_tr_b16 a[242:243], v220 offset:2304
s_waitcnt lgkmcnt(11)
v_mfma_f32_32x32x16_bf16 v[96:111], a[248:251], a[76:79], v[96:111]
ds_read_b64_tr_b16 a[244:245], v221 offset:256
ds_read_b64_tr_b16 a[246:247], v221 offset:2304
v_mfma_f32_32x32x16_bf16 v[112:127], a[252:255], a[76:79], v[112:127]
ds_read_b64_tr_b16 a[248:249], v222 offset:256
ds_read_b64_tr_b16 a[250:251], v222 offset:2304
s_waitcnt vmcnt(4)
s_barrier
s_waitcnt lgkmcnt(10)
v_mfma_f32_32x32x16_bf16 v[0:15], a[224:227], a[64:67], v[0:15]
ds_read_b64_tr_b16 a[252:253], v223 offset:256
ds_read_b64_tr_b16 a[254:255], v223 offset:2304
s_add_u32 m0, s6, 114688
s_nop 0
buffer_load_dwordx4 v208, s[8:11], s40 offen offset:0 lds
v_mfma_f32_32x32x16_bf16 v[16:31], a[228:231], a[64:67], v[16:31]
ds_read_b128 a[68:71], v217 offset:32768
ds_read_b64_tr_b16 a[224:225], v220 offset:8192
ds_read_b64_tr_b16 a[226:227], v220 offset:10240
s_waitcnt lgkmcnt(11)
v_mfma_f32_32x32x16_bf16 v[32:47], a[232:235], a[64:67], v[32:47]
ds_read_b64_tr_b16 a[228:229], v221 offset:8192
ds_read_b64_tr_b16 a[230:231], v221 offset:10240
buffer_load_dwordx4 v209, s[8:11], s40 offen offset:1024 lds
v_mfma_f32_32x32x16_bf16 v[48:63], a[236:239], a[64:67], v[48:63]
ds_read_b64_tr_b16 a[232:233], v222 offset:8192
ds_read_b64_tr_b16 a[234:235], v222 offset:10240
s_waitcnt lgkmcnt(11)
v_mfma_f32_32x32x16_bf16 v[64:79], a[240:243], a[64:67], v[64:79]
ds_read_b64_tr_b16 a[236:237], v223 offset:8192
ds_read_b64_tr_b16 a[238:239], v223 offset:10240
buffer_load_dwordx4 v210, s[8:11], s40 offen offset:2048 lds
v_mfma_f32_32x32x16_bf16 v[80:95], a[244:247], a[64:67], v[80:95]
ds_read_b64_tr_b16 a[240:241], v220 offset:8448
ds_read_b64_tr_b16 a[242:243], v220 offset:10496
s_waitcnt lgkmcnt(11)
v_mfma_f32_32x32x16_bf16 v[96:111], a[248:251], a[64:67], v[96:111]
ds_read_b64_tr_b16 a[244:245], v221 offset:8448
ds_read_b64_tr_b16 a[246:247], v221 offset:10496
buffer_load_dwordx4 v211, s[8:11], s40 offen offset:3072 lds
s_add_u32 s40, s40, 128
s_cmp_eq_u32 s40, 896
s_cselect_b32 s40, 128, s40
v_mfma_f32_32x32x16_bf16 v[112:127], a[252:255], a[64:67], v[112:127]
ds_read_b64_tr_b16 a[248:249], v222 offset:8448
ds_read_b64_tr_b16 a[250:251], v222 offset:10496
s_waitcnt lgkmcnt(10)
v_mfma_f32_32x32x16_bf16 v[0:15], a[224:227], a[68:71], v[0:15]
ds_read_b64_tr_b16 a[252:253], v223 offset:8448
ds_read_b64_tr_b16 a[254:255], v223 offset:10496
s_add_u32 m0, s6, 131072
s_mov_b32 s44, 65536
buffer_load_dwordx4 v224, s[16:19], s44 offen offset:0 nt lds
v_mfma_f32_32x32x16_bf16 v[16:31], a[228:231], a[68:71], v[16:31]
ds_read_b128 a[72:75], v218 offset:32768
ds_read_b64_tr_b16 a[224:225], v220 offset:49152
ds_read_b64_tr_b16 a[226:227], v220 offset:51200
s_waitcnt lgkmcnt(11)
v_mfma_f32_32x32x16_bf16 v[32:47], a[232:235], a[68:71], v[32:47]
ds_read_b64_tr_b16 a[228:229], v221 offset:49152
ds_read_b64_tr_b16 a[230:231], v221 offset:51200
buffer_load_dwordx4 v225, s[16:19], s44 offen offset:1024 nt lds
v_mfma_f32_32x32x16_bf16 v[48:63], a[236:239], a[68:71], v[48:63]
ds_read_b64_tr_b16 a[232:233], v222 offset:49152
ds_read_b64_tr_b16 a[234:235], v222 offset:51200
s_waitcnt lgkmcnt(11)
v_mfma_f32_32x32x16_bf16 v[64:79], a[240:243], a[68:71], v[64:79]
ds_read_b64_tr_b16 a[236:237], v223 offset:49152
ds_read_b64_tr_b16 a[238:239], v223 offset:51200
buffer_load_dwordx4 v226, s[16:19], s44 offen offset:2048 nt lds
v_mfma_f32_32x32x16_bf16 v[80:95], a[244:247], a[68:71], v[80:95]
ds_read_b64_tr_b16 a[240:241], v220 offset:49408
ds_read_b64_tr_b16 a[242:243], v220 offset:51456
s_waitcnt lgkmcnt(11)
v_mfma_f32_32x32x16_bf16 v[96:111], a[248:251], a[68:71], v[96:111]
ds_read_b64_tr_b16 a[244:245], v221 offset:49408
ds_read_b64_tr_b16 a[246:247], v221 offset:51456
buffer_load_dwordx4 v227, s[16:19], s44 offen offset:3072 nt lds
v_mfma_f32_32x32x16_bf16 v[112:127], a[252:255], a[68:71], v[112:127]
ds_read_b64_tr_b16 a[248:249], v222 offset:49408
ds_read_b64_tr_b16 a[250:251], v222 offset:51456
s_waitcnt vmcnt(4)
s_barrier
s_waitcnt lgkmcnt(10)
v_mfma_f32_32x32x16_bf16 v[0:15], a[224:227], a[72:75], v[0:15]
ds_read_b64_tr_b16 a[252:253], v223 offset:49408
ds_read_b64_tr_b16 a[254:255], v223 offset:51456
s_add_u32 m0, s6, 0
s_nop 0
buffer_load_dwordx4 v212, s[12:15], s41 offen offset:0 lds
v_mfma_f32_32x32x16_bf16 v[16:31], a[228:231], a[72:75], v[16:31]
ds_read_b128 a[76:79], v219 offset:32768
ds_read_b64_tr_b16 a[224:225], v220 offset:57344
ds_read_b64_tr_b16 a[226:227], v220 offset:59392
s_waitcnt lgkmcnt(11)
v_mfma_f32_32x32x16_bf16 v[32:47], a[232:235], a[72:75], v[32:47]
ds_read_b64_tr_b16 a[228:229], v221 offset:57344
ds_read_b64_tr_b16 a[230:231], v221 offset:59392
v_mfma_f32_32x32x16_bf16 v[48:63], a[236:239], a[72:75], v[48:63]
ds_read_b64_tr_b16 a[232:233], v222 offset:57344
ds_read_b64_tr_b16 a[234:235], v222 offset:59392
s_waitcnt lgkmcnt(11)
v_mfma_f32_32x32x16_bf16 v[64:79], a[240:243], a[72:75], v[64:79]
ds_read_b64_tr_b16 a[236:237], v223 offset:57344
ds_read_b64_tr_b16 a[238:239], v223 offset:59392
buffer_load_dwordx4 v213, s[12:15], s41 offen offset:1024 lds
v_mfma_f32_32x32x16_bf16 v[80:95], a[244:247], a[72:75], v[80:95]
ds_read_b64_tr_b16 a[240:241], v220 offset:57600
ds_read_b64_tr_b16 a[242:243], v220 offset:59648
s_waitcnt lgkmcnt(11)
v_mfma_f32_32x32x16_bf16 v[96:111], a[248:251], a[72:75], v[96:111]
ds_read_b64_tr_b16 a[244:245], v221 offset:57600
ds_read_b64_tr_b16 a[246:247], v221 offset:59648
v_mfma_f32_32x32x16_bf16 v[112:127], a[252:255], a[72:75], v[112:127]
ds_read_b64_tr_b16 a[248:249], v222 offset:57600
ds_read_b64_tr_b16 a[250:251], v222 offset:59648
s_waitcnt lgkmcnt(10)
v_mfma_f32_32x32x16_bf16 v[0:15], a[224:227], a[76:79], v[0:15]
ds_read_b64_tr_b16 a[252:253], v223 offset:57600
ds_read_b64_tr_b16 a[254:255], v223 offset:59648
buffer_load_dwordx4 v214, s[12:15], s41 offen offset:2048 lds
v_mfma_f32_32x32x16_bf16 v[16:31], a[228:231], a[76:79], v[16:31]
ds_read_b128 a[64:67], v136 offset:49152
ds_read_b64_tr_b16 a[224:225], v128 offset:16384
ds_read_b64_tr_b16 a[226:227], v128 offset:18432
s_waitcnt lgkmcnt(11)
v_mfma_f32_32x32x16_bf16 v[32:47], a[232:235], a[76:79], v[32:47]
ds_read_b64_tr_b16 a[228:229], v129 offset:16384
ds_read_b64_tr_b16 a[230:231], v129 offset:18432
v_mfma_f32_32x32x16_bf16 v[48:63], a[236:239], a[76:79], v[48:63]
ds_read_b64_tr_b16 a[232:233], v130 offset:16384
ds_read_b64_tr_b16 a[234:235], v130 offset:18432
s_waitcnt lgkmcnt(11)
v_mfma_f32_32x32x16_bf16 v[64:79], a[240:243], a[76:79], v[64:79]
ds_read_b64_tr_b16 a[236:237], v131 offset:16384
ds_read_b64_tr_b16 a[238:239], v131 offset:18432
buffer_load_dwordx4 v215, s[12:15], s41 offen offset:3072 lds
s_add_u32 s41, s41, 262144
s_cmp_eq_u32 s41, 3670016
s_cselect_b32 s41, 524288, s41
v_mfma_f32_32x32x16_bf16 v[80:95], a[244:247], a[76:79], v[80:95]
ds_read_b64_tr_b16 a[240:241], v128 offset:16640
ds_read_b64_tr_b16 a[242:243], v128 offset:18688
s_waitcnt lgkmcnt(11)
v_mfma_f32_32x32x16_bf16 v[96:111], a[248:251], a[76:79], v[96:111]
ds_read_b64_tr_b16 a[244:245], v129 offset:16640
ds_read_b64_tr_b16 a[246:247], v129 offset:18688
v_mfma_f32_32x32x16_bf16 v[112:127], a[252:255], a[76:79], v[112:127]
ds_read_b64_tr_b16 a[248:249], v130 offset:16640
ds_read_b64_tr_b16 a[250:251], v130 offset:18688
s_waitcnt vmcnt(0)
s_barrier
s_waitcnt lgkmcnt(10)
v_mfma_f32_32x32x16_bf16 v[0:15], a[224:227], a[64:67], v[0:15]
ds_read_b64_tr_b16 a[252:253], v131 offset:16640
ds_read_b64_tr_b16 a[254:255], v131 offset:18688
s_add_u32 m0, s6, 32768
s_mov_b32 s44, 81920
buffer_load_dwordx4 v224, s[16:19], s44 offen offset:0 nt lds
v_mfma_f32_32x32x16_bf16 v[16:31], a[228:231], a[64:67], v[16:31]
ds_read_b128 a[68:71], v137 offset:49152
ds_read_b64_tr_b16 a[224:225], v128 offset:24576
ds_read_b64_tr_b16 a[226:227], v128 offset:26624
s_waitcnt lgkmcnt(11)
v_mfma_f32_32x32x16_bf16 v[32:47], a[232:235], a[64:67], v[32:47]
ds_read_b64_tr_b16 a[228:229], v129 offset:24576
ds_read_b64_tr_b16 a[230:231], v129 offset:26624
buffer_load_dwordx4 v225, s[16:19], s44 offen offset:1024 nt lds
v_mfma_f32_32x32x16_bf16 v[48:63], a[236:239], a[64:67], v[48:63]
ds_read_b64_tr_b16 a[232:233], v130 offset:24576
ds_read_b64_tr_b16 a[234:235], v130 offset:26624
s_waitcnt lgkmcnt(11)
v_mfma_f32_32x32x16_bf16 v[64:79], a[240:243], a[64:67], v[64:79]
ds_read_b64_tr_b16 a[236:237], v131 offset:24576
ds_read_b64_tr_b16 a[238:239], v131 offset:26624
buffer_load_dwordx4 v226, s[16:19], s44 offen offset:2048 nt lds
v_mfma_f32_32x32x16_bf16 v[80:95], a[244:247], a[64:67], v[80:95]
ds_read_b64_tr_b16 a[240:241], v128 offset:24832
ds_read_b64_tr_b16 a[242:243], v128 offset:26880
s_waitcnt lgkmcnt(11)
v_mfma_f32_32x32x16_bf16 v[96:111], a[248:251], a[64:67], v[96:111]
ds_read_b64_tr_b16 a[244:245], v129 offset:24832
ds_read_b64_tr_b16 a[246:247], v129 offset:26880
buffer_load_dwordx4 v227, s[16:19], s44 offen offset:3072 nt lds
v_mfma_f32_32x32x16_bf16 v[112:127], a[252:255], a[64:67], v[112:127]
ds_read_b64_tr_b16 a[248:249], v130 offset:24832
ds_read_b64_tr_b16 a[250:251], v130 offset:26880
s_waitcnt lgkmcnt(10)
v_mfma_f32_32x32x16_bf16 v[0:15], a[224:227], a[68:71], v[0:15]
ds_read_b64_tr_b16 a[252:253], v131 offset:24832
ds_read_b64_tr_b16 a[254:255], v131 offset:26880
s_add_u32 m0, s6, 49152
s_mov_b32 s44, 98304
buffer_load_dwordx4 v224, s[16:19], s44 offen offset:0 nt lds
v_mfma_f32_32x32x16_bf16 v[16:31], a[228:231], a[68:71], v[16:31]
ds_read_b128 a[72:75], v138 offset:49152
ds_read_b64_tr_b16 a[224:225], v220 offset:0
ds_read_b64_tr_b16 a[226:227], v220 offset:2048
s_waitcnt lgkmcnt(11)
v_mfma_f32_32x32x16_bf16 v[32:47], a[232:235], a[68:71], v[32:47]
ds_read_b128 a[76:79], v139 offset:49152
ds_read_b64_tr_b16 a[228:229], v220 offset:8192
ds_read_b64_tr_b16 a[230:231], v220 offset:10240
buffer_load_dwordx4 v225, s[16:19], s44 offen offset:1024 nt lds
v_mfma_f32_32x32x16_bf16 v[48:63], a[236:239], a[68:71], v[48:63]
ds_read_b64_tr_b16 a[232:233], v221 offset:0
s_waitcnt lgkmcnt(14)
ds_read_b64_tr_b16 a[234:235], v221 offset:2048
s_waitcnt lgkmcnt(12)
v_mfma_f32_32x32x16_bf16 v[64:79], a[240:243], a[68:71], v[64:79]
ds_read_b64_tr_b16 a[236:237], v221 offset:8192
ds_read_b64_tr_b16 a[238:239], v221 offset:10240
buffer_load_dwordx4 v226, s[16:19], s44 offen offset:2048 nt lds
v_mfma_f32_32x32x16_bf16 v[80:95], a[244:247], a[68:71], v[80:95]
ds_read_b64_tr_b16 a[240:241], v222 offset:0
s_waitcnt lgkmcnt(14)
ds_read_b64_tr_b16 a[242:243], v222 offset:2048
s_waitcnt lgkmcnt(12)
v_mfma_f32_32x32x16_bf16 v[96:111], a[248:251], a[68:71], v[96:111]
ds_read_b64_tr_b16 a[244:245], v222 offset:8192
ds_read_b64_tr_b16 a[246:247], v222 offset:10240
buffer_load_dwordx4 v227, s[16:19], s44 offen offset:3072 nt lds
v_mfma_f32_32x32x16_bf16 v[112:127], a[252:255], a[68:71], v[112:127]
ds_read_b64_tr_b16 a[248:249], v223 offset:0
s_waitcnt lgkmcnt(14)
ds_read_b64_tr_b16 a[250:251], v223 offset:2048
s_barrier
s_waitcnt lgkmcnt(10)
v_mfma_f32_32x32x16_bf16 v[0:15], a[224:227], a[72:75], v[0:15]
ds_read_b64_tr_b16 a[252:253], v223 offset:8192
ds_read_b64_tr_b16 a[254:255], v223 offset:10240
s_add_u32 m0, s6, 81920
s_mov_b32 s44, 114688
buffer_load_dwordx4 v224, s[16:19], s44 offen offset:0 nt lds
v_mfma_f32_32x32x16_bf16 v[0:15], a[228:231], a[76:79], v[0:15]
ds_read_b64_tr_b16 a[224:225], v220 offset:256
ds_read_b64_tr_b16 a[226:227], v220 offset:2304
s_waitcnt lgkmcnt(10)
v_mfma_f32_32x32x16_bf16 v[16:31], a[232:235], a[72:75], v[16:31]
ds_read_b64_tr_b16 a[228:229], v220 offset:8448
ds_read_b64_tr_b16 a[230:231], v220 offset:10496
v_mfma_f32_32x32x16_bf16 v[16:31], a[236:239], a[76:79], v[16:31]
ds_read_b64_tr_b16 a[232:233], v221 offset:256
ds_read_b64_tr_b16 a[234:235], v221 offset:2304
s_waitcnt lgkmcnt(10)
v_mfma_f32_32x32x16_bf16 v[32:47], a[240:243], a[72:75], v[32:47]
ds_read_b64_tr_b16 a[236:237], v221 offset:8448
ds_read_b64_tr_b16 a[238:239], v221 offset:10496
buffer_load_dwordx4 v225, s[16:19], s44 offen offset:1024 nt lds
v_mfma_f32_32x32x16_bf16 v[32:47], a[244:247], a[76:79], v[32:47]
ds_read_b64_tr_b16 a[240:241], v222 offset:256
ds_read_b64_tr_b16 a[242:243], v222 offset:2304
v_pk_mul_f32 v[0:1], v[0:1], s[60:61]
v_pk_mul_f32 v[2:3], v[2:3], s[60:61]
v_pk_mul_f32 v[4:5], v[4:5], s[60:61]
v_pk_mul_f32 v[6:7], v[6:7], s[60:61]
v_pk_mul_f32 v[8:9], v[8:9], s[60:61]
v_pk_mul_f32 v[10:11], v[10:11], s[60:61]
v_pk_mul_f32 v[12:13], v[12:13], s[60:61]
v_pk_mul_f32 v[14:15], v[14:15], s[60:61]
v_cvt_pk_bf16_f32 v192, v0, v1
v_cvt_pk_bf16_f32 v193, v2, v3
v_cvt_pk_bf16_f32 v194, v4, v5
v_cvt_pk_bf16_f32 v195, v6, v7
v_cvt_pk_bf16_f32 v196, v8, v9
v_cvt_pk_bf16_f32 v197, v10, v11
v_cvt_pk_bf16_f32 v198, v12, v13
v_cvt_pk_bf16_f32 v199, v14, v15
v_accvgpr_write_b32 a0, v192
v_accvgpr_write_b32 a1, v193
v_accvgpr_write_b32 a2, v194
v_accvgpr_write_b32 a3, v195
v_accvgpr_write_b32 a4, v196
v_accvgpr_write_b32 a5, v197
v_accvgpr_write_b32 a6, v198
v_accvgpr_write_b32 a7, v199
s_waitcnt lgkmcnt(10)
v_mfma_f32_32x32x16_bf16 v[48:63], a[248:251], a[72:75], v[48:63]
ds_read_b64_tr_b16 a[244:245], v222 offset:8448
ds_read_b64_tr_b16 a[246:247], v222 offset:10496
v_mfma_f32_32x32x16_bf16 v[48:63], a[252:255], a[76:79], v[48:63]
ds_read_b64_tr_b16 a[248:249], v223 offset:256
ds_read_b64_tr_b16 a[250:251], v223 offset:2304
v_pk_mul_f32 v[16:17], v[16:17], s[60:61]
v_pk_mul_f32 v[18:19], v[18:19], s[60:61]
v_pk_mul_f32 v[20:21], v[20:21], s[60:61]
v_pk_mul_f32 v[22:23], v[22:23], s[60:61]
v_pk_mul_f32 v[24:25], v[24:25], s[60:61]
v_pk_mul_f32 v[26:27], v[26:27], s[60:61]
v_pk_mul_f32 v[28:29], v[28:29], s[60:61]
v_pk_mul_f32 v[30:31], v[30:31], s[60:61]
v_cvt_pk_bf16_f32 v200, v16, v17
v_cvt_pk_bf16_f32 v201, v18, v19
v_cvt_pk_bf16_f32 v202, v20, v21
v_cvt_pk_bf16_f32 v203, v22, v23
v_cvt_pk_bf16_f32 v204, v24, v25
v_cvt_pk_bf16_f32 v205, v26, v27
v_cvt_pk_bf16_f32 v206, v28, v29
v_cvt_pk_bf16_f32 v207, v30, v31
v_accvgpr_write_b32 a8, v200
v_accvgpr_write_b32 a9, v201
v_accvgpr_write_b32 a10, v202
v_accvgpr_write_b32 a11, v203
v_accvgpr_write_b32 a12, v204
v_accvgpr_write_b32 a13, v205
v_accvgpr_write_b32 a14, v206
v_accvgpr_write_b32 a15, v207
s_waitcnt lgkmcnt(10)
v_mfma_f32_32x32x16_bf16 v[64:79], a[224:227], a[72:75], v[64:79]
ds_read_b64_tr_b16 a[252:253], v223 offset:8448
ds_read_b64_tr_b16 a[254:255], v223 offset:10496
buffer_load_dwordx4 v226, s[16:19], s44 offen offset:2048 nt lds
v_mfma_f32_32x32x16_bf16 v[64:79], a[228:231], a[76:79], v[64:79]
ds_read_b128 a[224:227], v160 offset:32768
v_pk_mul_f32 v[32:33], v[32:33], s[60:61]
v_pk_mul_f32 v[34:35], v[34:35], s[60:61]
v_pk_mul_f32 v[36:37], v[36:37], s[60:61]
v_pk_mul_f32 v[38:39], v[38:39], s[60:61]
v_pk_mul_f32 v[40:41], v[40:41], s[60:61]
v_pk_mul_f32 v[42:43], v[42:43], s[60:61]
v_pk_mul_f32 v[44:45], v[44:45], s[60:61]
v_pk_mul_f32 v[46:47], v[46:47], s[60:61]
v_cvt_pk_bf16_f32 v192, v32, v33
v_cvt_pk_bf16_f32 v193, v34, v35
v_cvt_pk_bf16_f32 v194, v36, v37
v_cvt_pk_bf16_f32 v195, v38, v39
v_cvt_pk_bf16_f32 v196, v40, v41
v_cvt_pk_bf16_f32 v197, v42, v43
v_cvt_pk_bf16_f32 v198, v44, v45
v_cvt_pk_bf16_f32 v199, v46, v47
v_accvgpr_write_b32 a16, v192
v_accvgpr_write_b32 a17, v193
v_accvgpr_write_b32 a18, v194
v_accvgpr_write_b32 a19, v195
v_accvgpr_write_b32 a20, v196
v_accvgpr_write_b32 a21, v197
v_accvgpr_write_b32 a22, v198
v_accvgpr_write_b32 a23, v199
s_waitcnt lgkmcnt(9)
v_mfma_f32_32x32x16_bf16 v[80:95], a[232:235], a[72:75], v[80:95]
ds_read_b128 a[228:231], v161 offset:32768
v_mfma_f32_32x32x16_bf16 v[80:95], a[236:239], a[76:79], v[80:95]
ds_read_b128 a[232:235], v162 offset:32768
v_pk_mul_f32 v[48:49], v[48:49], s[60:61]
v_pk_mul_f32 v[50:51], v[50:51], s[60:61]
v_pk_mul_f32 v[52:53], v[52:53], s[60:61]
v_pk_mul_f32 v[54:55], v[54:55], s[60:61]
v_pk_mul_f32 v[56:57], v[56:57], s[60:61]
v_pk_mul_f32 v[58:59], v[58:59], s[60:61]
v_pk_mul_f32 v[60:61], v[60:61], s[60:61]
v_pk_mul_f32 v[62:63], v[62:63], s[60:61]
v_cvt_pk_bf16_f32 v200, v48, v49
v_cvt_pk_bf16_f32 v201, v50, v51
v_cvt_pk_bf16_f32 v202, v52, v53
v_cvt_pk_bf16_f32 v203, v54, v55
v_cvt_pk_bf16_f32 v204, v56, v57
v_cvt_pk_bf16_f32 v205, v58, v59
v_cvt_pk_bf16_f32 v206, v60, v61
v_cvt_pk_bf16_f32 v207, v62, v63
v_accvgpr_write_b32 a24, v200
v_accvgpr_write_b32 a25, v201
v_accvgpr_write_b32 a26, v202
v_accvgpr_write_b32 a27, v203
v_accvgpr_write_b32 a28, v204
v_accvgpr_write_b32 a29, v205
v_accvgpr_write_b32 a30, v206
v_accvgpr_write_b32 a31, v207
s_waitcnt lgkmcnt(7)
v_mfma_f32_32x32x16_bf16 v[96:111], a[240:243], a[72:75], v[96:111]
ds_read_b128 a[236:239], v163 offset:32768
buffer_load_dwordx4 v227, s[16:19], s44 offen offset:3072 nt lds
v_mfma_f32_32x32x16_bf16 v[96:111], a[244:247], a[76:79], v[96:111]
ds_read_b128 a[240:243], v164 offset:32768
v_pk_mul_f32 v[64:65], v[64:65], s[60:61]
v_pk_mul_f32 v[66:67], v[66:67], s[60:61]
v_pk_mul_f32 v[68:69], v[68:69], s[60:61]
v_pk_mul_f32 v[70:71], v[70:71], s[60:61]
v_pk_mul_f32 v[72:73], v[72:73], s[60:61]
v_pk_mul_f32 v[74:75], v[74:75], s[60:61]
v_pk_mul_f32 v[76:77], v[76:77], s[60:61]
v_pk_mul_f32 v[78:79], v[78:79], s[60:61]
v_cvt_pk_bf16_f32 v192, v64, v65
v_cvt_pk_bf16_f32 v193, v66, v67
v_cvt_pk_bf16_f32 v194, v68, v69
v_cvt_pk_bf16_f32 v195, v70, v71
v_cvt_pk_bf16_f32 v196, v72, v73
v_cvt_pk_bf16_f32 v197, v74, v75
v_cvt_pk_bf16_f32 v198, v76, v77
v_cvt_pk_bf16_f32 v199, v78, v79
v_accvgpr_write_b32 a32, v192
v_accvgpr_write_b32 a33, v193
v_accvgpr_write_b32 a34, v194
v_accvgpr_write_b32 a35, v195
v_accvgpr_write_b32 a36, v196
v_accvgpr_write_b32 a37, v197
v_accvgpr_write_b32 a38, v198
v_accvgpr_write_b32 a39, v199
s_waitcnt lgkmcnt(5)
v_mfma_f32_32x32x16_bf16 v[112:127], a[248:251], a[72:75], v[112:127]
ds_read_b128 a[244:247], v165 offset:32768
v_mfma_f32_32x32x16_bf16 v[112:127], a[252:255], a[76:79], v[112:127]
ds_read_b128 a[248:251], v166 offset:32768
v_pk_mul_f32 v[80:81], v[80:81], s[60:61]
v_pk_mul_f32 v[82:83], v[82:83], s[60:61]
v_pk_mul_f32 v[84:85], v[84:85], s[60:61]
v_pk_mul_f32 v[86:87], v[86:87], s[60:61]
v_pk_mul_f32 v[88:89], v[88:89], s[60:61]
v_pk_mul_f32 v[90:91], v[90:91], s[60:61]
v_pk_mul_f32 v[92:93], v[92:93], s[60:61]
v_pk_mul_f32 v[94:95], v[94:95], s[60:61]
v_cvt_pk_bf16_f32 v200, v80, v81
v_cvt_pk_bf16_f32 v201, v82, v83
v_cvt_pk_bf16_f32 v202, v84, v85
v_cvt_pk_bf16_f32 v203, v86, v87
v_cvt_pk_bf16_f32 v204, v88, v89
v_cvt_pk_bf16_f32 v205, v90, v91
v_cvt_pk_bf16_f32 v206, v92, v93
v_cvt_pk_bf16_f32 v207, v94, v95
v_accvgpr_write_b32 a40, v200
v_accvgpr_write_b32 a41, v201
v_accvgpr_write_b32 a42, v202
v_accvgpr_write_b32 a43, v203
v_accvgpr_write_b32 a44, v204
v_accvgpr_write_b32 a45, v205
v_accvgpr_write_b32 a46, v206
v_accvgpr_write_b32 a47, v207
s_nop 7
s_nop 3
v_pk_mul_f32 v[96:97], v[96:97], s[60:61]
v_pk_mul_f32 v[98:99], v[98:99], s[60:61]
v_pk_mul_f32 v[100:101], v[100:101], s[60:61]
v_pk_mul_f32 v[102:103], v[102:103], s[60:61]
v_pk_mul_f32 v[104:105], v[104:105], s[60:61]
v_pk_mul_f32 v[106:107], v[106:107], s[60:61]
v_pk_mul_f32 v[108:109], v[108:109], s[60:61]
v_pk_mul_f32 v[110:111], v[110:111], s[60:61]
v_cvt_pk_bf16_f32 v192, v96, v97
v_cvt_pk_bf16_f32 v193, v98, v99
v_cvt_pk_bf16_f32 v194, v100, v101
v_cvt_pk_bf16_f32 v195, v102, v103
v_cvt_pk_bf16_f32 v196, v104, v105
v_cvt_pk_bf16_f32 v197, v106, v107
v_cvt_pk_bf16_f32 v198, v108, v109
v_cvt_pk_bf16_f32 v199, v110, v111
v_accvgpr_write_b32 a48, v192
v_accvgpr_write_b32 a49, v193
v_accvgpr_write_b32 a50, v194
v_accvgpr_write_b32 a51, v195
v_accvgpr_write_b32 a52, v196
v_accvgpr_write_b32 a53, v197
v_accvgpr_write_b32 a54, v198
v_accvgpr_write_b32 a55, v199
v_pk_mul_f32 v[112:113], v[112:113], s[60:61]
v_pk_mul_f32 v[114:115], v[114:115], s[60:61]
v_pk_mul_f32 v[116:117], v[116:117], s[60:61]
v_pk_mul_f32 v[118:119], v[118:119], s[60:61]
v_pk_mul_f32 v[120:121], v[120:121], s[60:61]
v_pk_mul_f32 v[122:123], v[122:123], s[60:61]
v_pk_mul_f32 v[124:125], v[124:125], s[60:61]
v_pk_mul_f32 v[126:127], v[126:127], s[60:61]
v_cvt_pk_bf16_f32 v200, v112, v113
v_cvt_pk_bf16_f32 v201, v114, v115
v_cvt_pk_bf16_f32 v202, v116, v117
v_cvt_pk_bf16_f32 v203, v118, v119
v_cvt_pk_bf16_f32 v204, v120, v121
v_cvt_pk_bf16_f32 v205, v122, v123
v_cvt_pk_bf16_f32 v206, v124, v125
v_cvt_pk_bf16_f32 v207, v126, v127
v_accvgpr_write_b32 a56, v200
v_accvgpr_write_b32 a57, v201
v_accvgpr_write_b32 a58, v202
v_accvgpr_write_b32 a59, v203
v_accvgpr_write_b32 a60, v204
v_accvgpr_write_b32 a61, v205
v_accvgpr_write_b32 a62, v206
v_accvgpr_write_b32 a63, v207
s_nop 1
s_barrier
s_waitcnt lgkmcnt(5)
v_mfma_f32_32x32x16_bf16 v[128:143], a[224:227], a[0:3], 0
ds_read_b128 a[252:255], v167 offset:32768
s_add_u32 m0, s6, 114688
s_mov_b32 s44, 131072
buffer_load_dwordx4 v224, s[16:19], s44 offen offset:0 nt lds
v_mfma_f32_32x32x16_bf16 v[128:143], a[228:231], a[4:7], v[128:143]
ds_read_b128 a[224:227], v160 offset:33024
s_waitcnt lgkmcnt(5)
v_mfma_f32_32x32x16_bf16 v[128:143], a[232:235], a[8:11], v[128:143]
ds_read_b128 a[228:231], v161 offset:33024
buffer_load_dwordx4 v225, s[16:19], s44 offen offset:1024 nt lds
v_mfma_f32_32x32x16_bf16 v[128:143], a[236:239], a[12:15], v[128:143]
ds_read_b128 a[232:235], v162 offset:33024
s_waitcnt lgkmcnt(5)
v_mfma_f32_32x32x16_bf16 v[128:143], a[240:243], a[16:19], v[128:143]
ds_read_b128 a[236:239], v163 offset:33024
buffer_load_dwordx4 v226, s[16:19], s44 offen offset:2048 nt lds
v_mfma_f32_32x32x16_bf16 v[128:143], a[244:247], a[20:23], v[128:143]
ds_read_b128 a[240:243], v164 offset:33024
s_waitcnt lgkmcnt(5)
v_mfma_f32_32x32x16_bf16 v[128:143], a[248:251], a[24:27], v[128:143]
ds_read_b128 a[244:247], v165 offset:33024
buffer_load_dwordx4 v227, s[16:19], s44 offen offset:3072 nt lds
v_mfma_f32_32x32x16_bf16 v[128:143], a[252:255], a[28:31], v[128:143]
ds_read_b128 a[248:251], v166 offset:33024
s_waitcnt lgkmcnt(5)
v_mfma_f32_32x32x16_bf16 v[128:143], a[224:227], a[32:35], v[128:143]
ds_read_b128 a[252:255], v167 offset:33024
s_add_u32 m0, s6, 0
s_mov_b32 s44, 147456
buffer_load_dwordx4 v224, s[16:19], s44 offen offset:0 nt lds
v_mfma_f32_32x32x16_bf16 v[128:143], a[228:231], a[36:39], v[128:143]
ds_read_b128 a[224:227], v236 offset:16384
s_waitcnt lgkmcnt(5)
v_mfma_f32_32x32x16_bf16 v[128:143], a[232:235], a[40:43], v[128:143]
ds_read_b128 a[228:231], v237 offset:16384
buffer_load_dwordx4 v225, s[16:19], s44 offen offset:1024 nt lds
v_mfma_f32_32x32x16_bf16 v[128:143], a[236:239], a[44:47], v[128:143]
ds_read_b128 a[232:235], v238 offset:16384
s_waitcnt lgkmcnt(5)
v_mfma_f32_32x32x16_bf16 v[128:143], a[240:243], a[48:51], v[128:143]
ds_read_b128 a[236:239], v239 offset:16384
buffer_load_dwordx4 v226, s[16:19], s44 offen offset:2048 nt lds
v_mfma_f32_32x32x16_bf16 v[128:143], a[244:247], a[52:55], v[128:143]
ds_read_b128 a[240:243], v240 offset:16384
s_waitcnt lgkmcnt(5)
v_mfma_f32_32x32x16_bf16 v[128:143], a[248:251], a[56:59], v[128:143]
ds_read_b128 a[244:247], v241 offset:16384
buffer_load_dwordx4 v227, s[16:19], s44 offen offset:3072 nt lds
v_mfma_f32_32x32x16_bf16 v[128:143], a[252:255], a[60:63], v[128:143]
ds_read_b128 a[248:251], v242 offset:16384
s_barrier
s_waitcnt lgkmcnt(5)
v_mfma_f32_32x32x16_bf16 v[144:159], a[224:227], a[0:3], 0
ds_read_b128 a[252:255], v243 offset:16384
s_add_u32 m0, s6, 98304
s_mov_b32 s44, 163840
buffer_load_dwordx4 v224, s[16:19], s44 offen offset:0 nt lds
v_mfma_f32_32x32x16_bf16 v[144:159], a[228:231], a[4:7], v[144:159]
ds_read_b128 a[224:227], v236 offset:16640
s_waitcnt lgkmcnt(5)
v_mfma_f32_32x32x16_bf16 v[144:159], a[232:235], a[8:11], v[144:159]
ds_read_b128 a[228:231], v237 offset:16640
v_max3_f32 v253, v128, v129, v130
v_max3_f32 v253, v253, v131, v132
v_max3_f32 v253, v253, v133, v134
v_max3_f32 v253, v253, v135, v136
v_max3_f32 v253, v253, v137, v138
v_max3_f32 v253, v253, v139, v140
v_max3_f32 v253, v253, v141, v142
v_max_f32 v253, v253, v143
v_mfma_f32_32x32x16_bf16 v[144:159], a[236:239], a[12:15], v[144:159]
ds_read_b128 a[232:235], v238 offset:16640
v_mov_b32 v254, v253
s_nop 1
v_permlane32_swap_b32 v253, v254
v_max_f32 v253, v253, v254
v_ceil_f32 v253, v253
v_sub_f32 v249, 0, v253
v_mov_b32 v254, 0xf149f2ca
s_waitcnt lgkmcnt(5)
v_mfma_f32_32x32x16_bf16 v[144:159], a[240:243], a[16:19], v[144:159]
ds_read_b128 a[236:239], v239 offset:16640
buffer_load_dwordx4 v225, s[16:19], s44 offen offset:1024 nt lds
v_cndmask_b32_e64 v249, v254, v249, s[62:63]
v_mov_b32 v248, 0
v_mov_b32 v208, v249
v_mov_b32 v209, v249
v_mov_b32 v210, v249
v_mov_b32 v211, v249
v_mov_b32 v212, v249
v_mov_b32 v213, v249
v_mfma_f32_32x32x16_bf16 v[144:159], a[244:247], a[20:23], v[144:159]
ds_read_b128 a[240:243], v240 offset:16640
v_mov_b32 v214, v249
v_mov_b32 v215, v249
v_mov_b32 v216, v249
v_mov_b32 v217, v249
v_mov_b32 v218, v249
v_mov_b32 v219, v249
v_mov_b32 v220, v249
s_waitcnt lgkmcnt(5)
v_mfma_f32_32x32x16_bf16 v[144:159], a[248:251], a[24:27], v[144:159]
ds_read_b128 a[244:247], v241 offset:16640
v_mov_b32 v221, v249
v_mov_b32 v222, v249
v_mov_b32 v223, v249
v_add_f32 v128, v128, v249
v_add_f32 v129, v129, v249
v_add_f32 v130, v130, v249
v_add_f32 v131, v131, v249
v_add_f32 v132, v132, v249
v_mfma_f32_32x32x16_bf16 v[144:159], a[252:255], a[28:31], v[144:159]
ds_read_b128 a[248:251], v242 offset:16640
v_add_f32 v133, v133, v249
v_add_f32 v134, v134, v249
v_add_f32 v135, v135, v249
v_add_f32 v136, v136, v249
v_add_f32 v137, v137, v249
v_add_f32 v138, v138, v249
v_add_f32 v139, v139, v249
s_waitcnt lgkmcnt(5)
v_mfma_f32_32x32x16_bf16 v[144:159], a[224:227], a[32:35], v[144:159]
ds_read_b128 a[252:255], v243 offset:16640
buffer_load_dwordx4 v226, s[16:19], s44 offen offset:2048 nt lds
v_add_f32 v140, v140, v249
v_add_f32 v141, v141, v249
v_add_f32 v142, v142, v249
v_add_f32 v143, v143, v249
v_exp_f32 v192, v128
v_exp_f32 v193, v129
v_mfma_f32_32x32x16_bf16 v[144:159], a[228:231], a[36:39], v[144:159]
ds_read_b128 a[224:227], v160 offset:0
v_exp_f32 v194, v130
v_exp_f32 v195, v131
v_add_f32 v251, v192, v193
v_cvt_pk_bf16_f32 v0, v192, v193
v_exp_f32 v196, v132
s_waitcnt lgkmcnt(5)
v_mfma_f32_32x32x16_bf16 v[144:159], a[232:235], a[40:43], v[144:159]
ds_read_b128 a[228:231], v161 offset:0
v_exp_f32 v197, v133
v_add_f32 v252, v194, v195
v_cvt_pk_bf16_f32 v1, v194, v195
v_exp_f32 v198, v134
v_exp_f32 v199, v135
v_mfma_f32_32x32x16_bf16 v[144:159], a[236:239], a[44:47], v[144:159]
ds_read_b128 a[232:235], v162 offset:0
v_add_f32 v251, v251, v196
v_add_f32 v252, v252, v197
v_cvt_pk_bf16_f32 v2, v196, v197
v_exp_f32 v200, v136
v_exp_f32 v201, v137
s_waitcnt lgkmcnt(5)
v_mfma_f32_32x32x16_bf16 v[144:159], a[240:243], a[48:51], v[144:159]
ds_read_b128 a[236:239], v163 offset:0
buffer_load_dwordx4 v227, s[16:19], s44 offen offset:3072 nt lds
v_add_f32 v251, v251, v198
v_add_f32 v252, v252, v199
v_cvt_pk_bf16_f32 v3, v198, v199
v_exp_f32 v202, v138
v_exp_f32 v203, v139
v_mfma_f32_32x32x16_bf16 v[144:159], a[244:247], a[52:55], v[144:159]
ds_read_b128 a[240:243], v164 offset:0
v_add_f32 v251, v251, v200
v_add_f32 v252, v252, v201
v_cvt_pk_bf16_f32 v4, v200, v201
v_exp_f32 v204, v140
v_exp_f32 v205, v141
s_waitcnt lgkmcnt(5)
v_mfma_f32_32x32x16_bf16 v[144:159], a[248:251], a[56:59], v[144:159]
ds_read_b128 a[244:247], v165 offset:0
v_add_f32 v251, v251, v202
v_add_f32 v252, v252, v203
v_cvt_pk_bf16_f32 v5, v202, v203
v_exp_f32 v206, v142
v_exp_f32 v207, v143
v_add_f32 v251, v251, v204
v_mfma_f32_32x32x16_bf16 v[144:159], a[252:255], a[60:63], v[144:159]
ds_read_b128 a[248:251], v166 offset:0
v_add_f32 v252, v252, v205
v_cvt_pk_bf16_f32 v6, v204, v205
v_add_f32 v251, v251, v252
v_add_f32 v252, v206, v207
v_cvt_pk_bf16_f32 v7, v206, v207
v_add_f32 v251, v251, v252
v_add_f32 v248, v248, v251
s_barrier
s_waitcnt lgkmcnt(5)
v_mfma_f32_32x32x16_bf16 v[128:143], a[224:227], a[0:3], v[208:223]
ds_read_b128 a[252:255], v167 offset:0
s_add_u32 m0, s6, 16384
s_mov_b32 s44, 180224
buffer_load_dwordx4 v224, s[16:19], s44 offen offset:0 nt lds
v_mfma_f32_32x32x16_bf16 v[128:143], a[228:231], a[4:7], v[128:143]
ds_read_b128 a[224:227], v160 offset:256
s_waitcnt lgkmcnt(5)
v_mfma_f32_32x32x16_bf16 v[128:143], a[232:235], a[8:11], v[128:143]
ds_read_b128 a[228:231], v161 offset:256
v_add_f32 v144, v144, v249
v_add_f32 v145, v145, v249
v_add_f32 v146, v146, v249
v_add_f32 v147, v147, v249
v_add_f32 v148, v148, v249
v_mfma_f32_32x32x16_bf16 v[128:143], a[236:239], a[12:15], v[128:143]
ds_read_b128 a[232:235], v162 offset:256
v_add_f32 v149, v149, v249
v_add_f32 v150, v150, v249
v_add_f32 v151, v151, v249
v_add_f32 v152, v152, v249
v_add_f32 v153, v153, v249
s_waitcnt lgkmcnt(5)
v_mfma_f32_32x32x16_bf16 v[128:143], a[240:243], a[16:19], v[128:143]
ds_read_b128 a[236:239], v163 offset:256
buffer_load_dwordx4 v225, s[16:19], s44 offen offset:1024 nt lds
v_add_f32 v154, v154, v249
v_add_f32 v155, v155, v249
v_add_f32 v156, v156, v249
v_add_f32 v157, v157, v249
v_add_f32 v158, v158, v249
v_mfma_f32_32x32x16_bf16 v[128:143], a[244:247], a[20:23], v[128:143]
ds_read_b128 a[240:243], v164 offset:256
v_add_f32 v159, v159, v249
v_exp_f32 v192, v144
v_exp_f32 v193, v145
s_waitcnt lgkmcnt(5)
v_mfma_f32_32x32x16_bf16 v[128:143], a[248:251], a[24:27], v[128:143]
ds_read_b128 a[244:247], v165 offset:256
v_exp_f32 v194, v146
v_exp_f32 v195, v147
v_add_f32 v251, v192, v193
v_mfma_f32_32x32x16_bf16 v[128:143], a[252:255], a[28:31], v[128:143]
ds_read_b128 a[248:251], v166 offset:256
v_cvt_pk_bf16_f32 v8, v192, v193
v_exp_f32 v196, v148
v_exp_f32 v197, v149
s_waitcnt lgkmcnt(5)
v_mfma_f32_32x32x16_bf16 v[128:143], a[224:227], a[32:35], v[128:143]
ds_read_b128 a[252:255], v167 offset:256
buffer_load_dwordx4 v226, s[16:19], s44 offen offset:2048 nt lds
v_add_f32 v252, v194, v195
v_cvt_pk_bf16_f32 v9, v194, v195
v_exp_f32 v198, v150
v_exp_f32 v199, v151
v_mfma_f32_32x32x16_bf16 v[128:143], a[228:231], a[36:39], v[128:143]
ds_read_b128 a[224:227], v168 offset:16384
v_add_f32 v251, v251, v196
v_add_f32 v252, v252, v197
v_cvt_pk_bf16_f32 v10, v196, v197
v_exp_f32 v200, v152
s_waitcnt lgkmcnt(5)
v_mfma_f32_32x32x16_bf16 v[128:143], a[232:235], a[40:43], v[128:143]
ds_read_b128 a[228:231], v169 offset:16384
v_exp_f32 v201, v153
v_add_f32 v251, v251, v198
v_add_f32 v252, v252, v199
v_cvt_pk_bf16_f32 v11, v198, v199
v_mfma_f32_32x32x16_bf16 v[128:143], a[236:239], a[44:47], v[128:143]
ds_read_b128 a[232:235], v170 offset:16384
v_exp_f32 v202, v154
v_exp_f32 v203, v155
v_add_f32 v251, v251, v200
v_add_f32 v252, v252, v201
s_waitcnt lgkmcnt(5)
v_mfma_f32_32x32x16_bf16 v[128:143], a[240:243], a[48:51], v[128:143]
ds_read_b128 a[236:239], v171 offset:16384
buffer_load_dwordx4 v227, s[16:19], s44 offen offset:3072 nt lds
v_cvt_pk_bf16_f32 v12, v200, v201
v_exp_f32 v204, v156
v_exp_f32 v205, v157
v_add_f32 v251, v251, v202
v_mfma_f32_32x32x16_bf16 v[128:143], a[244:247], a[52:55], v[128:143]
ds_read_b128 a[240:243], v172 offset:16384
v_add_f32 v252, v252, v203
v_cvt_pk_bf16_f32 v13, v202, v203
v_exp_f32 v206, v158
v_exp_f32 v207, v159
s_waitcnt lgkmcnt(5)
v_mfma_f32_32x32x16_bf16 v[128:143], a[248:251], a[56:59], v[128:143]
ds_read_b128 a[244:247], v173 offset:16384
v_add_f32 v251, v251, v204
v_add_f32 v252, v252, v205
v_cvt_pk_bf16_f32 v14, v204, v205
v_add_f32 v251, v251, v252
v_add_f32 v252, v206, v207
v_mfma_f32_32x32x16_bf16 v[128:143], a[252:255], a[60:63], v[128:143]
ds_read_b128 a[248:251], v174 offset:16384
v_cvt_pk_bf16_f32 v15, v206, v207
v_add_f32 v251, v251, v252
v_cmp_ngt_f32 vcc, s47, v251
s_cbranch_vccnz L_rare1
L_back1:
v_add_f32 v248, v248, v251
s_barrier
s_waitcnt lgkmcnt(5)
v_mfma_f32_32x32x16_bf16 v[144:159], a[224:227], a[0:3], v[208:223]
ds_read_b128 a[252:255], v175 offset:16384
s_add_u32 m0, s6, 65536
s_mov_b32 s44, 196608
buffer_load_dwordx4 v224, s[16:19], s44 offen offset:0 nt lds
v_mfma_f32_32x32x16_bf16 v[144:159], a[228:231], a[4:7], v[144:159]
ds_read_b128 a[224:227], v168 offset:16640
s_waitcnt lgkmcnt(5)
v_mfma_f32_32x32x16_bf16 v[144:159], a[232:235], a[8:11], v[144:159]
ds_read_b128 a[228:231], v169 offset:16640
v_exp_f32 v192, v128
v_exp_f32 v193, v129
v_mfma_f32_32x32x16_bf16 v[144:159], a[236:239], a[12:15], v[144:159]
ds_read_b128 a[232:235], v170 offset:16640
v_exp_f32 v194, v130
v_exp_f32 v195, v131
s_waitcnt lgkmcnt(5)
v_mfma_f32_32x32x16_bf16 v[144:159], a[240:243], a[16:19], v[144:159]
ds_read_b128 a[236:239], v171 offset:16640
buffer_load_dwordx4 v225, s[16:19], s44 offen offset:1024 nt lds
v_add_f32 v251, v192, v193
v_cvt_pk_bf16_f32 v16, v192, v193
v_exp_f32 v196, v132
v_mfma_f32_32x32x16_bf16 v[144:159], a[244:247], a[20:23], v[144:159]
ds_read_b128 a[240:243], v172 offset:16640
v_exp_f32 v197, v133
v_add_f32 v252, v194, v195
v_cvt_pk_bf16_f32 v17, v194, v195
s_waitcnt lgkmcnt(5)
v_mfma_f32_32x32x16_bf16 v[144:159], a[248:251], a[24:27], v[144:159]
ds_read_b128 a[244:247], v173 offset:16640
v_exp_f32 v198, v134
v_exp_f32 v199, v135
v_mfma_f32_32x32x16_bf16 v[144:159], a[252:255], a[28:31], v[144:159]
ds_read_b128 a[248:251], v174 offset:16640
v_add_f32 v251, v251, v196
v_add_f32 v252, v252, v197
v_cvt_pk_bf16_f32 v18, v196, v197
v_exp_f32 v200, v136
s_waitcnt lgkmcnt(5)
v_mfma_f32_32x32x16_bf16 v[144:159], a[224:227], a[32:35], v[144:159]
ds_read_b128 a[252:255], v175 offset:16640
buffer_load_dwordx4 v226, s[16:19], s44 offen offset:2048 nt lds
v_exp_f32 v201, v137
v_add_f32 v251, v251, v198
v_add_f32 v252, v252, v199
v_mfma_f32_32x32x16_bf16 v[144:159], a[228:231], a[36:39], v[144:159]
ds_read_b128 a[224:227], v168 offset:0
v_cvt_pk_bf16_f32 v19, v198, v199
v_exp_f32 v202, v138
v_exp_f32 v203, v139
s_waitcnt lgkmcnt(5)
v_mfma_f32_32x32x16_bf16 v[144:159], a[232:235], a[40:43], v[144:159]
ds_read_b128 a[228:231], v169 offset:0
v_add_f32 v251, v251, v200
v_add_f32 v252, v252, v201
v_cvt_pk_bf16_f32 v20, v200, v201
v_exp_f32 v204, v140
v_mfma_f32_32x32x16_bf16 v[144:159], a[236:239], a[44:47], v[144:159]
ds_read_b128 a[232:235], v170 offset:0
v_exp_f32 v205, v141
v_add_f32 v251, v251, v202
v_add_f32 v252, v252, v203
s_waitcnt lgkmcnt(5)
v_mfma_f32_32x32x16_bf16 v[144:159], a[240:243], a[48:51], v[144:159]
ds_read_b128 a[236:239], v171 offset:0
buffer_load_dwordx4 v227, s[16:19], s44 offen offset:3072 nt lds
v_cvt_pk_bf16_f32 v21, v202, v203
v_exp_f32 v206, v142
v_mfma_f32_32x32x16_bf16 v[144:159], a[244:247], a[52:55], v[144:159]
ds_read_b128 a[240:243], v172 offset:0
v_exp_f32 v207, v143
v_add_f32 v251, v251, v204
v_add_f32 v252, v252, v205
s_waitcnt lgkmcnt(5)
v_mfma_f32_32x32x16_bf16 v[144:159], a[248:251], a[56:59], v[144:159]
ds_read_b128 a[244:247], v173 offset:0
v_cvt_pk_bf16_f32 v22, v204, v205
v_add_f32 v251, v251, v252
v_add_f32 v252, v206, v207
v_cvt_pk_bf16_f32 v23, v206, v207
v_mfma_f32_32x32x16_bf16 v[144:159], a[252:255], a[60:63], v[144:159]
ds_read_b128 a[248:251], v174 offset:0
v_add_f32 v251, v251, v252
v_cmp_ngt_f32 vcc, s47, v251
s_cbranch_vccnz L_rare2
L_back2:
v_add_f32 v248, v248, v251
s_waitcnt vmcnt(28)
s_barrier
s_waitcnt lgkmcnt(5)
v_mfma_f32_32x32x16_bf16 v[128:143], a[224:227], a[0:3], v[208:223]
ds_read_b128 a[252:255], v175 offset:0
s_add_u32 m0, s6, 147456
s_mov_b32 s44, 212992
buffer_load_dwordx4 v224, s[16:19], s44 offen offset:0 nt lds
v_mfma_f32_32x32x16_bf16 v[128:143], a[228:231], a[4:7], v[128:143]
ds_read_b128 a[224:227], v168 offset:256
s_waitcnt lgkmcnt(5)
v_mfma_f32_32x32x16_bf16 v[128:143], a[232:235], a[8:11], v[128:143]
ds_read_b128 a[228:231], v169 offset:256
v_exp_f32 v192, v144
v_exp_f32 v193, v145
v_mfma_f32_32x32x16_bf16 v[128:143], a[236:239], a[12:15], v[128:143]
ds_read_b128 a[232:235], v170 offset:256
v_exp_f32 v194, v146
v_exp_f32 v195, v147
s_waitcnt lgkmcnt(5)
v_mfma_f32_32x32x16_bf16 v[128:143], a[240:243], a[16:19], v[128:143]
ds_read_b128 a[236:239], v171 offset:256
buffer_load_dwordx4 v225, s[16:19], s44 offen offset:1024 nt lds
v_add_f32 v251, v192, v193
v_cvt_pk_bf16_f32 v24, v192, v193
v_exp_f32 v196, v148
v_mfma_f32_32x32x16_bf16 v[128:143], a[244:247], a[20:23], v[128:143]
ds_read_b128 a[240:243], v172 offset:256
v_exp_f32 v197, v149
v_add_f32 v252, v194, v195
v_cvt_pk_bf16_f32 v25, v194, v195
s_waitcnt lgkmcnt(5)
v_mfma_f32_32x32x16_bf16 v[128:143], a[248:251], a[24:27], v[128:143]
ds_read_b128 a[244:247], v173 offset:256
v_exp_f32 v198, v150
v_exp_f32 v199, v151
v_mfma_f32_32x32x16_bf16 v[128:143], a[252:255], a[28:31], v[128:143]
ds_read_b128 a[248:251], v174 offset:256
v_add_f32 v251, v251, v196
v_add_f32 v252, v252, v197
v_cvt_pk_bf16_f32 v26, v196, v197
v_exp_f32 v200, v152
s_waitcnt lgkmcnt(5)
v_mfma_f32_32x32x16_bf16 v[128:143], a[224:227], a[32:35], v[128:143]
ds_read_b128 a[252:255], v175 offset:256
buffer_load_dwordx4 v226, s[16:19], s44 offen offset:2048 nt lds
v_exp_f32 v201, v153
v_add_f32 v251, v251, v198
v_add_f32 v252, v252, v199
v_mfma_f32_32x32x16_bf16 v[128:143], a[228:231], a[36:39], v[128:143]
ds_read_b128 a[224:227], v236 offset:32768
v_cvt_pk_bf16_f32 v27, v198, v199
v_exp_f32 v202, v154
v_exp_f32 v203, v155
s_waitcnt lgkmcnt(5)
v_mfma_f32_32x32x16_bf16 v[128:143], a[232:235], a[40:43], v[128:143]
ds_read_b128 a[228:231], v237 offset:32768
v_add_f32 v251, v251, v200
v_add_f32 v252, v252, v201
v_cvt_pk_bf16_f32 v28, v200, v201
v_exp_f32 v204, v156
v_mfma_f32_32x32x16_bf16 v[128:143], a[236:239], a[44:47], v[128:143]
ds_read_b128 a[232:235], v238 offset:32768
v_exp_f32 v205, v157
v_add_f32 v251, v251, v202
v_add_f32 v252, v252, v203
s_waitcnt lgkmcnt(5)
v_mfma_f32_32x32x16_bf16 v[128:143], a[240:243], a[48:51], v[128:143]
ds_read_b128 a[236:239], v239 offset:32768
buffer_load_dwordx4 v227, s[16:19], s44 offen offset:3072 nt lds
v_cvt_pk_bf16_f32 v29, v202, v203
v_exp_f32 v206, v158
v_mfma_f32_32x32x16_bf16 v[128:143], a[244:247], a[52:55], v[128:143]
ds_read_b128 a[240:243], v240 offset:32768
v_exp_f32 v207, v159
v_add_f32 v251, v251, v204
v_add_f32 v252, v252, v205
s_waitcnt lgkmcnt(5)
v_mfma_f32_32x32x16_bf16 v[128:143], a[248:251], a[56:59], v[128:143]
ds_read_b128 a[244:247], v241 offset:32768
v_cvt_pk_bf16_f32 v30, v204, v205
v_add_f32 v251, v251, v252
v_add_f32 v252, v206, v207
v_cvt_pk_bf16_f32 v31, v206, v207
v_mfma_f32_32x32x16_bf16 v[128:143], a[252:255], a[60:63], v[128:143]
ds_read_b128 a[248:251], v242 offset:32768
v_add_f32 v251, v251, v252
v_cmp_ngt_f32 vcc, s47, v251
s_cbranch_vccnz L_rare3
L_back3:
v_add_f32 v248, v248, v251
s_waitcnt vmcnt(28)
s_barrier
s_waitcnt lgkmcnt(5)
v_mfma_f32_32x32x16_bf16 v[144:159], a[224:227], a[0:3], v[208:223]
ds_read_b128 a[252:255], v243 offset:32768
s_add_u32 m0, s6, 131072
s_mov_b32 s44, 229376
buffer_load_dwordx4 v224, s[16:19], s44 offen offset:0 nt lds
v_mfma_f32_32x32x16_bf16 v[144:159], a[228:231], a[4:7], v[144:159]
ds_read_b128 a[224:227], v236 offset:33024
s_waitcnt lgkmcnt(5)
v_mfma_f32_32x32x16_bf16 v[144:159], a[232:235], a[8:11], v[144:159]
ds_read_b128 a[228:231], v237 offset:33024
v_exp_f32 v192, v128
v_exp_f32 v193, v129
v_mfma_f32_32x32x16_bf16 v[144:159], a[236:239], a[12:15], v[144:159]
ds_read_b128 a[232:235], v238 offset:33024
v_exp_f32 v194, v130
v_exp_f32 v195, v131
s_waitcnt lgkmcnt(5)
v_mfma_f32_32x32x16_bf16 v[144:159], a[240:243], a[16:19], v[144:159]
ds_read_b128 a[236:239], v239 offset:33024
buffer_load_dwordx4 v225, s[16:19], s44 offen offset:1024 nt lds
v_add_f32 v251, v192, v193
v_cvt_pk_bf16_f32 v32, v192, v193
v_exp_f32 v196, v132
v_mfma_f32_32x32x16_bf16 v[144:159], a[244:247], a[20:23], v[144:159]
ds_read_b128 a[240:243], v240 offset:33024
v_exp_f32 v197, v133
v_add_f32 v252, v194, v195
v_cvt_pk_bf16_f32 v33, v194, v195
s_waitcnt lgkmcnt(5)
v_mfma_f32_32x32x16_bf16 v[144:159], a[248:251], a[24:27], v[144:159]
ds_read_b128 a[244:247], v241 offset:33024
v_exp_f32 v198, v134
v_exp_f32 v199, v135
v_mfma_f32_32x32x16_bf16 v[144:159], a[252:255], a[28:31], v[144:159]
ds_read_b128 a[248:251], v242 offset:33024
v_add_f32 v251, v251, v196
v_add_f32 v252, v252, v197
v_cvt_pk_bf16_f32 v34, v196, v197
v_exp_f32 v200, v136
s_waitcnt lgkmcnt(5)
v_mfma_f32_32x32x16_bf16 v[144:159], a[224:227], a[32:35], v[144:159]
ds_read_b128 a[252:255], v243 offset:33024
buffer_load_dwordx4 v226, s[16:19], s44 offen offset:2048 nt lds
v_exp_f32 v201, v137
v_add_f32 v251, v251, v198
v_add_f32 v252, v252, v199
v_mfma_f32_32x32x16_bf16 v[144:159], a[228:231], a[36:39], v[144:159]
ds_read_b128 a[224:227], v236 offset:49152
v_cvt_pk_bf16_f32 v35, v198, v199
v_exp_f32 v202, v138
v_exp_f32 v203, v139
s_waitcnt lgkmcnt(5)
v_mfma_f32_32x32x16_bf16 v[144:159], a[232:235], a[40:43], v[144:159]
ds_read_b128 a[228:231], v237 offset:49152
v_add_f32 v251, v251, v200
v_add_f32 v252, v252, v201
v_cvt_pk_bf16_f32 v36, v200, v201
v_exp_f32 v204, v140
v_mfma_f32_32x32x16_bf16 v[144:159], a[236:239], a[44:47], v[144:159]
ds_read_b128 a[232:235], v238 offset:49152
v_exp_f32 v205, v141
v_add_f32 v251, v251, v202
v_add_f32 v252, v252, v203
s_waitcnt lgkmcnt(5)
v_mfma_f32_32x32x16_bf16 v[144:159], a[240:243], a[48:51], v[144:159]
ds_read_b128 a[236:239], v239 offset:49152
buffer_load_dwordx4 v227, s[16:19], s44 offen offset:3072 nt lds
v_cvt_pk_bf16_f32 v37, v202, v203
v_exp_f32 v206, v142
v_mfma_f32_32x32x16_bf16 v[144:159], a[244:247], a[52:55], v[144:159]
ds_read_b128 a[240:243], v240 offset:49152
v_exp_f32 v207, v143
v_add_f32 v251, v251, v204
v_add_f32 v252, v252, v205
s_waitcnt lgkmcnt(5)
v_mfma_f32_32x32x16_bf16 v[144:159], a[248:251], a[56:59], v[144:159]
ds_read_b128 a[244:247], v241 offset:49152
v_cvt_pk_bf16_f32 v38, v204, v205
v_add_f32 v251, v251, v252
v_add_f32 v252, v206, v207
v_cvt_pk_bf16_f32 v39, v206, v207
v_mfma_f32_32x32x16_bf16 v[144:159], a[252:255], a[60:63], v[144:159]
ds_read_b128 a[248:251], v242 offset:49152
v_add_f32 v251, v251, v252
v_cmp_ngt_f32 vcc, s47, v251
s_cbranch_vccnz L_rare4
L_back4:
v_add_f32 v248, v248, v251
s_waitcnt vmcnt(28)
s_barrier
s_waitcnt lgkmcnt(5)
v_mfma_f32_32x32x16_bf16 v[128:143], a[224:227], a[0:3], v[208:223]
ds_read_b128 a[252:255], v243 offset:49152
s_add_u32 m0, s6, 32768
s_mov_b32 s44, 245760
buffer_load_dwordx4 v224, s[16:19], s44 offen offset:0 nt lds
v_mfma_f32_32x32x16_bf16 v[128:143], a[228:231], a[4:7], v[128:143]
ds_read_b128 a[224:227], v236 offset:49408
s_waitcnt lgkmcnt(5)
v_mfma_f32_32x32x16_bf16 v[128:143], a[232:235], a[8:11], v[128:143]
ds_read_b128 a[228:231], v237 offset:49408
v_exp_f32 v192, v144
v_exp_f32 v193, v145
v_mfma_f32_32x32x16_bf16 v[128:143], a[236:239], a[12:15], v[128:143]
ds_read_b128 a[232:235], v238 offset:49408
v_exp_f32 v194, v146
v_exp_f32 v195, v147
s_waitcnt lgkmcnt(5)
v_mfma_f32_32x32x16_bf16 v[128:143], a[240:243], a[16:19], v[128:143]
ds_read_b128 a[236:239], v239 offset:49408
buffer_load_dwordx4 v225, s[16:19], s44 offen offset:1024 nt lds
v_add_f32 v251, v192, v193
v_cvt_pk_bf16_f32 v40, v192, v193
v_exp_f32 v196, v148
v_mfma_f32_32x32x16_bf16 v[128:143], a[244:247], a[20:23], v[128:143]
ds_read_b128 a[240:243], v240 offset:49408
v_exp_f32 v197, v149
v_add_f32 v252, v194, v195
v_cvt_pk_bf16_f32 v41, v194, v195
s_waitcnt lgkmcnt(5)
v_mfma_f32_32x32x16_bf16 v[128:143], a[248:251], a[24:27], v[128:143]
ds_read_b128 a[244:247], v241 offset:49408
v_exp_f32 v198, v150
v_exp_f32 v199, v151
v_mfma_f32_32x32x16_bf16 v[128:143], a[252:255], a[28:31], v[128:143]
ds_read_b128 a[248:251], v242 offset:49408
v_add_f32 v251, v251, v196
v_add_f32 v252, v252, v197
v_cvt_pk_bf16_f32 v42, v196, v197
v_exp_f32 v200, v152
s_waitcnt lgkmcnt(5)
v_mfma_f32_32x32x16_bf16 v[128:143], a[224:227], a[32:35], v[128:143]
ds_read_b128 a[252:255], v243 offset:49408
buffer_load_dwordx4 v226, s[16:19], s44 offen offset:2048 nt lds
v_exp_f32 v201, v153
v_add_f32 v251, v251, v198
v_add_f32 v252, v252, v199
v_mfma_f32_32x32x16_bf16 v[128:143], a[228:231], a[36:39], v[128:143]
ds_read_b128 a[224:227], v160 offset:16384
v_cvt_pk_bf16_f32 v43, v198, v199
v_exp_f32 v202, v154
v_exp_f32 v203, v155
s_waitcnt lgkmcnt(5)
v_mfma_f32_32x32x16_bf16 v[128:143], a[232:235], a[40:43], v[128:143]
ds_read_b128 a[228:231], v161 offset:16384
v_add_f32 v251, v251, v200
v_add_f32 v252, v252, v201
v_cvt_pk_bf16_f32 v44, v200, v201
v_exp_f32 v204, v156
v_mfma_f32_32x32x16_bf16 v[128:143], a[236:239], a[44:47], v[128:143]
ds_read_b128 a[232:235], v162 offset:16384
v_exp_f32 v205, v157
v_add_f32 v251, v251, v202
v_add_f32 v252, v252, v203
s_waitcnt lgkmcnt(5)
v_mfma_f32_32x32x16_bf16 v[128:143], a[240:243], a[48:51], v[128:143]
ds_read_b128 a[236:239], v163 offset:16384
buffer_load_dwordx4 v227, s[16:19], s44 offen offset:3072 nt lds
v_cvt_pk_bf16_f32 v45, v202, v203
v_exp_f32 v206, v158
v_mfma_f32_32x32x16_bf16 v[128:143], a[244:247], a[52:55], v[128:143]
ds_read_b128 a[240:243], v164 offset:16384
v_exp_f32 v207, v159
v_add_f32 v251, v251, v204
v_add_f32 v252, v252, v205
s_waitcnt lgkmcnt(5)
v_mfma_f32_32x32x16_bf16 v[128:143], a[248:251], a[56:59], v[128:143]
ds_read_b128 a[244:247], v165 offset:16384
v_cvt_pk_bf16_f32 v46, v204, v205
v_add_f32 v251, v251, v252
v_add_f32 v252, v206, v207
v_cvt_pk_bf16_f32 v47, v206, v207
v_mfma_f32_32x32x16_bf16 v[128:143], a[252:255], a[60:63], v[128:143]
ds_read_b128 a[248:251], v166 offset:16384
v_add_f32 v251, v251, v252
v_cmp_ngt_f32 vcc, s47, v251
s_cbranch_vccnz L_rare5
L_back5:
v_add_f32 v248, v248, v251
s_waitcnt vmcnt(28)
s_barrier
s_waitcnt lgkmcnt(5)
v_mfma_f32_32x32x16_bf16 v[144:159], a[224:227], a[0:3], v[208:223]
ds_read_b128 a[252:255], v167 offset:16384
v_mfma_f32_32x32x16_bf16 v[144:159], a[228:231], a[4:7], v[144:159]
ds_read_b128 a[224:227], v160 offset:16640
s_waitcnt lgkmcnt(5)
v_mfma_f32_32x32x16_bf16 v[144:159], a[232:235], a[8:11], v[144:159]
ds_read_b128 a[228:231], v161 offset:16640
v_exp_f32 v192, v128
v_exp_f32 v193, v129
v_mfma_f32_32x32x16_bf16 v[144:159], a[236:239], a[12:15], v[144:159]
ds_read_b128 a[232:235], v162 offset:16640
v_exp_f32 v194, v130
v_exp_f32 v195, v131
s_waitcnt lgkmcnt(5)
v_mfma_f32_32x32x16_bf16 v[144:159], a[240:243], a[16:19], v[144:159]
ds_read_b128 a[236:239], v163 offset:16640
v_add_f32 v251, v192, v193
v_cvt_pk_bf16_f32 v48, v192, v193
v_exp_f32 v196, v132
v_mfma_f32_32x32x16_bf16 v[144:159], a[244:247], a[20:23], v[144:159]
ds_read_b128 a[240:243], v164 offset:16640
v_exp_f32 v197, v133
v_add_f32 v252, v194, v195
v_cvt_pk_bf16_f32 v49, v194, v195
s_waitcnt lgkmcnt(5)
v_mfma_f32_32x32x16_bf16 v[144:159], a[248:251], a[24:27], v[144:159]
ds_read_b128 a[244:247], v165 offset:16640
v_exp_f32 v198, v134
v_exp_f32 v199, v135
v_mfma_f32_32x32x16_bf16 v[144:159], a[252:255], a[28:31], v[144:159]
ds_read_b128 a[248:251], v166 offset:16640
v_add_f32 v251, v251, v196
v_add_f32 v252, v252, v197
v_cvt_pk_bf16_f32 v50, v196, v197
v_exp_f32 v200, v136
s_waitcnt lgkmcnt(5)
v_mfma_f32_32x32x16_bf16 v[144:159], a[224:227], a[32:35], v[144:159]
ds_read_b128 a[252:255], v167 offset:16640
v_exp_f32 v201, v137
v_add_f32 v251, v251, v198
v_add_f32 v252, v252, v199
v_mfma_f32_32x32x16_bf16 v[144:159], a[228:231], a[36:39], v[144:159]
ds_read_b128 a[224:227], v160 offset:49152
v_cvt_pk_bf16_f32 v51, v198, v199
v_exp_f32 v202, v138
v_exp_f32 v203, v139
s_waitcnt lgkmcnt(5)
v_mfma_f32_32x32x16_bf16 v[144:159], a[232:235], a[40:43], v[144:159]
ds_read_b128 a[228:231], v161 offset:49152
v_add_f32 v251, v251, v200
v_add_f32 v252, v252, v201
v_cvt_pk_bf16_f32 v52, v200, v201
v_exp_f32 v204, v140
v_mfma_f32_32x32x16_bf16 v[144:159], a[236:239], a[44:47], v[144:159]
ds_read_b128 a[232:235], v162 offset:49152
v_exp_f32 v205, v141
v_add_f32 v251, v251, v202
v_add_f32 v252, v252, v203
s_waitcnt lgkmcnt(5)
v_mfma_f32_32x32x16_bf16 v[144:159], a[240:243], a[48:51], v[144:159]
ds_read_b128 a[236:239], v163 offset:49152
v_cvt_pk_bf16_f32 v53, v202, v203
v_exp_f32 v206, v142
v_mfma_f32_32x32x16_bf16 v[144:159], a[244:247], a[52:55], v[144:159]
ds_read_b128 a[240:243], v164 offset:49152
v_exp_f32 v207, v143
v_add_f32 v251, v251, v204
v_add_f32 v252, v252, v205
s_waitcnt lgkmcnt(5)
v_mfma_f32_32x32x16_bf16 v[144:159], a[248:251], a[56:59], v[144:159]
ds_read_b128 a[244:247], v165 offset:49152
v_cvt_pk_bf16_f32 v54, v204, v205
v_add_f32 v251, v251, v252
v_add_f32 v252, v206, v207
v_cvt_pk_bf16_f32 v55, v206, v207
v_mfma_f32_32x32x16_bf16 v[144:159], a[252:255], a[60:63], v[144:159]
ds_read_b128 a[248:251], v166 offset:49152
v_add_f32 v251, v251, v252
v_cmp_ngt_f32 vcc, s47, v251
s_cbranch_vccnz L_rare6
L_back6:
v_add_f32 v248, v248, v251
s_waitcnt vmcnt(24)
s_barrier
s_waitcnt lgkmcnt(5)
v_mfma_f32_32x32x16_bf16 v[128:143], a[224:227], a[0:3], v[208:223]
ds_read_b128 a[252:255], v167 offset:49152
s_add_u32 m0, s6, 49152
s_add_u32 s44, s68, 0
buffer_load_dwordx4 v228, s[20:23], s44 offen offset:0 nt lds
v_mfma_f32_32x32x16_bf16 v[128:143], a[228:231], a[4:7], v[128:143]
ds_read_b128 a[224:227], v160 offset:49408
s_waitcnt lgkmcnt(5)
v_mfma_f32_32x32x16_bf16 v[128:143], a[232:235], a[8:11], v[128:143]
ds_read_b128 a[228:231], v161 offset:49408
v_exp_f32 v192, v144
v_exp_f32 v193, v145
v_mfma_f32_32x32x16_bf16 v[128:143], a[236:239], a[12:15], v[128:143]
ds_read_b128 a[232:235], v162 offset:49408
v_exp_f32 v194, v146
v_exp_f32 v195, v147
s_waitcnt lgkmcnt(5)
v_mfma_f32_32x32x16_bf16 v[128:143], a[240:243], a[16:19], v[128:143]
ds_read_b128 a[236:239], v163 offset:49408
buffer_load_dwordx4 v229, s[20:23], s44 offen offset:1024 nt lds
v_add_f32 v251, v192, v193
v_cvt_pk_bf16_f32 v56, v192, v193
v_exp_f32 v196, v148
v_mfma_f32_32x32x16_bf16 v[128:143], a[244:247], a[20:23], v[128:143]
ds_read_b128 a[240:243], v164 offset:49408
v_exp_f32 v197, v149
v_add_f32 v252, v194, v195
v_cvt_pk_bf16_f32 v57, v194, v195
s_waitcnt lgkmcnt(5)
v_mfma_f32_32x32x16_bf16 v[128:143], a[248:251], a[24:27], v[128:143]
ds_read_b128 a[244:247], v165 offset:49408
v_exp_f32 v198, v150
v_exp_f32 v199, v151
v_mfma_f32_32x32x16_bf16 v[128:143], a[252:255], a[28:31], v[128:143]
ds_read_b128 a[248:251], v166 offset:49408
v_add_f32 v251, v251, v196
v_add_f32 v252, v252, v197
v_cvt_pk_bf16_f32 v58, v196, v197
v_exp_f32 v200, v152
s_waitcnt lgkmcnt(5)
v_mfma_f32_32x32x16_bf16 v[128:143], a[224:227], a[32:35], v[128:143]
ds_read_b128 a[252:255], v167 offset:49408
buffer_load_dwordx4 v230, s[20:23], s44 offen offset:2048 nt lds
v_exp_f32 v201, v153
v_add_f32 v251, v251, v198
v_add_f32 v252, v252, v199
v_mfma_f32_32x32x16_bf16 v[128:143], a[228:231], a[36:39], v[128:143]
ds_read_b128 a[224:227], v236 offset:0
v_cvt_pk_bf16_f32 v59, v198, v199
v_exp_f32 v202, v154
v_exp_f32 v203, v155
s_waitcnt lgkmcnt(5)
v_mfma_f32_32x32x16_bf16 v[128:143], a[232:235], a[40:43], v[128:143]
ds_read_b128 a[228:231], v237 offset:0
v_add_f32 v251, v251, v200
v_add_f32 v252, v252, v201
v_cvt_pk_bf16_f32 v60, v200, v201
v_exp_f32 v204, v156
v_mfma_f32_32x32x16_bf16 v[128:143], a[236:239], a[44:47], v[128:143]
ds_read_b128 a[232:235], v238 offset:0
v_exp_f32 v205, v157
v_add_f32 v251, v251, v202
v_add_f32 v252, v252, v203
s_waitcnt lgkmcnt(5)
v_mfma_f32_32x32x16_bf16 v[128:143], a[240:243], a[48:51], v[128:143]
ds_read_b128 a[236:239], v239 offset:0
buffer_load_dwordx4 v231, s[20:23], s44 offen offset:3072 nt lds
v_cvt_pk_bf16_f32 v61, v202, v203
v_exp_f32 v206, v158
v_mfma_f32_32x32x16_bf16 v[128:143], a[244:247], a[52:55], v[128:143]
ds_read_b128 a[240:243], v240 offset:0
v_exp_f32 v207, v159
v_add_f32 v251, v251, v204
v_add_f32 v252, v252, v205
s_waitcnt lgkmcnt(5)
v_mfma_f32_32x32x16_bf16 v[128:143], a[248:251], a[56:59], v[128:143]
ds_read_b128 a[244:247], v241 offset:0
v_cvt_pk_bf16_f32 v62, v204, v205
v_add_f32 v251, v251, v252
v_add_f32 v252, v206, v207
v_cvt_pk_bf16_f32 v63, v206, v207
v_mfma_f32_32x32x16_bf16 v[128:143], a[252:255], a[60:63], v[128:143]
ds_read_b128 a[248:251], v242 offset:0
v_add_f32 v251, v251, v252
v_cmp_ngt_f32 vcc, s47, v251
s_cbranch_vccnz L_rare7
L_back7:
v_add_f32 v248, v248, v251
s_waitcnt vmcnt(24)
s_barrier
s_waitcnt lgkmcnt(5)
v_mfma_f32_32x32x16_bf16 v[144:159], a[224:227], a[0:3], v[208:223]
ds_read_b128 a[252:255], v243 offset:0
s_add_u32 m0, s6, 81920
s_add_u32 s44, s68, 65536
buffer_load_dwordx4 v228, s[20:23], s44 offen offset:0 nt lds
v_mfma_f32_32x32x16_bf16 v[144:159], a[228:231], a[4:7], v[144:159]
ds_read_b128 a[224:227], v236 offset:256
s_waitcnt lgkmcnt(5)
v_mfma_f32_32x32x16_bf16 v[144:159], a[232:235], a[8:11], v[144:159]
ds_read_b128 a[228:231], v237 offset:256
v_exp_f32 v192, v128
v_exp_f32 v193, v129
v_mfma_f32_32x32x16_bf16 v[144:159], a[236:239], a[12:15], v[144:159]
ds_read_b128 a[232:235], v238 offset:256
v_exp_f32 v194, v130
v_exp_f32 v195, v131
s_waitcnt lgkmcnt(5)
v_mfma_f32_32x32x16_bf16 v[144:159], a[240:243], a[16:19], v[144:159]
ds_read_b128 a[236:239], v239 offset:256
buffer_load_dwordx4 v229, s[20:23], s44 offen offset:1024 nt lds
v_add_f32 v251, v192, v193
v_cvt_pk_bf16_f32 v64, v192, v193
v_exp_f32 v196, v132
v_mfma_f32_32x32x16_bf16 v[144:159], a[244:247], a[20:23], v[144:159]
ds_read_b128 a[240:243], v240 offset:256
v_exp_f32 v197, v133
v_add_f32 v252, v194, v195
v_cvt_pk_bf16_f32 v65, v194, v195
s_waitcnt lgkmcnt(5)
v_mfma_f32_32x32x16_bf16 v[144:159], a[248:251], a[24:27], v[144:159]
ds_read_b128 a[244:247], v241 offset:256
v_exp_f32 v198, v134
v_exp_f32 v199, v135
v_mfma_f32_32x32x16_bf16 v[144:159], a[252:255], a[28:31], v[144:159]
ds_read_b128 a[248:251], v242 offset:256
v_add_f32 v251, v251, v196
v_add_f32 v252, v252, v197
v_cvt_pk_bf16_f32 v66, v196, v197
v_exp_f32 v200, v136
s_waitcnt lgkmcnt(5)
v_mfma_f32_32x32x16_bf16 v[144:159], a[224:227], a[32:35], v[144:159]
ds_read_b128 a[252:255], v243 offset:256
buffer_load_dwordx4 v230, s[20:23], s44 offen offset:2048 nt lds
v_exp_f32 v201, v137
v_add_f32 v251, v251, v198
v_add_f32 v252, v252, v199
v_mfma_f32_32x32x16_bf16 v[144:159], a[228:231], a[36:39], v[144:159]
ds_read_b128 a[224:227], v160 offset:32768
v_cvt_pk_bf16_f32 v67, v198, v199
v_exp_f32 v202, v138
v_exp_f32 v203, v139
s_waitcnt lgkmcnt(5)
v_mfma_f32_32x32x16_bf16 v[144:159], a[232:235], a[40:43], v[144:159]
ds_read_b128 a[228:231], v161 offset:32768
v_add_f32 v251, v251, v200
v_add_f32 v252, v252, v201
v_cvt_pk_bf16_f32 v68, v200, v201
v_exp_f32 v204, v140
v_mfma_f32_32x32x16_bf16 v[144:159], a[236:239], a[44:47], v[144:159]
ds_read_b128 a[232:235], v162 offset:32768
v_exp_f32 v205, v141
v_add_f32 v251, v251, v202
v_add_f32 v252, v252, v203
s_waitcnt lgkmcnt(5)
v_mfma_f32_32x32x16_bf16 v[144:159], a[240:243], a[48:51], v[144:159]
ds_read_b128 a[236:239], v163 offset:32768
buffer_load_dwordx4 v231, s[20:23], s44 offen offset:3072 nt lds
v_cvt_pk_bf16_f32 v69, v202, v203
v_exp_f32 v206, v142
v_mfma_f32_32x32x16_bf16 v[144:159], a[244:247], a[52:55], v[144:159]
ds_read_b128 a[240:243], v164 offset:32768
v_exp_f32 v207, v143
v_add_f32 v251, v251, v204
v_add_f32 v252, v252, v205
s_waitcnt lgkmcnt(5)
v_mfma_f32_32x32x16_bf16 v[144:159], a[248:251], a[56:59], v[144:159]
ds_read_b128 a[244:247], v165 offset:32768
v_cvt_pk_bf16_f32 v70, v204, v205
v_add_f32 v251, v251, v252
v_add_f32 v252, v206, v207
v_cvt_pk_bf16_f32 v71, v206, v207
v_mfma_f32_32x32x16_bf16 v[144:159], a[252:255], a[60:63], v[144:159]
ds_read_b128 a[248:251], v166 offset:32768
v_add_f32 v251, v251, v252
v_cmp_ngt_f32 vcc, s47, v251
s_cbranch_vccnz L_rare8
L_back8:
v_add_f32 v248, v248, v251
s_waitcnt vmcnt(24)
s_barrier
s_waitcnt lgkmcnt(5)
v_mfma_f32_32x32x16_bf16 v[128:143], a[224:227], a[0:3], v[208:223]
ds_read_b128 a[252:255], v167 offset:32768
s_add_u32 m0, s6, 114688
s_add_u32 s44, s68, 131072
buffer_load_dwordx4 v228, s[20:23], s44 offen offset:0 nt lds
v_mfma_f32_32x32x16_bf16 v[128:143], a[228:231], a[4:7], v[128:143]
ds_read_b128 a[224:227], v160 offset:33024
s_waitcnt lgkmcnt(5)
v_mfma_f32_32x32x16_bf16 v[128:143], a[232:235], a[8:11], v[128:143]
ds_read_b128 a[228:231], v161 offset:33024
v_exp_f32 v192, v144
v_exp_f32 v193, v145
v_mfma_f32_32x32x16_bf16 v[128:143], a[236:239], a[12:15], v[128:143]
ds_read_b128 a[232:235], v162 offset:33024
v_exp_f32 v194, v146
v_exp_f32 v195, v147
s_waitcnt lgkmcnt(5)
v_mfma_f32_32x32x16_bf16 v[128:143], a[240:243], a[16:19], v[128:143]
ds_read_b128 a[236:239], v163 offset:33024
buffer_load_dwordx4 v229, s[20:23], s44 offen offset:1024 nt lds
v_add_f32 v251, v192, v193
v_cvt_pk_bf16_f32 v72, v192, v193
v_exp_f32 v196, v148
v_mfma_f32_32x32x16_bf16 v[128:143], a[244:247], a[20:23], v[128:143]
ds_read_b128 a[240:243], v164 offset:33024
v_exp_f32 v197, v149
v_add_f32 v252, v194, v195
v_cvt_pk_bf16_f32 v73, v194, v195
s_waitcnt lgkmcnt(5)
v_mfma_f32_32x32x16_bf16 v[128:143], a[248:251], a[24:27], v[128:143]
ds_read_b128 a[244:247], v165 offset:33024
v_exp_f32 v198, v150
v_exp_f32 v199, v151
v_mfma_f32_32x32x16_bf16 v[128:143], a[252:255], a[28:31], v[128:143]
ds_read_b128 a[248:251], v166 offset:33024
v_add_f32 v251, v251, v196
v_add_f32 v252, v252, v197
v_cvt_pk_bf16_f32 v74, v196, v197
v_exp_f32 v200, v152
s_waitcnt lgkmcnt(5)
v_mfma_f32_32x32x16_bf16 v[128:143], a[224:227], a[32:35], v[128:143]
ds_read_b128 a[252:255], v167 offset:33024
buffer_load_dwordx4 v230, s[20:23], s44 offen offset:2048 nt lds
v_exp_f32 v201, v153
v_add_f32 v251, v251, v198
v_add_f32 v252, v252, v199
v_mfma_f32_32x32x16_bf16 v[128:143], a[228:231], a[36:39], v[128:143]
ds_read_b128 a[224:227], v236 offset:16384
v_cvt_pk_bf16_f32 v75, v198, v199
v_exp_f32 v202, v154
v_exp_f32 v203, v155
s_waitcnt lgkmcnt(5)
v_mfma_f32_32x32x16_bf16 v[128:143], a[232:235], a[40:43], v[128:143]
ds_read_b128 a[228:231], v237 offset:16384
v_add_f32 v251, v251, v200
v_add_f32 v252, v252, v201
v_cvt_pk_bf16_f32 v76, v200, v201
v_exp_f32 v204, v156
v_mfma_f32_32x32x16_bf16 v[128:143], a[236:239], a[44:47], v[128:143]
ds_read_b128 a[232:235], v238 offset:16384
v_exp_f32 v205, v157
v_add_f32 v251, v251, v202
v_add_f32 v252, v252, v203
s_waitcnt lgkmcnt(5)
v_mfma_f32_32x32x16_bf16 v[128:143], a[240:243], a[48:51], v[128:143]
ds_read_b128 a[236:239], v239 offset:16384
buffer_load_dwordx4 v231, s[20:23], s44 offen offset:3072 nt lds
v_cvt_pk_bf16_f32 v77, v202, v203
v_exp_f32 v206, v158
v_mfma_f32_32x32x16_bf16 v[128:143], a[244:247], a[52:55], v[128:143]
ds_read_b128 a[240:243], v240 offset:16384
v_exp_f32 v207, v159
v_add_f32 v251, v251, v204
v_add_f32 v252, v252, v205
s_waitcnt lgkmcnt(5)
v_mfma_f32_32x32x16_bf16 v[128:143], a[248:251], a[56:59], v[128:143]
ds_read_b128 a[244:247], v241 offset:16384
v_cvt_pk_bf16_f32 v78, v204, v205
v_add_f32 v251, v251, v252
v_add_f32 v252, v206, v207
v_cvt_pk_bf16_f32 v79, v206, v207
v_mfma_f32_32x32x16_bf16 v[128:143], a[252:255], a[60:63], v[128:143]
ds_read_b128 a[248:251], v242 offset:16384
v_add_f32 v251, v251, v252
v_cmp_ngt_f32 vcc, s47, v251
s_cbranch_vccnz L_rare9
L_back9:
v_add_f32 v248, v248, v251
s_waitcnt vmcnt(24)
s_barrier
s_waitcnt lgkmcnt(5)
v_mfma_f32_32x32x16_bf16 v[144:159], a[224:227], a[0:3], v[208:223]
ds_read_b128 a[252:255], v243 offset:16384
s_add_u32 m0, s6, 0
s_add_u32 s44, s68, 196608
buffer_load_dwordx4 v228, s[20:23], s44 offen offset:0 nt lds
v_mfma_f32_32x32x16_bf16 v[144:159], a[228:231], a[4:7], v[144:159]
ds_read_b128 a[224:227], v236 offset:16640
s_waitcnt lgkmcnt(5)
v_mfma_f32_32x32x16_bf16 v[144:159], a[232:235], a[8:11], v[144:159]
ds_read_b128 a[228:231], v237 offset:16640
v_exp_f32 v192, v128
v_exp_f32 v193, v129
v_mfma_f32_32x32x16_bf16 v[144:159], a[236:239], a[12:15], v[144:159]
ds_read_b128 a[232:235], v238 offset:16640
v_exp_f32 v194, v130
v_exp_f32 v195, v131
s_waitcnt lgkmcnt(5)
v_mfma_f32_32x32x16_bf16 v[144:159], a[240:243], a[16:19], v[144:159]
ds_read_b128 a[236:239], v239 offset:16640
buffer_load_dwordx4 v229, s[20:23], s44 offen offset:1024 nt lds
v_add_f32 v251, v192, v193
v_cvt_pk_bf16_f32 v80, v192, v193
v_exp_f32 v196, v132
v_mfma_f32_32x32x16_bf16 v[144:159], a[244:247], a[20:23], v[144:159]
ds_read_b128 a[240:243], v240 offset:16640
v_exp_f32 v197, v133
v_add_f32 v252, v194, v195
v_cvt_pk_bf16_f32 v81, v194, v195
s_waitcnt lgkmcnt(5)
v_mfma_f32_32x32x16_bf16 v[144:159], a[248:251], a[24:27], v[144:159]
ds_read_b128 a[244:247], v241 offset:16640
v_exp_f32 v198, v134
v_exp_f32 v199, v135
v_mfma_f32_32x32x16_bf16 v[144:159], a[252:255], a[28:31], v[144:159]
ds_read_b128 a[248:251], v242 offset:16640
v_add_f32 v251, v251, v196
v_add_f32 v252, v252, v197
v_cvt_pk_bf16_f32 v82, v196, v197
v_exp_f32 v200, v136
s_waitcnt lgkmcnt(5)
v_mfma_f32_32x32x16_bf16 v[144:159], a[224:227], a[32:35], v[144:159]
ds_read_b128 a[252:255], v243 offset:16640
buffer_load_dwordx4 v230, s[20:23], s44 offen offset:2048 nt lds
v_exp_f32 v201, v137
v_add_f32 v251, v251, v198
v_add_f32 v252, v252, v199
v_mfma_f32_32x32x16_bf16 v[144:159], a[228:231], a[36:39], v[144:159]
ds_read_b128 a[224:227], v160 offset:0
v_cvt_pk_bf16_f32 v83, v198, v199
v_exp_f32 v202, v138
v_exp_f32 v203, v139
s_waitcnt lgkmcnt(5)
v_mfma_f32_32x32x16_bf16 v[144:159], a[232:235], a[40:43], v[144:159]
ds_read_b128 a[228:231], v161 offset:0
v_add_f32 v251, v251, v200
v_add_f32 v252, v252, v201
v_cvt_pk_bf16_f32 v84, v200, v201
v_exp_f32 v204, v140
v_mfma_f32_32x32x16_bf16 v[144:159], a[236:239], a[44:47], v[144:159]
ds_read_b128 a[232:235], v162 offset:0
v_exp_f32 v205, v141
v_add_f32 v251, v251, v202
v_add_f32 v252, v252, v203
s_waitcnt lgkmcnt(5)
v_mfma_f32_32x32x16_bf16 v[144:159], a[240:243], a[48:51], v[144:159]
ds_read_b128 a[236:239], v163 offset:0
buffer_load_dwordx4 v231, s[20:23], s44 offen offset:3072 nt lds
v_cvt_pk_bf16_f32 v85, v202, v203
v_exp_f32 v206, v142
v_mfma_f32_32x32x16_bf16 v[144:159], a[244:247], a[52:55], v[144:159]
ds_read_b128 a[240:243], v164 offset:0
v_exp_f32 v207, v143
v_add_f32 v251, v251, v204
v_add_f32 v252, v252, v205
s_waitcnt lgkmcnt(5)
v_mfma_f32_32x32x16_bf16 v[144:159], a[248:251], a[56:59], v[144:159]
ds_read_b128 a[244:247], v165 offset:0
v_cvt_pk_bf16_f32 v86, v204, v205
v_add_f32 v251, v251, v252
v_add_f32 v252, v206, v207
v_cvt_pk_bf16_f32 v87, v206, v207
v_mfma_f32_32x32x16_bf16 v[144:159], a[252:255], a[60:63], v[144:159]
ds_read_b128 a[248:251], v166 offset:0
v_add_f32 v251, v251, v252
v_cmp_ngt_f32 vcc, s47, v251
s_cbranch_vccnz L_rare10
L_back10:
v_add_f32 v248, v248, v251
s_waitcnt vmcnt(24)
s_barrier
s_waitcnt lgkmcnt(5)
v_mfma_f32_32x32x16_bf16 v[128:143], a[224:227], a[0:3], v[208:223]
ds_read_b128 a[252:255], v167 offset:0
s_add_u32 m0, s6, 98304
s_add_u32 s44, s69, 0
buffer_load_dwordx4 v228, s[20:23], s44 offen offset:0 nt lds
v_mfma_f32_32x32x16_bf16 v[128:143], a[228:231], a[4:7], v[128:143]
ds_read_b128 a[224:227], v160 offset:256
s_waitcnt lgkmcnt(5)
v_mfma_f32_32x32x16_bf16 v[128:143], a[232:235], a[8:11], v[128:143]
ds_read_b128 a[228:231], v161 offset:256
v_exp_f32 v192, v144
v_exp_f32 v193, v145
v_mfma_f32_32x32x16_bf16 v[128:143], a[236:239], a[12:15], v[128:143]
ds_read_b128 a[232:235], v162 offset:256
v_exp_f32 v194, v146
v_exp_f32 v195, v147
s_waitcnt lgkmcnt(5)
v_mfma_f32_32x32x16_bf16 v[128:143], a[240:243], a[16:19], v[128:143]
ds_read_b128 a[236:239], v163 offset:256
buffer_load_dwordx4 v229, s[20:23], s44 offen offset:1024 nt lds
v_add_f32 v251, v192, v193
v_cvt_pk_bf16_f32 v88, v192, v193
v_exp_f32 v196, v148
v_mfma_f32_32x32x16_bf16 v[128:143], a[244:247], a[20:23], v[128:143]
ds_read_b128 a[240:243], v164 offset:256
v_exp_f32 v197, v149
v_add_f32 v252, v194, v195
v_cvt_pk_bf16_f32 v89, v194, v195
s_waitcnt lgkmcnt(5)
v_mfma_f32_32x32x16_bf16 v[128:143], a[248:251], a[24:27], v[128:143]
ds_read_b128 a[244:247], v165 offset:256
v_exp_f32 v198, v150
v_exp_f32 v199, v151
v_mfma_f32_32x32x16_bf16 v[128:143], a[252:255], a[28:31], v[128:143]
ds_read_b128 a[248:251], v166 offset:256
v_add_f32 v251, v251, v196
v_add_f32 v252, v252, v197
v_cvt_pk_bf16_f32 v90, v196, v197
v_exp_f32 v200, v152
s_waitcnt lgkmcnt(5)
v_mfma_f32_32x32x16_bf16 v[128:143], a[224:227], a[32:35], v[128:143]
ds_read_b128 a[252:255], v167 offset:256
buffer_load_dwordx4 v230, s[20:23], s44 offen offset:2048 nt lds
v_exp_f32 v201, v153
v_add_f32 v251, v251, v198
v_add_f32 v252, v252, v199
v_mfma_f32_32x32x16_bf16 v[128:143], a[228:231], a[36:39], v[128:143]
ds_read_b128 a[224:227], v168 offset:16384
v_cvt_pk_bf16_f32 v91, v198, v199
v_exp_f32 v202, v154
v_exp_f32 v203, v155
s_waitcnt lgkmcnt(5)
v_mfma_f32_32x32x16_bf16 v[128:143], a[232:235], a[40:43], v[128:143]
ds_read_b128 a[228:231], v169 offset:16384
v_add_f32 v251, v251, v200
v_add_f32 v252, v252, v201
v_cvt_pk_bf16_f32 v92, v200, v201
v_exp_f32 v204, v156
v_mfma_f32_32x32x16_bf16 v[128:143], a[236:239], a[44:47], v[128:143]
ds_read_b128 a[232:235], v170 offset:16384
v_exp_f32 v205, v157
v_add_f32 v251, v251, v202
v_add_f32 v252, v252, v203
s_waitcnt lgkmcnt(5)
v_mfma_f32_32x32x16_bf16 v[128:143], a[240:243], a[48:51], v[128:143]
ds_read_b128 a[236:239], v171 offset:16384
buffer_load_dwordx4 v231, s[20:23], s44 offen offset:3072 nt lds
v_cvt_pk_bf16_f32 v93, v202, v203
v_exp_f32 v206, v158
v_mfma_f32_32x32x16_bf16 v[128:143], a[244:247], a[52:55], v[128:143]
ds_read_b128 a[240:243], v172 offset:16384
v_exp_f32 v207, v159
v_add_f32 v251, v251, v204
v_add_f32 v252, v252, v205
s_waitcnt lgkmcnt(5)
v_mfma_f32_32x32x16_bf16 v[128:143], a[248:251], a[56:59], v[128:143]
ds_read_b128 a[244:247], v173 offset:16384
v_cvt_pk_bf16_f32 v94, v204, v205
v_add_f32 v251, v251, v252
v_add_f32 v252, v206, v207
v_cvt_pk_bf16_f32 v95, v206, v207
v_mfma_f32_32x32x16_bf16 v[128:143], a[252:255], a[60:63], v[128:143]
ds_read_b128 a[248:251], v174 offset:16384
v_add_f32 v251, v251, v252
v_cmp_ngt_f32 vcc, s47, v251
s_cbranch_vccnz L_rare11
L_back11:
v_add_f32 v248, v248, v251
s_waitcnt vmcnt(24)
s_barrier
s_waitcnt lgkmcnt(5)
v_mfma_f32_32x32x16_bf16 v[144:159], a[224:227], a[0:3], v[208:223]
ds_read_b128 a[252:255], v175 offset:16384
v_mfma_f32_32x32x16_bf16 v[144:159], a[228:231], a[4:7], v[144:159]
ds_read_b128 a[224:227], v168 offset:16640
s_waitcnt lgkmcnt(5)
v_mfma_f32_32x32x16_bf16 v[144:159], a[232:235], a[8:11], v[144:159]
ds_read_b128 a[228:231], v169 offset:16640
v_exp_f32 v192, v128
v_exp_f32 v193, v129
v_mfma_f32_32x32x16_bf16 v[144:159], a[236:239], a[12:15], v[144:159]
ds_read_b128 a[232:235], v170 offset:16640
v_exp_f32 v194, v130
v_exp_f32 v195, v131
s_waitcnt lgkmcnt(5)
v_mfma_f32_32x32x16_bf16 v[144:159], a[240:243], a[16:19], v[144:159]
ds_read_b128 a[236:239], v171 offset:16640
v_add_f32 v251, v192, v193
v_cvt_pk_bf16_f32 v96, v192, v193
v_exp_f32 v196, v132
v_mfma_f32_32x32x16_bf16 v[144:159], a[244:247], a[20:23], v[144:159]
ds_read_b128 a[240:243], v172 offset:16640
v_exp_f32 v197, v133
v_add_f32 v252, v194, v195
v_cvt_pk_bf16_f32 v97, v194, v195
s_waitcnt lgkmcnt(5)
v_mfma_f32_32x32x16_bf16 v[144:159], a[248:251], a[24:27], v[144:159]
ds_read_b128 a[244:247], v173 offset:16640
v_exp_f32 v198, v134
v_exp_f32 v199, v135
v_mfma_f32_32x32x16_bf16 v[144:159], a[252:255], a[28:31], v[144:159]
ds_read_b128 a[248:251], v174 offset:16640
v_add_f32 v251, v251, v196
v_add_f32 v252, v252, v197
v_cvt_pk_bf16_f32 v98, v196, v197
v_exp_f32 v200, v136
s_waitcnt lgkmcnt(5)
v_mfma_f32_32x32x16_bf16 v[144:159], a[224:227], a[32:35], v[144:159]
ds_read_b128 a[252:255], v175 offset:16640
v_exp_f32 v201, v137
v_add_f32 v251, v251, v198
v_add_f32 v252, v252, v199
v_mfma_f32_32x32x16_bf16 v[144:159], a[228:231], a[36:39], v[144:159]
ds_read_b128 a[224:227], v168 offset:0
v_cvt_pk_bf16_f32 v99, v198, v199
v_exp_f32 v202, v138
v_exp_f32 v203, v139
s_waitcnt lgkmcnt(5)
v_mfma_f32_32x32x16_bf16 v[144:159], a[232:235], a[40:43], v[144:159]
ds_read_b128 a[228:231], v169 offset:0
v_add_f32 v251, v251, v200
v_add_f32 v252, v252, v201
v_cvt_pk_bf16_f32 v100, v200, v201
v_exp_f32 v204, v140
v_mfma_f32_32x32x16_bf16 v[144:159], a[236:239], a[44:47], v[144:159]
ds_read_b128 a[232:235], v170 offset:0
v_exp_f32 v205, v141
v_add_f32 v251, v251, v202
v_add_f32 v252, v252, v203
s_waitcnt lgkmcnt(5)
v_mfma_f32_32x32x16_bf16 v[144:159], a[240:243], a[48:51], v[144:159]
ds_read_b128 a[236:239], v171 offset:0
v_cvt_pk_bf16_f32 v101, v202, v203
v_exp_f32 v206, v142
v_mfma_f32_32x32x16_bf16 v[144:159], a[244:247], a[52:55], v[144:159]
ds_read_b128 a[240:243], v172 offset:0
v_exp_f32 v207, v143
v_add_f32 v251, v251, v204
v_add_f32 v252, v252, v205
s_waitcnt lgkmcnt(5)
v_mfma_f32_32x32x16_bf16 v[144:159], a[248:251], a[56:59], v[144:159]
ds_read_b128 a[244:247], v173 offset:0
v_cvt_pk_bf16_f32 v102, v204, v205
v_add_f32 v251, v251, v252
v_add_f32 v252, v206, v207
v_cvt_pk_bf16_f32 v103, v206, v207
v_mfma_f32_32x32x16_bf16 v[144:159], a[252:255], a[60:63], v[144:159]
ds_read_b128 a[248:251], v174 offset:0
v_add_f32 v251, v251, v252
v_cmp_ngt_f32 vcc, s47, v251
s_cbranch_vccnz L_rare12
L_back12:
v_add_f32 v248, v248, v251
s_waitcnt vmcnt(20)
s_barrier
s_waitcnt lgkmcnt(5)
v_mfma_f32_32x32x16_bf16 v[128:143], a[224:227], a[0:3], v[208:223]
ds_read_b128 a[252:255], v175 offset:0
s_add_u32 m0, s6, 16384
s_add_u32 s44, s69, 65536
buffer_load_dwordx4 v228, s[20:23], s44 offen offset:0 nt lds
v_mfma_f32_32x32x16_bf16 v[128:143], a[228:231], a[4:7], v[128:143]
ds_read_b128 a[224:227], v168 offset:256
s_waitcnt lgkmcnt(5)
v_mfma_f32_32x32x16_bf16 v[128:143], a[232:235], a[8:11], v[128:143]
ds_read_b128 a[228:231], v169 offset:256
v_exp_f32 v192, v144
v_exp_f32 v193, v145
v_mfma_f32_32x32x16_bf16 v[128:143], a[236:239], a[12:15], v[128:143]
ds_read_b128 a[232:235], v170 offset:256
v_exp_f32 v194, v146
v_exp_f32 v195, v147
s_waitcnt lgkmcnt(5)
v_mfma_f32_32x32x16_bf16 v[128:143], a[240:243], a[16:19], v[128:143]
ds_read_b128 a[236:239], v171 offset:256
buffer_load_dwordx4 v229, s[20:23], s44 offen offset:1024 nt lds
v_add_f32 v251, v192, v193
v_cvt_pk_bf16_f32 v104, v192, v193
v_exp_f32 v196, v148
v_mfma_f32_32x32x16_bf16 v[128:143], a[244:247], a[20:23], v[128:143]
ds_read_b128 a[240:243], v172 offset:256
v_exp_f32 v197, v149
v_add_f32 v252, v194, v195
v_cvt_pk_bf16_f32 v105, v194, v195
s_waitcnt lgkmcnt(5)
v_mfma_f32_32x32x16_bf16 v[128:143], a[248:251], a[24:27], v[128:143]
ds_read_b128 a[244:247], v173 offset:256
v_exp_f32 v198, v150
v_exp_f32 v199, v151
v_mfma_f32_32x32x16_bf16 v[128:143], a[252:255], a[28:31], v[128:143]
ds_read_b128 a[248:251], v174 offset:256
v_add_f32 v251, v251, v196
v_add_f32 v252, v252, v197
v_cvt_pk_bf16_f32 v106, v196, v197
v_exp_f32 v200, v152
s_waitcnt lgkmcnt(5)
v_mfma_f32_32x32x16_bf16 v[128:143], a[224:227], a[32:35], v[128:143]
ds_read_b128 a[252:255], v175 offset:256
buffer_load_dwordx4 v230, s[20:23], s44 offen offset:2048 nt lds
v_exp_f32 v201, v153
v_add_f32 v251, v251, v198
v_add_f32 v252, v252, v199
v_mfma_f32_32x32x16_bf16 v[128:143], a[228:231], a[36:39], v[128:143]
ds_read_b128 a[224:227], v236 offset:32768
v_cvt_pk_bf16_f32 v107, v198, v199
v_exp_f32 v202, v154
v_exp_f32 v203, v155
s_waitcnt lgkmcnt(5)
v_mfma_f32_32x32x16_bf16 v[128:143], a[232:235], a[40:43], v[128:143]
ds_read_b128 a[228:231], v237 offset:32768
v_add_f32 v251, v251, v200
v_add_f32 v252, v252, v201
v_cvt_pk_bf16_f32 v108, v200, v201
v_exp_f32 v204, v156
v_mfma_f32_32x32x16_bf16 v[128:143], a[236:239], a[44:47], v[128:143]
ds_read_b128 a[232:235], v238 offset:32768
v_exp_f32 v205, v157
v_add_f32 v251, v251, v202
v_add_f32 v252, v252, v203
s_waitcnt lgkmcnt(5)
v_mfma_f32_32x32x16_bf16 v[128:143], a[240:243], a[48:51], v[128:143]
ds_read_b128 a[236:239], v239 offset:32768
buffer_load_dwordx4 v231, s[20:23], s44 offen offset:3072 nt lds
v_cvt_pk_bf16_f32 v109, v202, v203
v_exp_f32 v206, v158
v_mfma_f32_32x32x16_bf16 v[128:143], a[244:247], a[52:55], v[128:143]
ds_read_b128 a[240:243], v240 offset:32768
v_exp_f32 v207, v159
v_add_f32 v251, v251, v204
v_add_f32 v252, v252, v205
s_waitcnt lgkmcnt(5)
v_mfma_f32_32x32x16_bf16 v[128:143], a[248:251], a[56:59], v[128:143]
ds_read_b128 a[244:247], v241 offset:32768
v_cvt_pk_bf16_f32 v110, v204, v205
v_add_f32 v251, v251, v252
v_add_f32 v252, v206, v207
v_cvt_pk_bf16_f32 v111, v206, v207
v_mfma_f32_32x32x16_bf16 v[128:143], a[252:255], a[60:63], v[128:143]
ds_read_b128 a[248:251], v242 offset:32768
v_add_f32 v251, v251, v252
v_cmp_ngt_f32 vcc, s47, v251
s_cbranch_vccnz L_rare13
L_back13:
v_add_f32 v248, v248, v251
s_waitcnt vmcnt(20)
s_barrier
s_waitcnt lgkmcnt(5)
v_mfma_f32_32x32x16_bf16 v[144:159], a[224:227], a[0:3], v[208:223]
ds_read_b128 a[252:255], v243 offset:32768
s_add_u32 m0, s6, 65536
s_add_u32 s44, s72, 0
buffer_load_dwordx4 v232, s[24:27], s44 offen offset:0 lds
v_mfma_f32_32x32x16_bf16 v[144:159], a[228:231], a[4:7], v[144:159]
ds_read_b128 a[224:227], v236 offset:33024
s_waitcnt lgkmcnt(5)
v_mfma_f32_32x32x16_bf16 v[144:159], a[232:235], a[8:11], v[144:159]
ds_read_b128 a[228:231], v237 offset:33024
v_exp_f32 v192, v128
v_exp_f32 v193, v129
v_mfma_f32_32x32x16_bf16 v[144:159], a[236:239], a[12:15], v[144:159]
ds_read_b128 a[232:235], v238 offset:33024
v_exp_f32 v194, v130
v_exp_f32 v195, v131
s_waitcnt lgkmcnt(5)
v_mfma_f32_32x32x16_bf16 v[144:159], a[240:243], a[16:19], v[144:159]
ds_read_b128 a[236:239], v239 offset:33024
buffer_load_dwordx4 v233, s[24:27], s44 offen offset:1024 lds
v_add_f32 v251, v192, v193
v_cvt_pk_bf16_f32 v112, v192, v193
v_exp_f32 v196, v132
v_mfma_f32_32x32x16_bf16 v[144:159], a[244:247], a[20:23], v[144:159]
ds_read_b128 a[240:243], v240 offset:33024
v_exp_f32 v197, v133
v_add_f32 v252, v194, v195
v_cvt_pk_bf16_f32 v113, v194, v195
s_waitcnt lgkmcnt(5)
v_mfma_f32_32x32x16_bf16 v[144:159], a[248:251], a[24:27], v[144:159]
ds_read_b128 a[244:247], v241 offset:33024
v_exp_f32 v198, v134
v_exp_f32 v199, v135
v_mfma_f32_32x32x16_bf16 v[144:159], a[252:255], a[28:31], v[144:159]
ds_read_b128 a[248:251], v242 offset:33024
v_add_f32 v251, v251, v196
v_add_f32 v252, v252, v197
v_cvt_pk_bf16_f32 v114, v196, v197
v_exp_f32 v200, v136
s_waitcnt lgkmcnt(5)
v_mfma_f32_32x32x16_bf16 v[144:159], a[224:227], a[32:35], v[144:159]
ds_read_b128 a[252:255], v243 offset:33024
buffer_load_dwordx4 v234, s[24:27], s44 offen offset:2048 lds
v_exp_f32 v201, v137
v_add_f32 v251, v251, v198
v_add_f32 v252, v252, v199
v_mfma_f32_32x32x16_bf16 v[144:159], a[228:231], a[36:39], v[144:159]
v_add_u32 v244, 0xc000, v244
ds_read_b64_tr_b16 a[224:225], v244 offset:0
ds_read_b64_tr_b16 a[226:227], v244 offset:1024
v_cvt_pk_bf16_f32 v115, v198, v199
v_exp_f32 v202, v138
v_exp_f32 v203, v139
s_waitcnt lgkmcnt(6)
v_mfma_f32_32x32x16_bf16 v[144:159], a[232:235], a[40:43], v[144:159]
v_add_u32 v245, 0xc000, v245
ds_read_b64_tr_b16 a[228:229], v245 offset:0
ds_read_b64_tr_b16 a[230:231], v245 offset:1024
v_add_f32 v251, v251, v200
v_add_f32 v252, v252, v201
v_cvt_pk_bf16_f32 v116, v200, v201
v_exp_f32 v204, v140
v_mfma_f32_32x32x16_bf16 v[144:159], a[236:239], a[44:47], v[144:159]
ds_read_b64_tr_b16 a[232:233], v244 offset:2048
ds_read_b64_tr_b16 a[234:235], v244 offset:3072
v_exp_f32 v205, v141
v_add_f32 v251, v251, v202
v_add_f32 v252, v252, v203
s_waitcnt lgkmcnt(8)
v_mfma_f32_32x32x16_bf16 v[144:159], a[240:243], a[48:51], v[144:159]
ds_read_b64_tr_b16 a[236:237], v245 offset:2048
ds_read_b64_tr_b16 a[238:239], v245 offset:3072
buffer_load_dwordx4 v235, s[24:27], s44 offen offset:3072 lds
v_cvt_pk_bf16_f32 v117, v202, v203
v_exp_f32 v206, v142
v_mfma_f32_32x32x16_bf16 v[144:159], a[244:247], a[52:55], v[144:159]
ds_read_b64_tr_b16 a[240:241], v244 offset:4096
ds_read_b64_tr_b16 a[242:243], v244 offset:5120
v_exp_f32 v207, v143
v_add_f32 v251, v251, v204
v_add_f32 v252, v252, v205
s_waitcnt lgkmcnt(10)
v_mfma_f32_32x32x16_bf16 v[144:159], a[248:251], a[56:59], v[144:159]
ds_read_b64_tr_b16 a[244:245], v245 offset:4096
ds_read_b64_tr_b16 a[246:247], v245 offset:5120
v_cvt_pk_bf16_f32 v118, v204, v205
v_add_f32 v251, v251, v252
v_add_f32 v252, v206, v207
v_cvt_pk_bf16_f32 v119, v206, v207
v_mfma_f32_32x32x16_bf16 v[144:159], a[252:255], a[60:63], v[144:159]
ds_read_b64_tr_b16 a[248:249], v244 offset:6144
ds_read_b64_tr_b16 a[250:251], v244 offset:7168
v_add_f32 v251, v251, v252
v_cmp_ngt_f32 vcc, s47, v251
s_cbranch_vccnz L_rare14
L_back14:
v_add_f32 v248, v248, v251
s_waitcnt vmcnt(20)
s_barrier
s_waitcnt lgkmcnt(10)
v_mfma_f32_32x32x16_bf16 v[160:175], a[224:227], v[0:3], 0
ds_read_b64_tr_b16 a[252:253], v245 offset:6144
ds_read_b64_tr_b16 a[254:255], v245 offset:7168
s_add_u32 m0, s6, 147456
s_add_u32 s44, s69, 131072
buffer_load_dwordx4 v228, s[20:23], s44 offen offset:0 nt lds
v_mfma_f32_32x32x16_bf16 v[176:191], a[228:231], v[0:3], 0
ds_read_b64_tr_b16 a[224:225], v244 offset:8192
ds_read_b64_tr_b16 a[226:227], v244 offset:9216
s_waitcnt lgkmcnt(10)
v_mfma_f32_32x32x16_bf16 v[160:175], a[232:235], v[4:7], v[160:175]
ds_read_b64_tr_b16 a[228:229], v245 offset:8192
ds_read_b64_tr_b16 a[230:231], v245 offset:9216
v_exp_f32 v192, v144
v_exp_f32 v193, v145
v_mfma_f32_32x32x16_bf16 v[176:191], a[236:239], v[4:7], v[176:191]
ds_read_b64_tr_b16 a[232:233], v244 offset:10240
ds_read_b64_tr_b16 a[234:235], v244 offset:11264
v_exp_f32 v194, v146
v_exp_f32 v195, v147
v_add_f32 v251, v192, v193
s_waitcnt lgkmcnt(10)
v_mfma_f32_32x32x16_bf16 v[160:175], a[240:243], v[8:11], v[160:175]
ds_read_b64_tr_b16 a[236:237], v245 offset:10240
ds_read_b64_tr_b16 a[238:239], v245 offset:11264
buffer_load_dwordx4 v229, s[20:23], s44 offen offset:1024 nt lds
v_cvt_pk_bf16_f32 v120, v192, v193
v_exp_f32 v196, v148
v_exp_f32 v197, v149
v_mfma_f32_32x32x16_bf16 v[176:191], a[244:247], v[8:11], v[176:191]
ds_read_b64_tr_b16 a[240:241], v244 offset:12288
ds_read_b64_tr_b16 a[242:243], v244 offset:13312
v_add_f32 v252, v194, v195
v_cvt_pk_bf16_f32 v121, v194, v195
v_exp_f32 v198, v150
s_waitcnt lgkmcnt(10)
v_mfma_f32_32x32x16_bf16 v[160:175], a[248:251], v[12:15], v[160:175]
ds_read_b64_tr_b16 a[244:245], v245 offset:12288
ds_read_b64_tr_b16 a[246:247], v245 offset:13312
v_exp_f32 v199, v151
v_add_f32 v251, v251, v196
v_add_f32 v252, v252, v197
v_cvt_pk_bf16_f32 v122, v196, v197
v_mfma_f32_32x32x16_bf16 v[176:191], a[252:255], v[12:15], v[176:191]
ds_read_b64_tr_b16 a[248:249], v244 offset:14336
ds_read_b64_tr_b16 a[250:251], v244 offset:15360
v_exp_f32 v200, v152
v_exp_f32 v201, v153
v_add_f32 v251, v251, v198
s_waitcnt lgkmcnt(10)
v_mfma_f32_32x32x16_bf16 v[160:175], a[224:227], v[16:19], v[160:175]
ds_read_b64_tr_b16 a[252:253], v245 offset:14336
ds_read_b64_tr_b16 a[254:255], v245 offset:15360
buffer_load_dwordx4 v230, s[20:23], s44 offen offset:2048 nt lds
v_add_f32 v252, v252, v199
v_cvt_pk_bf16_f32 v123, v198, v199
v_exp_f32 v202, v154
v_mfma_f32_32x32x16_bf16 v[176:191], a[228:231], v[16:19], v[176:191]
v_add_u32 v244, 0x8000, v244
ds_read_b64_tr_b16 a[224:225], v244 offset:0
ds_read_b64_tr_b16 a[226:227], v244 offset:1024
v_exp_f32 v203, v155
v_add_f32 v251, v251, v200
v_add_f32 v252, v252, v201
v_cvt_pk_bf16_f32 v124, v200, v201
s_waitcnt lgkmcnt(10)
v_mfma_f32_32x32x16_bf16 v[160:175], a[232:235], v[20:23], v[160:175]
v_add_u32 v245, 0x8000, v245
ds_read_b64_tr_b16 a[228:229], v245 offset:0
ds_read_b64_tr_b16 a[230:231], v245 offset:1024
v_exp_f32 v204, v156
v_exp_f32 v205, v157
v_add_f32 v251, v251, v202
v_mfma_f32_32x32x16_bf16 v[176:191], a[236:239], v[20:23], v[176:191]
ds_read_b64_tr_b16 a[232:233], v244 offset:2048
ds_read_b64_tr_b16 a[234:235], v244 offset:3072
v_add_f32 v252, v252, v203
v_cvt_pk_bf16_f32 v125, v202, v203
v_exp_f32 v206, v158
s_waitcnt lgkmcnt(10)
v_mfma_f32_32x32x16_bf16 v[160:175], a[240:243], v[24:27], v[160:175]
ds_read_b64_tr_b16 a[236:237], v245 offset:2048
ds_read_b64_tr_b16 a[238:239], v245 offset:3072
buffer_load_dwordx4 v231, s[20:23], s44 offen offset:3072 nt lds
v_exp_f32 v207, v159
v_add_f32 v251, v251, v204
v_add_f32 v252, v252, v205
v_cvt_pk_bf16_f32 v126, v204, v205
v_mfma_f32_32x32x16_bf16 v[176:191], a[244:247], v[24:27], v[176:191]
ds_read_b64_tr_b16 a[240:241], v244 offset:4096
ds_read_b64_tr_b16 a[242:243], v244 offset:5120
v_add_f32 v251, v251, v252
v_add_f32 v252, v206, v207
v_cvt_pk_bf16_f32 v127, v206, v207
v_add_f32 v251, v251, v252
v_cmp_ngt_f32 vcc, s47, v251
s_waitcnt lgkmcnt(10)
v_mfma_f32_32x32x16_bf16 v[160:175], a[248:251], v[28:31], v[160:175]
ds_read_b64_tr_b16 a[244:245], v245 offset:4096
ds_read_b64_tr_b16 a[246:247], v245 offset:5120
s_cbranch_vccnz L_rare15
L_back15:
v_add_f32 v248, v248, v251
v_mov_b32 v254, v248
s_nop 1
v_permlane32_swap_b32 v248, v254
v_mfma_f32_32x32x16_bf16 v[176:191], a[252:255], v[28:31], v[176:191]
ds_read_b64_tr_b16 a[248:249], v244 offset:6144
ds_read_b64_tr_b16 a[250:251], v244 offset:7168
s_nop 0
v_add_f32 v248, v248, v254
v_rcp_f32 v250, v248
s_nop 0
v_cndmask_b32_e64 v250, 0, v250, s[62:63]
s_waitcnt vmcnt(20)
s_barrier
s_waitcnt lgkmcnt(10)
v_mfma_f32_32x32x16_bf16 v[160:175], a[224:227], v[32:35], v[160:175]
ds_read_b64_tr_b16 a[252:253], v245 offset:6144
ds_read_b64_tr_b16 a[254:255], v245 offset:7168
s_add_u32 m0, s6, 131072
s_add_u32 s44, s72, 14336
buffer_load_dwordx4 v232, s[24:27], s44 offen offset:0 lds
v_mfma_f32_32x32x16_bf16 v[176:191], a[228:231], v[32:35], v[176:191]
ds_read_b64_tr_b16 a[224:225], v244 offset:8192
ds_read_b64_tr_b16 a[226:227], v244 offset:9216
s_waitcnt lgkmcnt(10)
v_mfma_f32_32x32x16_bf16 v[160:175], a[232:235], v[36:39], v[160:175]
ds_read_b64_tr_b16 a[228:229], v245 offset:8192
ds_read_b64_tr_b16 a[230:231], v245 offset:9216
v_mfma_f32_32x32x16_bf16 v[176:191], a[236:239], v[36:39], v[176:191]
ds_read_b64_tr_b16 a[232:233], v244 offset:10240
ds_read_b64_tr_b16 a[234:235], v244 offset:11264
s_waitcnt lgkmcnt(10)
v_mfma_f32_32x32x16_bf16 v[160:175], a[240:243], v[40:43], v[160:175]
ds_read_b64_tr_b16 a[236:237], v245 offset:10240
ds_read_b64_tr_b16 a[238:239], v245 offset:11264
buffer_load_dwordx4 v233, s[24:27], s44 offen offset:1024 lds
v_mfma_f32_32x32x16_bf16 v[176:191], a[244:247], v[40:43], v[176:191]
ds_read_b64_tr_b16 a[240:241], v244 offset:12288
ds_read_b64_tr_b16 a[242:243], v244 offset:13312
s_waitcnt lgkmcnt(10)
v_mfma_f32_32x32x16_bf16 v[160:175], a[248:251], v[44:47], v[160:175]
ds_read_b64_tr_b16 a[244:245], v245 offset:12288
ds_read_b64_tr_b16 a[246:247], v245 offset:13312
v_mfma_f32_32x32x16_bf16 v[176:191], a[252:255], v[44:47], v[176:191]
ds_read_b64_tr_b16 a[248:249], v244 offset:14336
ds_read_b64_tr_b16 a[250:251], v244 offset:15360
s_waitcnt lgkmcnt(10)
v_mfma_f32_32x32x16_bf16 v[160:175], a[224:227], v[48:51], v[160:175]
ds_read_b64_tr_b16 a[252:253], v245 offset:14336
ds_read_b64_tr_b16 a[254:255], v245 offset:15360
buffer_load_dwordx4 v234, s[24:27], s44 offen offset:2048 lds
v_mfma_f32_32x32x16_bf16 v[176:191], a[228:231], v[48:51], v[176:191]
v_add_u32 v244, 0x8000, v244
ds_read_b64_tr_b16 a[224:225], v244 offset:0
ds_read_b64_tr_b16 a[226:227], v244 offset:1024
s_waitcnt lgkmcnt(10)
v_mfma_f32_32x32x16_bf16 v[160:175], a[232:235], v[52:55], v[160:175]
v_add_u32 v245, 0x8000, v245
ds_read_b64_tr_b16 a[228:229], v245 offset:0
ds_read_b64_tr_b16 a[230:231], v245 offset:1024
v_mfma_f32_32x32x16_bf16 v[176:191], a[236:239], v[52:55], v[176:191]
ds_read_b64_tr_b16 a[232:233], v244 offset:2048
ds_read_b64_tr_b16 a[234:235], v244 offset:3072
s_waitcnt lgkmcnt(10)
v_mfma_f32_32x32x16_bf16 v[160:175], a[240:243], v[56:59], v[160:175]
ds_read_b64_tr_b16 a[236:237], v245 offset:2048
ds_read_b64_tr_b16 a[238:239], v245 offset:3072
buffer_load_dwordx4 v235, s[24:27], s44 offen offset:3072 lds
v_mfma_f32_32x32x16_bf16 v[176:191], a[244:247], v[56:59], v[176:191]
ds_read_b64_tr_b16 a[240:241], v244 offset:4096
ds_read_b64_tr_b16 a[242:243], v244 offset:5120
s_waitcnt lgkmcnt(10)
v_mfma_f32_32x32x16_bf16 v[160:175], a[248:251], v[60:63], v[160:175]
ds_read_b64_tr_b16 a[244:245], v245 offset:4096
ds_read_b64_tr_b16 a[246:247], v245 offset:5120
v_mfma_f32_32x32x16_bf16 v[176:191], a[252:255], v[60:63], v[176:191]
ds_read_b64_tr_b16 a[248:249], v244 offset:6144
ds_read_b64_tr_b16 a[250:251], v244 offset:7168
s_waitcnt vmcnt(20)
s_barrier
s_waitcnt lgkmcnt(10)
v_mfma_f32_32x32x16_bf16 v[160:175], a[224:227], v[64:67], v[160:175]
ds_read_b64_tr_b16 a[252:253], v245 offset:6144
ds_read_b64_tr_b16 a[254:255], v245 offset:7168
v_mfma_f32_32x32x16_bf16 v[176:191], a[228:231], v[64:67], v[176:191]
ds_read_b64_tr_b16 a[224:225], v244 offset:8192
ds_read_b64_tr_b16 a[226:227], v244 offset:9216
s_waitcnt lgkmcnt(10)
v_mfma_f32_32x32x16_bf16 v[160:175], a[232:235], v[68:71], v[160:175]
ds_read_b64_tr_b16 a[228:229], v245 offset:8192
ds_read_b64_tr_b16 a[230:231], v245 offset:9216
v_mfma_f32_32x32x16_bf16 v[176:191], a[236:239], v[68:71], v[176:191]
ds_read_b64_tr_b16 a[232:233], v244 offset:10240
ds_read_b64_tr_b16 a[234:235], v244 offset:11264
s_waitcnt lgkmcnt(10)
v_mfma_f32_32x32x16_bf16 v[160:175], a[240:243], v[72:75], v[160:175]
ds_read_b64_tr_b16 a[236:237], v245 offset:10240
ds_read_b64_tr_b16 a[238:239], v245 offset:11264
v_mfma_f32_32x32x16_bf16 v[176:191], a[244:247], v[72:75], v[176:191]
ds_read_b64_tr_b16 a[240:241], v244 offset:12288
ds_read_b64_tr_b16 a[242:243], v244 offset:13312
s_waitcnt lgkmcnt(10)
v_mfma_f32_32x32x16_bf16 v[160:175], a[248:251], v[76:79], v[160:175]
ds_read_b64_tr_b16 a[244:245], v245 offset:12288
ds_read_b64_tr_b16 a[246:247], v245 offset:13312
v_mfma_f32_32x32x16_bf16 v[176:191], a[252:255], v[76:79], v[176:191]
ds_read_b64_tr_b16 a[248:249], v244 offset:14336
ds_read_b64_tr_b16 a[250:251], v244 offset:15360
s_waitcnt lgkmcnt(10)
v_mfma_f32_32x32x16_bf16 v[160:175], a[224:227], v[80:83], v[160:175]
ds_read_b64_tr_b16 a[252:253], v245 offset:14336
ds_read_b64_tr_b16 a[254:255], v245 offset:15360
v_mfma_f32_32x32x16_bf16 v[176:191], a[228:231], v[80:83], v[176:191]
v_add_u32 v244, 0xfffe4000, v244
ds_read_b64_tr_b16 a[224:225], v244 offset:0
ds_read_b64_tr_b16 a[226:227], v244 offset:1024
s_waitcnt lgkmcnt(10)
v_mfma_f32_32x32x16_bf16 v[160:175], a[232:235], v[84:87], v[160:175]
v_add_u32 v245, 0xfffe4000, v245
ds_read_b64_tr_b16 a[228:229], v245 offset:0
ds_read_b64_tr_b16 a[230:231], v245 offset:1024
v_mfma_f32_32x32x16_bf16 v[176:191], a[236:239], v[84:87], v[176:191]
ds_read_b64_tr_b16 a[232:233], v244 offset:2048
ds_read_b64_tr_b16 a[234:235], v244 offset:3072
s_waitcnt lgkmcnt(10)
v_mfma_f32_32x32x16_bf16 v[160:175], a[240:243], v[88:91], v[160:175]
ds_read_b64_tr_b16 a[236:237], v245 offset:2048
ds_read_b64_tr_b16 a[238:239], v245 offset:3072
v_mfma_f32_32x32x16_bf16 v[176:191], a[244:247], v[88:91], v[176:191]
ds_read_b64_tr_b16 a[240:241], v244 offset:4096
ds_read_b64_tr_b16 a[242:243], v244 offset:5120
s_waitcnt lgkmcnt(10)
v_mfma_f32_32x32x16_bf16 v[160:175], a[248:251], v[92:95], v[160:175]
ds_read_b64_tr_b16 a[244:245], v245 offset:4096
ds_read_b64_tr_b16 a[246:247], v245 offset:5120
v_mfma_f32_32x32x16_bf16 v[176:191], a[252:255], v[92:95], v[176:191]
ds_read_b64_tr_b16 a[248:249], v244 offset:6144
ds_read_b64_tr_b16 a[250:251], v244 offset:7168
s_waitcnt vmcnt(16)
s_barrier
s_waitcnt lgkmcnt(10)
v_mfma_f32_32x32x16_bf16 v[160:175], a[224:227], v[96:99], v[160:175]
ds_read_b64_tr_b16 a[252:253], v245 offset:6144
ds_read_b64_tr_b16 a[254:255], v245 offset:7168
s_add_u32 m0, s6, 32768
s_add_u32 s44, s72, 28672
buffer_load_dwordx4 v232, s[24:27], s44 offen offset:0 lds
v_mfma_f32_32x32x16_bf16 v[176:191], a[228:231], v[96:99], v[176:191]
ds_read_b64_tr_b16 a[224:225], v244 offset:8192
ds_read_b64_tr_b16 a[226:227], v244 offset:9216
s_waitcnt lgkmcnt(10)
v_mfma_f32_32x32x16_bf16 v[160:175], a[232:235], v[100:103], v[160:175]
ds_read_b64_tr_b16 a[228:229], v245 offset:8192
ds_read_b64_tr_b16 a[230:231], v245 offset:9216
buffer_load_dwordx4 v233, s[24:27], s44 offen offset:1024 lds
v_mfma_f32_32x32x16_bf16 v[176:191], a[236:239], v[100:103], v[176:191]
ds_read_b64_tr_b16 a[232:233], v244 offset:10240
ds_read_b64_tr_b16 a[234:235], v244 offset:11264
s_waitcnt lgkmcnt(10)
v_mfma_f32_32x32x16_bf16 v[160:175], a[240:243], v[104:107], v[160:175]
ds_read_b64_tr_b16 a[236:237], v245 offset:10240
ds_read_b64_tr_b16 a[238:239], v245 offset:11264
buffer_load_dwordx4 v234, s[24:27], s44 offen offset:2048 lds
v_mfma_f32_32x32x16_bf16 v[176:191], a[244:247], v[104:107], v[176:191]
ds_read_b64_tr_b16 a[240:241], v244 offset:12288
ds_read_b64_tr_b16 a[242:243], v244 offset:13312
s_waitcnt lgkmcnt(10)
v_mfma_f32_32x32x16_bf16 v[160:175], a[248:251], v[108:111], v[160:175]
ds_read_b64_tr_b16 a[244:245], v245 offset:12288
ds_read_b64_tr_b16 a[246:247], v245 offset:13312
buffer_load_dwordx4 v235, s[24:27], s44 offen offset:3072 lds
v_mfma_f32_32x32x16_bf16 v[176:191], a[252:255], v[108:111], v[176:191]
ds_read_b64_tr_b16 a[248:249], v244 offset:14336
ds_read_b64_tr_b16 a[250:251], v244 offset:15360
s_waitcnt lgkmcnt(10)
v_mfma_f32_32x32x16_bf16 v[160:175], a[224:227], v[112:115], v[160:175]
ds_read_b64_tr_b16 a[252:253], v245 offset:14336
ds_read_b64_tr_b16 a[254:255], v245 offset:15360
s_add_u32 m0, s6, 49152
s_add_u32 s44, s69, 196608
buffer_load_dwordx4 v228, s[20:23], s44 offen offset:0 nt lds
v_mfma_f32_32x32x16_bf16 v[176:191], a[228:231], v[112:115], v[176:191]
v_add_u32 v244, 0x18000, v244
ds_read_b64_tr_b16 a[224:225], v244 offset:0
ds_read_b64_tr_b16 a[226:227], v244 offset:1024
s_waitcnt lgkmcnt(10)
v_mfma_f32_32x32x16_bf16 v[160:175], a[232:235], v[116:119], v[160:175]
v_add_u32 v245, 0x18000, v245
ds_read_b64_tr_b16 a[228:229], v245 offset:0
ds_read_b64_tr_b16 a[230:231], v245 offset:1024
buffer_load_dwordx4 v229, s[20:23], s44 offen offset:1024 nt lds
v_mfma_f32_32x32x16_bf16 v[176:191], a[236:239], v[116:119], v[176:191]
ds_read_b64_tr_b16 a[232:233], v244 offset:2048
ds_read_b64_tr_b16 a[234:235], v244 offset:3072
s_waitcnt lgkmcnt(10)
v_mfma_f32_32x32x16_bf16 v[160:175], a[240:243], v[120:123], v[160:175]
ds_read_b64_tr_b16 a[236:237], v245 offset:2048
ds_read_b64_tr_b16 a[238:239], v245 offset:3072
buffer_load_dwordx4 v230, s[20:23], s44 offen offset:2048 nt lds
v_mfma_f32_32x32x16_bf16 v[176:191], a[244:247], v[120:123], v[176:191]
ds_read_b64_tr_b16 a[240:241], v244 offset:4096
ds_read_b64_tr_b16 a[242:243], v244 offset:5120
s_waitcnt lgkmcnt(10)
v_mfma_f32_32x32x16_bf16 v[160:175], a[248:251], v[124:127], v[160:175]
ds_read_b64_tr_b16 a[244:245], v245 offset:4096
ds_read_b64_tr_b16 a[246:247], v245 offset:5120
buffer_load_dwordx4 v231, s[20:23], s44 offen offset:3072 nt lds
v_mfma_f32_32x32x16_bf16 v[176:191], a[252:255], v[124:127], v[176:191]
ds_read_b64_tr_b16 a[248:249], v244 offset:6144
ds_read_b64_tr_b16 a[250:251], v244 offset:7168
s_waitcnt vmcnt(16)
s_barrier
s_mul_i32 s7, s5, 114688
s_mul_i32 s46, s3, 28672
s_add_u32 s7, s7, s46
v_lshlrev_b32 v224, 4, v255
v_add_u32 v224, s7, v224
v_mov_b32 v226, 0x40000000
v_cndmask_b32_e64 v224, v226, v224, s[62:63]
s_nop 0
s_lshl_b32 s7, s3, 6
s_add_u32 s7, s7, s5
s_lshl_b32 s7, s7, 7
v_mov_b32 v225, s7
v_mov_b32 v226, s4
v_lshlrev_b32 v226, 2, v226
v_add_u32 v226, 128, v226
s_waitcnt lgkmcnt(10)
v_mfma_f32_32x32x16_bf16 v[128:143], a[224:227], v[0:3], 0
ds_read_b64_tr_b16 a[252:253], v245 offset:6144
ds_read_b64_tr_b16 a[254:255], v245 offset:7168
s_add_u32 m0, s6, 81920
s_add_u32 s44, s72, 43008
buffer_load_dwordx4 v232, s[24:27], s44 offen offset:0 lds
v_mfma_f32_32x32x16_bf16 v[144:159], a[228:231], v[0:3], 0
ds_read_b64_tr_b16 a[224:225], v244 offset:8192
ds_read_b64_tr_b16 a[226:227], v244 offset:9216
s_waitcnt lgkmcnt(10)
v_mfma_f32_32x32x16_bf16 v[128:143], a[232:235], v[4:7], v[128:143]
ds_read_b64_tr_b16 a[228:229], v245 offset:8192
ds_read_b64_tr_b16 a[230:231], v245 offset:9216
buffer_load_dwordx4 v233, s[24:27], s44 offen offset:1024 lds
v_mfma_f32_32x32x16_bf16 v[144:159], a[236:239], v[4:7], v[144:159]
ds_read_b64_tr_b16 a[232:233], v244 offset:10240
ds_read_b64_tr_b16 a[234:235], v244 offset:11264
v_mul_f32 v160, v160, v250
v_mul_f32 v161, v161, v250
v_mul_f32 v162, v162, v250
v_mul_f32 v163, v163, v250
s_waitcnt lgkmcnt(10)
v_mfma_f32_32x32x16_bf16 v[128:143], a[240:243], v[8:11], v[128:143]
ds_read_b64_tr_b16 a[236:237], v245 offset:10240
ds_read_b64_tr_b16 a[238:239], v245 offset:11264
buffer_load_dwordx4 v234, s[24:27], s44 offen offset:2048 lds
v_mul_f32 v164, v164, v250
v_mul_f32 v165, v165, v250
v_mul_f32 v166, v166, v250
v_mul_f32 v167, v167, v250
v_mfma_f32_32x32x16_bf16 v[144:159], a[244:247], v[8:11], v[144:159]
ds_read_b64_tr_b16 a[240:241], v244 offset:12288
ds_read_b64_tr_b16 a[242:243], v244 offset:13312
v_mul_f32 v168, v168, v250
v_mul_f32 v169, v169, v250
v_mul_f32 v170, v170, v250
v_mul_f32 v171, v171, v250
s_waitcnt lgkmcnt(10)
v_mfma_f32_32x32x16_bf16 v[128:143], a[248:251], v[12:15], v[128:143]
ds_read_b64_tr_b16 a[244:245], v245 offset:12288
ds_read_b64_tr_b16 a[246:247], v245 offset:13312
buffer_load_dwordx4 v235, s[24:27], s44 offen offset:3072 lds
v_mul_f32 v172, v172, v250
v_mul_f32 v173, v173, v250
v_mul_f32 v174, v174, v250
v_mul_f32 v175, v175, v250
v_mfma_f32_32x32x16_bf16 v[144:159], a[252:255], v[12:15], v[144:159]
ds_read_b64_tr_b16 a[248:249], v244 offset:14336
ds_read_b64_tr_b16 a[250:251], v244 offset:15360
v_mul_f32 v176, v176, v250
v_mul_f32 v177, v177, v250
v_mul_f32 v178, v178, v250
v_mul_f32 v179, v179, v250
s_waitcnt lgkmcnt(10)
v_mfma_f32_32x32x16_bf16 v[128:143], a[224:227], v[16:19], v[128:143]
ds_read_b64_tr_b16 a[252:253], v245 offset:14336
ds_read_b64_tr_b16 a[254:255], v245 offset:15360
s_add_u32 m0, s6, 114688
s_add_u32 s44, s70, 0
buffer_load_dwordx4 v228, s[20:23], s44 offen offset:0 nt lds
v_mul_f32 v180, v180, v250
v_mul_f32 v181, v181, v250
v_mul_f32 v182, v182, v250
v_mul_f32 v183, v183, v250
v_mfma_f32_32x32x16_bf16 v[144:159], a[228:231], v[16:19], v[144:159]
v_add_u32 v246, 0x10000, v246
ds_read_b64_tr_b16 a[224:225], v246 offset:0
ds_read_b64_tr_b16 a[226:227], v246 offset:7168
v_mul_f32 v184, v184, v250
v_mul_f32 v185, v185, v250
v_mul_f32 v186, v186, v250
s_waitcnt lgkmcnt(10)
v_mfma_f32_32x32x16_bf16 v[128:143], a[232:235], v[20:23], v[128:143]
v_add_u32 v247, 0x10000, v247
ds_read_b64_tr_b16 a[228:229], v247 offset:0
ds_read_b64_tr_b16 a[230:231], v247 offset:7168
buffer_load_dwordx4 v229, s[20:23], s44 offen offset:1024 nt lds
v_mul_f32 v187, v187, v250
v_mul_f32 v188, v188, v250
v_mul_f32 v189, v189, v250
v_mul_f32 v190, v190, v250
v_mfma_f32_32x32x16_bf16 v[144:159], a[236:239], v[20:23], v[144:159]
ds_read_b64_tr_b16 a[232:233], v246 offset:128
ds_read_b64_tr_b16 a[234:235], v246 offset:7296
v_mul_f32 v191, v191, v250
v_cvt_pk_bf16_f32 v192, v160, v161
v_cvt_pk_bf16_f32 v193, v162, v163
s_waitcnt lgkmcnt(10)
v_mfma_f32_32x32x16_bf16 v[128:143], a[240:243], v[24:27], v[128:143]
ds_read_b64_tr_b16 a[236:237], v247 offset:128
ds_read_b64_tr_b16 a[238:239], v247 offset:7296
buffer_load_dwordx4 v230, s[20:23], s44 offen offset:2048 nt lds
v_cvt_pk_bf16_f32 v194, v164, v165
v_cvt_pk_bf16_f32 v195, v166, v167
v_cvt_pk_bf16_f32 v196, v168, v169
v_cvt_pk_bf16_f32 v197, v170, v171
v_mfma_f32_32x32x16_bf16 v[144:159], a[244:247], v[24:27], v[144:159]
ds_read_b64_tr_b16 a[240:241], v246 offset:256
ds_read_b64_tr_b16 a[242:243], v246 offset:7424
v_cvt_pk_bf16_f32 v198, v172, v173
v_cvt_pk_bf16_f32 v199, v174, v175
v_cvt_pk_bf16_f32 v200, v176, v177
s_waitcnt lgkmcnt(10)
v_mfma_f32_32x32x16_bf16 v[128:143], a[248:251], v[28:31], v[128:143]
ds_read_b64_tr_b16 a[244:245], v247 offset:256
ds_read_b64_tr_b16 a[246:247], v247 offset:7424
buffer_load_dwordx4 v231, s[20:23], s44 offen offset:3072 nt lds
v_cvt_pk_bf16_f32 v201, v178, v179
v_cvt_pk_bf16_f32 v202, v180, v181
v_cvt_pk_bf16_f32 v203, v182, v183
v_cvt_pk_bf16_f32 v204, v184, v185
v_mfma_f32_32x32x16_bf16 v[144:159], a[252:255], v[28:31], v[144:159]
ds_read_b64_tr_b16 a[248:249], v246 offset:384
ds_read_b64_tr_b16 a[250:251], v246 offset:7552
v_cvt_pk_bf16_f32 v205, v186, v187
v_cvt_pk_bf16_f32 v206, v188, v189
v_cvt_pk_bf16_f32 v207, v190, v191
s_barrier
s_waitcnt lgkmcnt(10)
v_mfma_f32_32x32x16_bf16 a[0:15], a[224:227], v[192:195], 0
ds_read_b64_tr_b16 a[252:253], v247 offset:384
ds_read_b64_tr_b16 a[254:255], v247 offset:7552
v_mfma_f32_32x32x16_bf16 a[16:31], a[228:231], v[192:195], 0
ds_read_b64_tr_b16 a[224:225], v246 offset:512
ds_read_b64_tr_b16 a[226:227], v246 offset:7680
s_waitcnt lgkmcnt(10)
v_mfma_f32_32x32x16_bf16 a[32:47], a[232:235], v[192:195], 0
ds_read_b64_tr_b16 a[228:229], v247 offset:512
ds_read_b64_tr_b16 a[230:231], v247 offset:7680
v_mfma_f32_32x32x16_bf16 a[48:63], a[236:239], v[192:195], 0
ds_read_b64_tr_b16 a[232:233], v246 offset:640
ds_read_b64_tr_b16 a[234:235], v246 offset:7808
s_waitcnt lgkmcnt(10)
v_mfma_f32_32x32x16_bf16 a[64:79], a[240:243], v[192:195], 0
ds_read_b64_tr_b16 a[236:237], v247 offset:640
ds_read_b64_tr_b16 a[238:239], v247 offset:7808
v_mfma_f32_32x32x16_bf16 a[80:95], a[244:247], v[192:195], 0
ds_read_b64_tr_b16 a[240:241], v246 offset:768
ds_read_b64_tr_b16 a[242:243], v246 offset:7936
s_waitcnt lgkmcnt(10)
v_mfma_f32_32x32x16_bf16 a[96:111], a[248:251], v[192:195], 0
ds_read_b64_tr_b16 a[244:245], v247 offset:768
ds_read_b64_tr_b16 a[246:247], v247 offset:7936
v_mfma_f32_32x32x16_bf16 a[112:127], a[252:255], v[192:195], 0
v_add_u32 v244, 0xfffec000, v244
ds_read_b64_tr_b16 a[248:249], v244 offset:0
ds_read_b64_tr_b16 a[250:251], v244 offset:1024
s_waitcnt lgkmcnt(10)
v_mfma_f32_32x32x16_bf16 a[128:143], a[224:227], v[192:195], 0
v_add_u32 v245, 0xfffec000, v245
ds_read_b64_tr_b16 a[252:253], v245 offset:0
ds_read_b64_tr_b16 a[254:255], v245 offset:1024
v_mfma_f32_32x32x16_bf16 a[144:159], a[228:231], v[192:195], 0
ds_read_b64_tr_b16 a[224:225], v244 offset:2048
ds_read_b64_tr_b16 a[226:227], v244 offset:3072
s_waitcnt lgkmcnt(10)
v_mfma_f32_32x32x16_bf16 a[160:175], a[232:235], v[192:195], 0
ds_read_b64_tr_b16 a[228:229], v245 offset:2048
ds_read_b64_tr_b16 a[230:231], v245 offset:3072
v_mfma_f32_32x32x16_bf16 a[176:191], a[236:239], v[192:195], 0
ds_read_b64_tr_b16 a[232:233], v244 offset:4096
ds_read_b64_tr_b16 a[234:235], v244 offset:5120
s_waitcnt lgkmcnt(10)
v_mfma_f32_32x32x16_bf16 a[192:207], a[240:243], v[192:195], 0
ds_read_b64_tr_b16 a[236:237], v245 offset:4096
ds_read_b64_tr_b16 a[238:239], v245 offset:5120
v_mfma_f32_32x32x16_bf16 a[208:223], a[244:247], v[192:195], 0
ds_read_b64_tr_b16 a[240:241], v244 offset:6144
ds_read_b64_tr_b16 a[242:243], v244 offset:7168
s_waitcnt vmcnt(16)
s_barrier
s_waitcnt lgkmcnt(10)
v_mfma_f32_32x32x16_bf16 v[128:143], a[248:251], v[32:35], v[128:143]
ds_read_b64_tr_b16 a[244:245], v245 offset:6144
ds_read_b64_tr_b16 a[246:247], v245 offset:7168
s_add_u32 m0, s6, 0
s_add_u32 s44, s70, 65536
buffer_load_dwordx4 v228, s[20:23], s44 offen offset:0 nt lds
v_mfma_f32_32x32x16_bf16 v[144:159], a[252:255], v[32:35], v[144:159]
ds_read_b64_tr_b16 a[248:249], v244 offset:8192
ds_read_b64_tr_b16 a[250:251], v244 offset:9216
s_waitcnt lgkmcnt(10)
v_mfma_f32_32x32x16_bf16 v[128:143], a[224:227], v[36:39], v[128:143]
ds_read_b64_tr_b16 a[252:253], v245 offset:8192
ds_read_b64_tr_b16 a[254:255], v245 offset:9216
v_mfma_f32_32x32x16_bf16 v[144:159], a[228:231], v[36:39], v[144:159]
ds_read_b64_tr_b16 a[224:225], v244 offset:10240
ds_read_b64_tr_b16 a[226:227], v244 offset:11264
s_waitcnt lgkmcnt(10)
v_mfma_f32_32x32x16_bf16 v[128:143], a[232:235], v[40:43], v[128:143]
ds_read_b64_tr_b16 a[228:229], v245 offset:10240
ds_read_b64_tr_b16 a[230:231], v245 offset:11264
buffer_load_dwordx4 v229, s[20:23], s44 offen offset:1024 nt lds
v_mfma_f32_32x32x16_bf16 v[144:159], a[236:239], v[40:43], v[144:159]
ds_read_b64_tr_b16 a[232:233], v244 offset:12288
ds_read_b64_tr_b16 a[234:235], v244 offset:13312
s_waitcnt lgkmcnt(10)
v_mfma_f32_32x32x16_bf16 v[128:143], a[240:243], v[44:47], v[128:143]
ds_read_b64_tr_b16 a[236:237], v245 offset:12288
ds_read_b64_tr_b16 a[238:239], v245 offset:13312
v_mfma_f32_32x32x16_bf16 v[144:159], a[244:247], v[44:47], v[144:159]
ds_read_b64_tr_b16 a[240:241], v244 offset:14336
ds_read_b64_tr_b16 a[242:243], v244 offset:15360
s_waitcnt lgkmcnt(10)
v_mfma_f32_32x32x16_bf16 v[128:143], a[248:251], v[48:51], v[128:143]
ds_read_b64_tr_b16 a[244:245], v245 offset:14336
ds_read_b64_tr_b16 a[246:247], v245 offset:15360
buffer_load_dwordx4 v230, s[20:23], s44 offen offset:2048 nt lds
v_mfma_f32_32x32x16_bf16 v[144:159], a[252:255], v[48:51], v[144:159]
v_add_u32 v246, 0x10000, v246
ds_read_b64_tr_b16 a[248:249], v246 offset:0
ds_read_b64_tr_b16 a[250:251], v246 offset:7168
s_waitcnt lgkmcnt(10)
v_mfma_f32_32x32x16_bf16 v[128:143], a[224:227], v[52:55], v[128:143]
v_add_u32 v247, 0x10000, v247
ds_read_b64_tr_b16 a[252:253], v247 offset:0
ds_read_b64_tr_b16 a[254:255], v247 offset:7168
v_mfma_f32_32x32x16_bf16 v[144:159], a[228:231], v[52:55], v[144:159]
ds_read_b64_tr_b16 a[224:225], v246 offset:128
ds_read_b64_tr_b16 a[226:227], v246 offset:7296
s_waitcnt lgkmcnt(10)
v_mfma_f32_32x32x16_bf16 v[128:143], a[232:235], v[56:59], v[128:143]
ds_read_b64_tr_b16 a[228:229], v247 offset:128
ds_read_b64_tr_b16 a[230:231], v247 offset:7296
buffer_load_dwordx4 v231, s[20:23], s44 offen offset:3072 nt lds
v_mfma_f32_32x32x16_bf16 v[144:159], a[236:239], v[56:59], v[144:159]
ds_read_b64_tr_b16 a[232:233], v246 offset:256
ds_read_b64_tr_b16 a[234:235], v246 offset:7424
s_waitcnt lgkmcnt(10)
v_mfma_f32_32x32x16_bf16 v[128:143], a[240:243], v[60:63], v[128:143]
ds_read_b64_tr_b16 a[236:237], v247 offset:256
ds_read_b64_tr_b16 a[238:239], v247 offset:7424
v_mfma_f32_32x32x16_bf16 v[144:159], a[244:247], v[60:63], v[144:159]
ds_read_b64_tr_b16 a[240:241], v246 offset:384
ds_read_b64_tr_b16 a[242:243], v246 offset:7552
s_barrier
s_waitcnt lgkmcnt(10)
v_mfma_f32_32x32x16_bf16 a[0:15], a[248:251], v[196:199], a[0:15]
ds_read_b64_tr_b16 a[244:245], v247 offset:384
ds_read_b64_tr_b16 a[246:247], v247 offset:7552
s_add_u32 m0, s6, 98304
s_add_u32 s44, s73, 0
buffer_load_dwordx4 v232, s[24:27], s44 offen offset:0 lds
v_mfma_f32_32x32x16_bf16 a[16:31], a[252:255], v[196:199], a[16:31]
ds_read_b64_tr_b16 a[248:249], v246 offset:512
ds_read_b64_tr_b16 a[250:251], v246 offset:7680
s_waitcnt lgkmcnt(10)
v_mfma_f32_32x32x16_bf16 a[32:47], a[224:227], v[196:199], a[32:47]
ds_read_b64_tr_b16 a[252:253], v247 offset:512
ds_read_b64_tr_b16 a[254:255], v247 offset:7680
v_mfma_f32_32x32x16_bf16 a[48:63], a[228:231], v[196:199], a[48:63]
ds_read_b64_tr_b16 a[224:225], v246 offset:640
ds_read_b64_tr_b16 a[226:227], v246 offset:7808
buffer_load_dwordx4 v233, s[24:27], s44 offen offset:1024 lds
s_waitcnt lgkmcnt(10)
v_mfma_f32_32x32x16_bf16 a[64:79], a[232:235], v[196:199], a[64:79]
ds_read_b64_tr_b16 a[228:229], v247 offset:640
ds_read_b64_tr_b16 a[230:231], v247 offset:7808
v_mfma_f32_32x32x16_bf16 a[80:95], a[236:239], v[196:199], a[80:95]
ds_read_b64_tr_b16 a[232:233], v246 offset:768
ds_read_b64_tr_b16 a[234:235], v246 offset:7936
s_waitcnt lgkmcnt(10)
v_mfma_f32_32x32x16_bf16 a[96:111], a[240:243], v[196:199], a[96:111]
ds_read_b64_tr_b16 a[236:237], v247 offset:768
ds_read_b64_tr_b16 a[238:239], v247 offset:7936
v_mfma_f32_32x32x16_bf16 a[112:127], a[244:247], v[196:199], a[112:127]
v_add_u32 v244, 0x20000, v244
ds_read_b64_tr_b16 a[240:241], v244 offset:0
ds_read_b64_tr_b16 a[242:243], v244 offset:1024
buffer_load_dwordx4 v234, s[24:27], s44 offen offset:2048 lds
s_waitcnt lgkmcnt(10)
v_mfma_f32_32x32x16_bf16 a[128:143], a[248:251], v[196:199], a[128:143]
v_add_u32 v245, 0x20000, v245
ds_read_b64_tr_b16 a[244:245], v245 offset:0
ds_read_b64_tr_b16 a[246:247], v245 offset:1024
v_mfma_f32_32x32x16_bf16 a[144:159], a[252:255], v[196:199], a[144:159]
ds_read_b64_tr_b16 a[248:249], v244 offset:2048
ds_read_b64_tr_b16 a[250:251], v244 offset:3072
s_waitcnt lgkmcnt(10)
v_mfma_f32_32x32x16_bf16 a[160:175], a[224:227], v[196:199], a[160:175]
ds_read_b64_tr_b16 a[252:253], v245 offset:2048
ds_read_b64_tr_b16 a[254:255], v245 offset:3072
buffer_load_dwordx4 v235, s[24:27], s44 offen offset:3072 lds
v_mfma_f32_32x32x16_bf16 a[176:191], a[228:231], v[196:199], a[176:191]
ds_read_b64_tr_b16 a[224:225], v244 offset:4096
ds_read_b64_tr_b16 a[226:227], v244 offset:5120
s_waitcnt lgkmcnt(10)
v_mfma_f32_32x32x16_bf16 a[192:207], a[232:235], v[196:199], a[192:207]
ds_read_b64_tr_b16 a[228:229], v245 offset:4096
ds_read_b64_tr_b16 a[230:231], v245 offset:5120
v_mfma_f32_32x32x16_bf16 a[208:223], a[236:239], v[196:199], a[208:223]
ds_read_b64_tr_b16 a[232:233], v244 offset:6144
ds_read_b64_tr_b16 a[234:235], v244 offset:7168
s_waitcnt vmcnt(20)
s_barrier
s_waitcnt lgkmcnt(10)
v_mfma_f32_32x32x16_bf16 v[128:143], a[240:243], v[64:67], v[128:143]
ds_read_b64_tr_b16 a[236:237], v245 offset:6144
ds_read_b64_tr_b16 a[238:239], v245 offset:7168
s_add_u32 m0, s6, 65536
s_add_u32 s44, s70, 131072
buffer_load_dwordx4 v228, s[20:23], s44 offen offset:0 nt lds
v_mfma_f32_32x32x16_bf16 v[144:159], a[244:247], v[64:67], v[144:159]
ds_read_b64_tr_b16 a[240:241], v244 offset:8192
ds_read_b64_tr_b16 a[242:243], v244 offset:9216
s_waitcnt lgkmcnt(10)
v_mfma_f32_32x32x16_bf16 v[128:143], a[248:251], v[68:71], v[128:143]
ds_read_b64_tr_b16 a[244:245], v245 offset:8192
ds_read_b64_tr_b16 a[246:247], v245 offset:9216
v_mfma_f32_32x32x16_bf16 v[144:159], a[252:255], v[68:71], v[144:159]
ds_read_b64_tr_b16 a[248:249], v244 offset:10240
ds_read_b64_tr_b16 a[250:251], v244 offset:11264
s_waitcnt lgkmcnt(10)
v_mfma_f32_32x32x16_bf16 v[128:143], a[224:227], v[72:75], v[128:143]
ds_read_b64_tr_b16 a[252:253], v245 offset:10240
ds_read_b64_tr_b16 a[254:255], v245 offset:11264
buffer_load_dwordx4 v229, s[20:23], s44 offen offset:1024 nt lds
v_mfma_f32_32x32x16_bf16 v[144:159], a[228:231], v[72:75], v[144:159]
ds_read_b64_tr_b16 a[224:225], v244 offset:12288
ds_read_b64_tr_b16 a[226:227], v244 offset:13312
s_waitcnt lgkmcnt(10)
v_mfma_f32_32x32x16_bf16 v[128:143], a[232:235], v[76:79], v[128:143]
ds_read_b64_tr_b16 a[228:229], v245 offset:12288
ds_read_b64_tr_b16 a[230:231], v245 offset:13312
v_mfma_f32_32x32x16_bf16 v[144:159], a[236:239], v[76:79], v[144:159]
ds_read_b64_tr_b16 a[232:233], v244 offset:14336
ds_read_b64_tr_b16 a[234:235], v244 offset:15360
s_waitcnt lgkmcnt(10)
v_mfma_f32_32x32x16_bf16 v[128:143], a[240:243], v[80:83], v[128:143]
ds_read_b64_tr_b16 a[236:237], v245 offset:14336
ds_read_b64_tr_b16 a[238:239], v245 offset:15360
buffer_load_dwordx4 v230, s[20:23], s44 offen offset:2048 nt lds
v_mfma_f32_32x32x16_bf16 v[144:159], a[244:247], v[80:83], v[144:159]
v_add_u32 v246, 0xfffe8000, v246
ds_read_b64_tr_b16 a[240:241], v246 offset:0
ds_read_b64_tr_b16 a[242:243], v246 offset:7168
s_waitcnt lgkmcnt(10)
v_mfma_f32_32x32x16_bf16 v[128:143], a[248:251], v[84:87], v[128:143]
v_add_u32 v247, 0xfffe8000, v247
ds_read_b64_tr_b16 a[244:245], v247 offset:0
ds_read_b64_tr_b16 a[246:247], v247 offset:7168
v_mfma_f32_32x32x16_bf16 v[144:159], a[252:255], v[84:87], v[144:159]
ds_read_b64_tr_b16 a[248:249], v246 offset:128
ds_read_b64_tr_b16 a[250:251], v246 offset:7296
s_waitcnt lgkmcnt(10)
v_mfma_f32_32x32x16_bf16 v[128:143], a[224:227], v[88:91], v[128:143]
ds_read_b64_tr_b16 a[252:253], v247 offset:128
ds_read_b64_tr_b16 a[254:255], v247 offset:7296
buffer_load_dwordx4 v231, s[20:23], s44 offen offset:3072 nt lds
v_mfma_f32_32x32x16_bf16 v[144:159], a[228:231], v[88:91], v[144:159]
ds_read_b64_tr_b16 a[224:225], v246 offset:256
ds_read_b64_tr_b16 a[226:227], v246 offset:7424
s_waitcnt lgkmcnt(10)
v_mfma_f32_32x32x16_bf16 v[128:143], a[232:235], v[92:95], v[128:143]
ds_read_b64_tr_b16 a[228:229], v247 offset:256
ds_read_b64_tr_b16 a[230:231], v247 offset:7424
v_mfma_f32_32x32x16_bf16 v[144:159], a[236:239], v[92:95], v[144:159]
ds_read_b64_tr_b16 a[232:233], v246 offset:384
ds_read_b64_tr_b16 a[234:235], v246 offset:7552
s_waitcnt vmcnt(16)
s_barrier
s_waitcnt lgkmcnt(10)
v_mfma_f32_32x32x16_bf16 a[0:15], a[240:243], v[200:203], a[0:15]
ds_read_b64_tr_b16 a[236:237], v247 offset:384
ds_read_b64_tr_b16 a[238:239], v247 offset:7552
s_add_u32 m0, s6, 16384
s_add_u32 s44, s73, 14336
buffer_load_dwordx4 v232, s[24:27], s44 offen offset:0 lds
v_mfma_f32_32x32x16_bf16 a[16:31], a[244:247], v[200:203], a[16:31]
ds_read_b64_tr_b16 a[240:241], v246 offset:512
ds_read_b64_tr_b16 a[242:243], v246 offset:7680
s_waitcnt lgkmcnt(10)
v_mfma_f32_32x32x16_bf16 a[32:47], a[248:251], v[200:203], a[32:47]
ds_read_b64_tr_b16 a[244:245], v247 offset:512
ds_read_b64_tr_b16 a[246:247], v247 offset:7680
v_mfma_f32_32x32x16_bf16 a[48:63], a[252:255], v[200:203], a[48:63]
ds_read_b64_tr_b16 a[248:249], v246 offset:640
ds_read_b64_tr_b16 a[250:251], v246 offset:7808
buffer_load_dwordx4 v233, s[24:27], s44 offen offset:1024 lds
s_waitcnt lgkmcnt(10)
v_mfma_f32_32x32x16_bf16 a[64:79], a[224:227], v[200:203], a[64:79]
ds_read_b64_tr_b16 a[252:253], v247 offset:640
ds_read_b64_tr_b16 a[254:255], v247 offset:7808
v_mfma_f32_32x32x16_bf16 a[80:95], a[228:231], v[200:203], a[80:95]
ds_read_b64_tr_b16 a[224:225], v246 offset:768
ds_read_b64_tr_b16 a[226:227], v246 offset:7936
s_waitcnt lgkmcnt(10)
v_mfma_f32_32x32x16_bf16 a[96:111], a[232:235], v[200:203], a[96:111]
ds_read_b64_tr_b16 a[228:229], v247 offset:768
ds_read_b64_tr_b16 a[230:231], v247 offset:7936
v_mfma_f32_32x32x16_bf16 a[112:127], a[236:239], v[200:203], a[112:127]
v_add_u32 v246, 0xc000, v246
ds_read_b64_tr_b16 a[232:233], v246 offset:0
ds_read_b64_tr_b16 a[234:235], v246 offset:7168
buffer_load_dwordx4 v234, s[24:27], s44 offen offset:2048 lds
s_waitcnt lgkmcnt(10)
v_mfma_f32_32x32x16_bf16 a[128:143], a[240:243], v[200:203], a[128:143]
v_add_u32 v247, 0xc000, v247
ds_read_b64_tr_b16 a[236:237], v247 offset:0
ds_read_b64_tr_b16 a[238:239], v247 offset:7168
v_mfma_f32_32x32x16_bf16 a[144:159], a[244:247], v[200:203], a[144:159]
ds_read_b64_tr_b16 a[240:241], v246 offset:128
ds_read_b64_tr_b16 a[242:243], v246 offset:7296
s_waitcnt lgkmcnt(10)
v_mfma_f32_32x32x16_bf16 a[160:175], a[248:251], v[200:203], a[160:175]
ds_read_b64_tr_b16 a[244:245], v247 offset:128
ds_read_b64_tr_b16 a[246:247], v247 offset:7296
buffer_load_dwordx4 v235, s[24:27], s44 offen offset:3072 lds
v_mfma_f32_32x32x16_bf16 a[176:191], a[252:255], v[200:203], a[176:191]
ds_read_b64_tr_b16 a[248:249], v246 offset:256
ds_read_b64_tr_b16 a[250:251], v246 offset:7424
s_waitcnt lgkmcnt(10)
v_mfma_f32_32x32x16_bf16 a[192:207], a[224:227], v[200:203], a[192:207]
ds_read_b64_tr_b16 a[252:253], v247 offset:256
ds_read_b64_tr_b16 a[254:255], v247 offset:7424
v_mfma_f32_32x32x16_bf16 a[208:223], a[228:231], v[200:203], a[208:223]
ds_read_b64_tr_b16 a[224:225], v246 offset:384
ds_read_b64_tr_b16 a[226:227], v246 offset:7552
s_barrier
s_waitcnt lgkmcnt(10)
v_mfma_f32_32x32x16_bf16 a[0:15], a[232:235], v[204:207], a[0:15]
ds_read_b64_tr_b16 a[228:229], v247 offset:384
ds_read_b64_tr_b16 a[230:231], v247 offset:7552
v_mfma_f32_32x32x16_bf16 a[16:31], a[236:239], v[204:207], a[16:31]
ds_read_b64_tr_b16 a[232:233], v246 offset:512
ds_read_b64_tr_b16 a[234:235], v246 offset:7680
s_waitcnt lgkmcnt(10)
v_mfma_f32_32x32x16_bf16 a[32:47], a[240:243], v[204:207], a[32:47]
ds_read_b64_tr_b16 a[236:237], v247 offset:512
ds_read_b64_tr_b16 a[238:239], v247 offset:7680
v_mfma_f32_32x32x16_bf16 a[48:63], a[244:247], v[204:207], a[48:63]
ds_read_b64_tr_b16 a[240:241], v246 offset:640
ds_read_b64_tr_b16 a[242:243], v246 offset:7808
s_waitcnt lgkmcnt(10)
v_mfma_f32_32x32x16_bf16 a[64:79], a[248:251], v[204:207], a[64:79]
ds_read_b64_tr_b16 a[244:245], v247 offset:640
ds_read_b64_tr_b16 a[246:247], v247 offset:7808
v_mfma_f32_32x32x16_bf16 a[80:95], a[252:255], v[204:207], a[80:95]
ds_read_b64_tr_b16 a[248:249], v246 offset:768
ds_read_b64_tr_b16 a[250:251], v246 offset:7936
s_waitcnt lgkmcnt(10)
v_mfma_f32_32x32x16_bf16 a[96:111], a[224:227], v[204:207], a[96:111]
ds_read_b64_tr_b16 a[252:253], v247 offset:768
ds_read_b64_tr_b16 a[254:255], v247 offset:7936
v_mfma_f32_32x32x16_bf16 a[112:127], a[228:231], v[204:207], a[112:127]
v_add_u32 v244, 0xfffe8000, v244
ds_read_b64_tr_b16 a[224:225], v244 offset:0
ds_read_b64_tr_b16 a[226:227], v244 offset:1024
s_waitcnt lgkmcnt(10)
v_mfma_f32_32x32x16_bf16 a[128:143], a[232:235], v[204:207], a[128:143]
v_add_u32 v245, 0xfffe8000, v245
ds_read_b64_tr_b16 a[228:229], v245 offset:0
ds_read_b64_tr_b16 a[230:231], v245 offset:1024
v_mfma_f32_32x32x16_bf16 a[144:159], a[236:239], v[204:207], a[144:159]
ds_read_b64_tr_b16 a[232:233], v244 offset:2048
ds_read_b64_tr_b16 a[234:235], v244 offset:3072
s_waitcnt lgkmcnt(10)
v_mfma_f32_32x32x16_bf16 a[160:175], a[240:243], v[204:207], a[160:175]
ds_read_b64_tr_b16 a[236:237], v245 offset:2048
ds_read_b64_tr_b16 a[238:239], v245 offset:3072
v_mfma_f32_32x32x16_bf16 a[176:191], a[244:247], v[204:207], a[176:191]
ds_read_b64_tr_b16 a[240:241], v244 offset:4096
ds_read_b64_tr_b16 a[242:243], v244 offset:5120
s_waitcnt lgkmcnt(10)
v_mfma_f32_32x32x16_bf16 a[192:207], a[248:251], v[204:207], a[192:207]
ds_read_b64_tr_b16 a[244:245], v245 offset:4096
ds_read_b64_tr_b16 a[246:247], v245 offset:5120
v_mfma_f32_32x32x16_bf16 a[208:223], a[252:255], v[204:207], a[208:223]
ds_read_b64_tr_b16 a[248:249], v244 offset:6144
ds_read_b64_tr_b16 a[250:251], v244 offset:7168
s_waitcnt vmcnt(16)
s_barrier
s_waitcnt lgkmcnt(10)
v_mfma_f32_32x32x16_bf16 v[128:143], a[224:227], v[96:99], v[128:143]
ds_read_b64_tr_b16 a[252:253], v245 offset:6144
ds_read_b64_tr_b16 a[254:255], v245 offset:7168
s_add_u32 m0, s6, 131072
s_add_u32 s44, s73, 28672
buffer_load_dwordx4 v232, s[24:27], s44 offen offset:0 lds
v_mfma_f32_32x32x16_bf16 v[144:159], a[228:231], v[96:99], v[144:159]
ds_read_b64_tr_b16 a[224:225], v244 offset:8192
ds_read_b64_tr_b16 a[226:227], v244 offset:9216
s_waitcnt lgkmcnt(10)
v_mfma_f32_32x32x16_bf16 v[128:143], a[232:235], v[100:103], v[128:143]
ds_read_b64_tr_b16 a[228:229], v245 offset:8192
ds_read_b64_tr_b16 a[230:231], v245 offset:9216
buffer_load_dwordx4 v233, s[24:27], s44 offen offset:1024 lds
v_mfma_f32_32x32x16_bf16 v[144:159], a[236:239], v[100:103], v[144:159]
ds_read_b64_tr_b16 a[232:233], v244 offset:10240
ds_read_b64_tr_b16 a[234:235], v244 offset:11264
s_waitcnt lgkmcnt(10)
v_mfma_f32_32x32x16_bf16 v[128:143], a[240:243], v[104:107], v[128:143]
ds_read_b64_tr_b16 a[236:237], v245 offset:10240
ds_read_b64_tr_b16 a[238:239], v245 offset:11264
buffer_load_dwordx4 v234, s[24:27], s44 offen offset:2048 lds
v_mfma_f32_32x32x16_bf16 v[144:159], a[244:247], v[104:107], v[144:159]
ds_read_b64_tr_b16 a[240:241], v244 offset:12288
ds_read_b64_tr_b16 a[242:243], v244 offset:13312
s_waitcnt lgkmcnt(10)
v_mfma_f32_32x32x16_bf16 v[128:143], a[248:251], v[108:111], v[128:143]
ds_read_b64_tr_b16 a[244:245], v245 offset:12288
ds_read_b64_tr_b16 a[246:247], v245 offset:13312
buffer_load_dwordx4 v235, s[24:27], s44 offen offset:3072 lds
v_mfma_f32_32x32x16_bf16 v[144:159], a[252:255], v[108:111], v[144:159]
ds_read_b64_tr_b16 a[248:249], v244 offset:14336
ds_read_b64_tr_b16 a[250:251], v244 offset:15360
s_waitcnt lgkmcnt(10)
v_mfma_f32_32x32x16_bf16 v[128:143], a[224:227], v[112:115], v[128:143]
ds_read_b64_tr_b16 a[252:253], v245 offset:14336
ds_read_b64_tr_b16 a[254:255], v245 offset:15360
s_add_u32 m0, s6, 147456
s_add_u32 s44, s70, 196608
buffer_load_dwordx4 v228, s[20:23], s44 offen offset:0 nt lds
v_mfma_f32_32x32x16_bf16 v[144:159], a[228:231], v[112:115], v[144:159]
v_add_u32 v244, 0x10000, v244
ds_read_b64_tr_b16 a[224:225], v244 offset:0
ds_read_b64_tr_b16 a[226:227], v244 offset:1024
s_waitcnt lgkmcnt(10)
v_mfma_f32_32x32x16_bf16 v[128:143], a[232:235], v[116:119], v[128:143]
v_add_u32 v245, 0x10000, v245
ds_read_b64_tr_b16 a[228:229], v245 offset:0
ds_read_b64_tr_b16 a[230:231], v245 offset:1024
buffer_load_dwordx4 v229, s[20:23], s44 offen offset:1024 nt lds
v_mfma_f32_32x32x16_bf16 v[144:159], a[236:239], v[116:119], v[144:159]
ds_read_b64_tr_b16 a[232:233], v244 offset:2048
ds_read_b64_tr_b16 a[234:235], v244 offset:3072
s_waitcnt lgkmcnt(10)
v_mfma_f32_32x32x16_bf16 v[128:143], a[240:243], v[120:123], v[128:143]
ds_read_b64_tr_b16 a[236:237], v245 offset:2048
ds_read_b64_tr_b16 a[238:239], v245 offset:3072
buffer_load_dwordx4 v230, s[20:23], s44 offen offset:2048 nt lds
v_mfma_f32_32x32x16_bf16 v[144:159], a[244:247], v[120:123], v[144:159]
ds_read_b64_tr_b16 a[240:241], v244 offset:4096
ds_read_b64_tr_b16 a[242:243], v244 offset:5120
s_waitcnt lgkmcnt(10)
v_mfma_f32_32x32x16_bf16 v[128:143], a[248:251], v[124:127], v[128:143]
ds_read_b64_tr_b16 a[244:245], v245 offset:4096
ds_read_b64_tr_b16 a[246:247], v245 offset:5120
buffer_load_dwordx4 v231, s[20:23], s44 offen offset:3072 nt lds
v_mfma_f32_32x32x16_bf16 v[144:159], a[252:255], v[124:127], v[144:159]
ds_read_b64_tr_b16 a[248:249], v244 offset:6144
ds_read_b64_tr_b16 a[250:251], v244 offset:7168
s_waitcnt vmcnt(16)
s_barrier
s_waitcnt lgkmcnt(10)
v_mfma_f32_32x32x16_bf16 v[160:175], a[224:227], v[0:3], 0
ds_read_b64_tr_b16 a[252:253], v245 offset:6144
ds_read_b64_tr_b16 a[254:255], v245 offset:7168
s_add_u32 m0, s6, 32768
s_add_u32 s44, s73, 43008
buffer_load_dwordx4 v232, s[24:27], s44 offen offset:0 lds
v_mfma_f32_32x32x16_bf16 v[176:191], a[228:231], v[0:3], 0
ds_read_b64_tr_b16 a[224:225], v244 offset:8192
ds_read_b64_tr_b16 a[226:227], v244 offset:9216
s_waitcnt lgkmcnt(10)
v_mfma_f32_32x32x16_bf16 v[160:175], a[232:235], v[4:7], v[160:175]
ds_read_b64_tr_b16 a[228:229], v245 offset:8192
ds_read_b64_tr_b16 a[230:231], v245 offset:9216
buffer_load_dwordx4 v233, s[24:27], s44 offen offset:1024 lds
v_mfma_f32_32x32x16_bf16 v[176:191], a[236:239], v[4:7], v[176:191]
ds_read_b64_tr_b16 a[232:233], v244 offset:10240
ds_read_b64_tr_b16 a[234:235], v244 offset:11264
v_mul_f32 v128, v128, v250
v_mul_f32 v129, v129, v250
v_mul_f32 v130, v130, v250
v_mul_f32 v131, v131, v250
s_waitcnt lgkmcnt(10)
v_mfma_f32_32x32x16_bf16 v[160:175], a[240:243], v[8:11], v[160:175]
ds_read_b64_tr_b16 a[236:237], v245 offset:10240
ds_read_b64_tr_b16 a[238:239], v245 offset:11264
buffer_load_dwordx4 v234, s[24:27], s44 offen offset:2048 lds
v_mul_f32 v132, v132, v250
v_mul_f32 v133, v133, v250
v_mul_f32 v134, v134, v250
v_mul_f32 v135, v135, v250
v_mfma_f32_32x32x16_bf16 v[176:191], a[244:247], v[8:11], v[176:191]
ds_read_b64_tr_b16 a[240:241], v244 offset:12288
ds_read_b64_tr_b16 a[242:243], v244 offset:13312
v_mul_f32 v136, v136, v250
v_mul_f32 v137, v137, v250
v_mul_f32 v138, v138, v250
v_mul_f32 v139, v139, v250
s_waitcnt lgkmcnt(10)
v_mfma_f32_32x32x16_bf16 v[160:175], a[248:251], v[12:15], v[160:175]
ds_read_b64_tr_b16 a[244:245], v245 offset:12288
ds_read_b64_tr_b16 a[246:247], v245 offset:13312
buffer_load_dwordx4 v235, s[24:27], s44 offen offset:3072 lds
v_mul_f32 v140, v140, v250
v_mul_f32 v141, v141, v250
v_mul_f32 v142, v142, v250
v_mul_f32 v143, v143, v250
v_mfma_f32_32x32x16_bf16 v[176:191], a[252:255], v[12:15], v[176:191]
ds_read_b64_tr_b16 a[248:249], v244 offset:14336
ds_read_b64_tr_b16 a[250:251], v244 offset:15360
v_mul_f32 v144, v144, v250
v_mul_f32 v145, v145, v250
v_mul_f32 v146, v146, v250
v_mul_f32 v147, v147, v250
s_waitcnt lgkmcnt(10)
v_mfma_f32_32x32x16_bf16 v[160:175], a[224:227], v[16:19], v[160:175]
ds_read_b64_tr_b16 a[252:253], v245 offset:14336
ds_read_b64_tr_b16 a[254:255], v245 offset:15360
s_add_u32 m0, s6, 81920
s_add_u32 s44, s71, 0
buffer_load_dwordx4 v228, s[20:23], s44 offen offset:0 nt lds
v_mul_f32 v148, v148, v250
v_mul_f32 v149, v149, v250
v_mul_f32 v150, v150, v250
v_mul_f32 v151, v151, v250
v_mfma_f32_32x32x16_bf16 v[176:191], a[228:231], v[16:19], v[176:191]
v_add_u32 v246, 0x4000, v246
ds_read_b64_tr_b16 a[224:225], v246 offset:0
ds_read_b64_tr_b16 a[226:227], v246 offset:7168
v_mul_f32 v152, v152, v250
v_mul_f32 v153, v153, v250
v_mul_f32 v154, v154, v250
s_waitcnt lgkmcnt(10)
v_mfma_f32_32x32x16_bf16 v[160:175], a[232:235], v[20:23], v[160:175]
v_add_u32 v247, 0x4000, v247
ds_read_b64_tr_b16 a[228:229], v247 offset:0
ds_read_b64_tr_b16 a[230:231], v247 offset:7168
buffer_load_dwordx4 v229, s[20:23], s44 offen offset:1024 nt lds
v_mul_f32 v155, v155, v250
v_mul_f32 v156, v156, v250
v_mul_f32 v157, v157, v250
v_mul_f32 v158, v158, v250
v_mfma_f32_32x32x16_bf16 v[176:191], a[236:239], v[20:23], v[176:191]
ds_read_b64_tr_b16 a[232:233], v246 offset:128
ds_read_b64_tr_b16 a[234:235], v246 offset:7296
v_mul_f32 v159, v159, v250
v_cvt_pk_bf16_f32 v192, v128, v129
v_cvt_pk_bf16_f32 v193, v130, v131
s_waitcnt lgkmcnt(10)
v_mfma_f32_32x32x16_bf16 v[160:175], a[240:243], v[24:27], v[160:175]
ds_read_b64_tr_b16 a[236:237], v247 offset:128
ds_read_b64_tr_b16 a[238:239], v247 offset:7296
buffer_load_dwordx4 v230, s[20:23], s44 offen offset:2048 nt lds
v_cvt_pk_bf16_f32 v194, v132, v133
v_cvt_pk_bf16_f32 v195, v134, v135
v_cvt_pk_bf16_f32 v196, v136, v137
v_cvt_pk_bf16_f32 v197, v138, v139
v_mfma_f32_32x32x16_bf16 v[176:191], a[244:247], v[24:27], v[176:191]
ds_read_b64_tr_b16 a[240:241], v246 offset:256
ds_read_b64_tr_b16 a[242:243], v246 offset:7424
v_cvt_pk_bf16_f32 v198, v140, v141
v_cvt_pk_bf16_f32 v199, v142, v143
v_cvt_pk_bf16_f32 v200, v144, v145
s_waitcnt lgkmcnt(10)
v_mfma_f32_32x32x16_bf16 v[160:175], a[248:251], v[28:31], v[160:175]
ds_read_b64_tr_b16 a[244:245], v247 offset:256
ds_read_b64_tr_b16 a[246:247], v247 offset:7424
buffer_load_dwordx4 v231, s[20:23], s44 offen offset:3072 nt lds
v_cvt_pk_bf16_f32 v201, v146, v147
v_cvt_pk_bf16_f32 v202, v148, v149
v_cvt_pk_bf16_f32 v203, v150, v151
v_cvt_pk_bf16_f32 v204, v152, v153
v_mfma_f32_32x32x16_bf16 v[176:191], a[252:255], v[28:31], v[176:191]
ds_read_b64_tr_b16 a[248:249], v246 offset:384
ds_read_b64_tr_b16 a[250:251], v246 offset:7552
v_cvt_pk_bf16_f32 v205, v154, v155
v_cvt_pk_bf16_f32 v206, v156, v157
v_cvt_pk_bf16_f32 v207, v158, v159
s_barrier
s_waitcnt lgkmcnt(10)
v_mfma_f32_32x32x16_bf16 a[0:15], a[224:227], v[192:195], a[0:15]
ds_read_b64_tr_b16 a[252:253], v247 offset:384
ds_read_b64_tr_b16 a[254:255], v247 offset:7552
v_mfma_f32_32x32x16_bf16 a[16:31], a[228:231], v[192:195], a[16:31]
ds_read_b64_tr_b16 a[224:225], v246 offset:512
ds_read_b64_tr_b16 a[226:227], v246 offset:7680
s_waitcnt lgkmcnt(10)
v_mfma_f32_32x32x16_bf16 a[32:47], a[232:235], v[192:195], a[32:47]
ds_read_b64_tr_b16 a[228:229], v247 offset:512
ds_read_b64_tr_b16 a[230:231], v247 offset:7680
v_mfma_f32_32x32x16_bf16 a[48:63], a[236:239], v[192:195], a[48:63]
ds_read_b64_tr_b16 a[232:233], v246 offset:640
ds_read_b64_tr_b16 a[234:235], v246 offset:7808
s_waitcnt lgkmcnt(10)
v_mfma_f32_32x32x16_bf16 a[64:79], a[240:243], v[192:195], a[64:79]
ds_read_b64_tr_b16 a[236:237], v247 offset:640
ds_read_b64_tr_b16 a[238:239], v247 offset:7808
v_mfma_f32_32x32x16_bf16 a[80:95], a[244:247], v[192:195], a[80:95]
ds_read_b64_tr_b16 a[240:241], v246 offset:768
ds_read_b64_tr_b16 a[242:243], v246 offset:7936
s_waitcnt lgkmcnt(10)
v_mfma_f32_32x32x16_bf16 a[96:111], a[248:251], v[192:195], a[96:111]
ds_read_b64_tr_b16 a[244:245], v247 offset:768
ds_read_b64_tr_b16 a[246:247], v247 offset:7936
v_mfma_f32_32x32x16_bf16 a[112:127], a[252:255], v[192:195], a[112:127]
v_add_u32 v244, 0xfffe4000, v244
ds_read_b64_tr_b16 a[248:249], v244 offset:0
ds_read_b64_tr_b16 a[250:251], v244 offset:1024
s_waitcnt lgkmcnt(10)
v_mfma_f32_32x32x16_bf16 a[128:143], a[224:227], v[192:195], a[128:143]
v_add_u32 v245, 0xfffe4000, v245
ds_read_b64_tr_b16 a[252:253], v245 offset:0
ds_read_b64_tr_b16 a[254:255], v245 offset:1024
v_mfma_f32_32x32x16_bf16 a[144:159], a[228:231], v[192:195], a[144:159]
ds_read_b64_tr_b16 a[224:225], v244 offset:2048
ds_read_b64_tr_b16 a[226:227], v244 offset:3072
s_waitcnt lgkmcnt(10)
v_mfma_f32_32x32x16_bf16 a[160:175], a[232:235], v[192:195], a[160:175]
ds_read_b64_tr_b16 a[228:229], v245 offset:2048
ds_read_b64_tr_b16 a[230:231], v245 offset:3072
v_mfma_f32_32x32x16_bf16 a[176:191], a[236:239], v[192:195], a[176:191]
ds_read_b64_tr_b16 a[232:233], v244 offset:4096
ds_read_b64_tr_b16 a[234:235], v244 offset:5120
s_waitcnt lgkmcnt(10)
v_mfma_f32_32x32x16_bf16 a[192:207], a[240:243], v[192:195], a[192:207]
ds_read_b64_tr_b16 a[236:237], v245 offset:4096
ds_read_b64_tr_b16 a[238:239], v245 offset:5120
v_mfma_f32_32x32x16_bf16 a[208:223], a[244:247], v[192:195], a[208:223]
ds_read_b64_tr_b16 a[240:241], v244 offset:6144
ds_read_b64_tr_b16 a[242:243], v244 offset:7168
s_waitcnt vmcnt(16)
s_barrier
s_waitcnt lgkmcnt(10)
v_mfma_f32_32x32x16_bf16 v[160:175], a[248:251], v[32:35], v[160:175]
ds_read_b64_tr_b16 a[244:245], v245 offset:6144
ds_read_b64_tr_b16 a[246:247], v245 offset:7168
s_add_u32 m0, s6, 49152
s_add_u32 s44, s71, 65536
buffer_load_dwordx4 v228, s[20:23], s44 offen offset:0 nt lds
v_mfma_f32_32x32x16_bf16 v[176:191], a[252:255], v[32:35], v[176:191]
ds_read_b64_tr_b16 a[248:249], v244 offset:8192
ds_read_b64_tr_b16 a[250:251], v244 offset:9216
s_waitcnt lgkmcnt(10)
v_mfma_f32_32x32x16_bf16 v[160:175], a[224:227], v[36:39], v[160:175]
ds_read_b64_tr_b16 a[252:253], v245 offset:8192
ds_read_b64_tr_b16 a[254:255], v245 offset:9216
v_mfma_f32_32x32x16_bf16 v[176:191], a[228:231], v[36:39], v[176:191]
ds_read_b64_tr_b16 a[224:225], v244 offset:10240
ds_read_b64_tr_b16 a[226:227], v244 offset:11264
s_waitcnt lgkmcnt(10)
v_mfma_f32_32x32x16_bf16 v[160:175], a[232:235], v[40:43], v[160:175]
ds_read_b64_tr_b16 a[228:229], v245 offset:10240
ds_read_b64_tr_b16 a[230:231], v245 offset:11264
buffer_load_dwordx4 v229, s[20:23], s44 offen offset:1024 nt lds
v_mfma_f32_32x32x16_bf16 v[176:191], a[236:239], v[40:43], v[176:191]
ds_read_b64_tr_b16 a[232:233], v244 offset:12288
ds_read_b64_tr_b16 a[234:235], v244 offset:13312
s_waitcnt lgkmcnt(10)
v_mfma_f32_32x32x16_bf16 v[160:175], a[240:243], v[44:47], v[160:175]
ds_read_b64_tr_b16 a[236:237], v245 offset:12288
ds_read_b64_tr_b16 a[238:239], v245 offset:13312
v_mfma_f32_32x32x16_bf16 v[176:191], a[244:247], v[44:47], v[176:191]
ds_read_b64_tr_b16 a[240:241], v244 offset:14336
ds_read_b64_tr_b16 a[242:243], v244 offset:15360
s_waitcnt lgkmcnt(10)
v_mfma_f32_32x32x16_bf16 v[160:175], a[248:251], v[48:51], v[160:175]
ds_read_b64_tr_b16 a[244:245], v245 offset:14336
ds_read_b64_tr_b16 a[246:247], v245 offset:15360
buffer_load_dwordx4 v230, s[20:23], s44 offen offset:2048 nt lds
v_mfma_f32_32x32x16_bf16 v[176:191], a[252:255], v[48:51], v[176:191]
v_add_u32 v246, 0xfffec000, v246
ds_read_b64_tr_b16 a[248:249], v246 offset:0
ds_read_b64_tr_b16 a[250:251], v246 offset:7168
s_waitcnt lgkmcnt(10)
v_mfma_f32_32x32x16_bf16 v[160:175], a[224:227], v[52:55], v[160:175]
v_add_u32 v247, 0xfffec000, v247
ds_read_b64_tr_b16 a[252:253], v247 offset:0
ds_read_b64_tr_b16 a[254:255], v247 offset:7168
v_mfma_f32_32x32x16_bf16 v[176:191], a[228:231], v[52:55], v[176:191]
ds_read_b64_tr_b16 a[224:225], v246 offset:128
ds_read_b64_tr_b16 a[226:227], v246 offset:7296
s_waitcnt lgkmcnt(10)
v_mfma_f32_32x32x16_bf16 v[160:175], a[232:235], v[56:59], v[160:175]
ds_read_b64_tr_b16 a[228:229], v247 offset:128
ds_read_b64_tr_b16 a[230:231], v247 offset:7296
buffer_load_dwordx4 v231, s[20:23], s44 offen offset:3072 nt lds
v_mfma_f32_32x32x16_bf16 v[176:191], a[236:239], v[56:59], v[176:191]
ds_read_b64_tr_b16 a[232:233], v246 offset:256
ds_read_b64_tr_b16 a[234:235], v246 offset:7424
s_waitcnt lgkmcnt(10)
v_mfma_f32_32x32x16_bf16 v[160:175], a[240:243], v[60:63], v[160:175]
ds_read_b64_tr_b16 a[236:237], v247 offset:256
ds_read_b64_tr_b16 a[238:239], v247 offset:7424
v_mfma_f32_32x32x16_bf16 v[176:191], a[244:247], v[60:63], v[176:191]
ds_read_b64_tr_b16 a[240:241], v246 offset:384
ds_read_b64_tr_b16 a[242:243], v246 offset:7552
s_barrier
s_waitcnt lgkmcnt(10)
v_mfma_f32_32x32x16_bf16 a[0:15], a[248:251], v[196:199], a[0:15]
ds_read_b64_tr_b16 a[244:245], v247 offset:384
ds_read_b64_tr_b16 a[246:247], v247 offset:7552
s_add_u32 m0, s6, 114688
s_add_u32 s44, s74, 0
buffer_load_dwordx4 v232, s[24:27], s44 offen offset:0 lds
v_mfma_f32_32x32x16_bf16 a[16:31], a[252:255], v[196:199], a[16:31]
ds_read_b64_tr_b16 a[248:249], v246 offset:512
ds_read_b64_tr_b16 a[250:251], v246 offset:7680
s_waitcnt lgkmcnt(10)
v_mfma_f32_32x32x16_bf16 a[32:47], a[224:227], v[196:199], a[32:47]
ds_read_b64_tr_b16 a[252:253], v247 offset:512
ds_read_b64_tr_b16 a[254:255], v247 offset:7680
v_mfma_f32_32x32x16_bf16 a[48:63], a[228:231], v[196:199], a[48:63]
ds_read_b64_tr_b16 a[224:225], v246 offset:640
ds_read_b64_tr_b16 a[226:227], v246 offset:7808
buffer_load_dwordx4 v233, s[24:27], s44 offen offset:1024 lds
s_waitcnt lgkmcnt(10)
v_mfma_f32_32x32x16_bf16 a[64:79], a[232:235], v[196:199], a[64:79]
ds_read_b64_tr_b16 a[228:229], v247 offset:640
ds_read_b64_tr_b16 a[230:231], v247 offset:7808
v_mfma_f32_32x32x16_bf16 a[80:95], a[236:239], v[196:199], a[80:95]
ds_read_b64_tr_b16 a[232:233], v246 offset:768
ds_read_b64_tr_b16 a[234:235], v246 offset:7936
s_waitcnt lgkmcnt(10)
v_mfma_f32_32x32x16_bf16 a[96:111], a[240:243], v[196:199], a[96:111]
ds_read_b64_tr_b16 a[236:237], v247 offset:768
ds_read_b64_tr_b16 a[238:239], v247 offset:7936
v_mfma_f32_32x32x16_bf16 a[112:127], a[244:247], v[196:199], a[112:127]
v_add_u32 v244, 0x10000, v244
ds_read_b64_tr_b16 a[240:241], v244 offset:0
ds_read_b64_tr_b16 a[242:243], v244 offset:1024
buffer_load_dwordx4 v234, s[24:27], s44 offen offset:2048 lds
s_waitcnt lgkmcnt(10)
v_mfma_f32_32x32x16_bf16 a[128:143], a[248:251], v[196:199], a[128:143]
v_add_u32 v245, 0x10000, v245
ds_read_b64_tr_b16 a[244:245], v245 offset:0
ds_read_b64_tr_b16 a[246:247], v245 offset:1024
v_mfma_f32_32x32x16_bf16 a[144:159], a[252:255], v[196:199], a[144:159]
ds_read_b64_tr_b16 a[248:249], v244 offset:2048
ds_read_b64_tr_b16 a[250:251], v244 offset:3072
s_waitcnt lgkmcnt(10)
v_mfma_f32_32x32x16_bf16 a[160:175], a[224:227], v[196:199], a[160:175]
ds_read_b64_tr_b16 a[252:253], v245 offset:2048
ds_read_b64_tr_b16 a[254:255], v245 offset:3072
buffer_load_dwordx4 v235, s[24:27], s44 offen offset:3072 lds
v_mfma_f32_32x32x16_bf16 a[176:191], a[228:231], v[196:199], a[176:191]
ds_read_b64_tr_b16 a[224:225], v244 offset:4096
ds_read_b64_tr_b16 a[226:227], v244 offset:5120
s_waitcnt lgkmcnt(10)
v_mfma_f32_32x32x16_bf16 a[192:207], a[232:235], v[196:199], a[192:207]
ds_read_b64_tr_b16 a[228:229], v245 offset:4096
ds_read_b64_tr_b16 a[230:231], v245 offset:5120
v_mfma_f32_32x32x16_bf16 a[208:223], a[236:239], v[196:199], a[208:223]
ds_read_b64_tr_b16 a[232:233], v244 offset:6144
ds_read_b64_tr_b16 a[234:235], v244 offset:7168
s_waitcnt vmcnt(20)
s_barrier
s_waitcnt lgkmcnt(10)
v_mfma_f32_32x32x16_bf16 v[160:175], a[240:243], v[64:67], v[160:175]
ds_read_b64_tr_b16 a[236:237], v245 offset:6144
ds_read_b64_tr_b16 a[238:239], v245 offset:7168
s_add_u32 m0, s6, 98304
s_add_u32 s44, s71, 131072
buffer_load_dwordx4 v228, s[20:23], s44 offen offset:0 nt lds
v_mfma_f32_32x32x16_bf16 v[176:191], a[244:247], v[64:67], v[176:191]
ds_read_b64_tr_b16 a[240:241], v244 offset:8192
ds_read_b64_tr_b16 a[242:243], v244 offset:9216
s_waitcnt lgkmcnt(10)
v_mfma_f32_32x32x16_bf16 v[160:175], a[248:251], v[68:71], v[160:175]
ds_read_b64_tr_b16 a[244:245], v245 offset:8192
ds_read_b64_tr_b16 a[246:247], v245 offset:9216
v_mfma_f32_32x32x16_bf16 v[176:191], a[252:255], v[68:71], v[176:191]
ds_read_b64_tr_b16 a[248:249], v244 offset:10240
ds_read_b64_tr_b16 a[250:251], v244 offset:11264
s_waitcnt lgkmcnt(10)
v_mfma_f32_32x32x16_bf16 v[160:175], a[224:227], v[72:75], v[160:175]
ds_read_b64_tr_b16 a[252:253], v245 offset:10240
ds_read_b64_tr_b16 a[254:255], v245 offset:11264
buffer_load_dwordx4 v229, s[20:23], s44 offen offset:1024 nt lds
v_mfma_f32_32x32x16_bf16 v[176:191], a[228:231], v[72:75], v[176:191]
ds_read_b64_tr_b16 a[224:225], v244 offset:12288
ds_read_b64_tr_b16 a[226:227], v244 offset:13312
s_waitcnt lgkmcnt(10)
v_mfma_f32_32x32x16_bf16 v[160:175], a[232:235], v[76:79], v[160:175]
ds_read_b64_tr_b16 a[228:229], v245 offset:12288
ds_read_b64_tr_b16 a[230:231], v245 offset:13312
v_mfma_f32_32x32x16_bf16 v[176:191], a[236:239], v[76:79], v[176:191]
ds_read_b64_tr_b16 a[232:233], v244 offset:14336
ds_read_b64_tr_b16 a[234:235], v244 offset:15360
s_waitcnt lgkmcnt(10)
v_mfma_f32_32x32x16_bf16 v[160:175], a[240:243], v[80:83], v[160:175]
ds_read_b64_tr_b16 a[236:237], v245 offset:14336
ds_read_b64_tr_b16 a[238:239], v245 offset:15360
buffer_load_dwordx4 v230, s[20:23], s44 offen offset:2048 nt lds
v_mfma_f32_32x32x16_bf16 v[176:191], a[244:247], v[80:83], v[176:191]
v_add_u32 v246, 0x1c000, v246
ds_read_b64_tr_b16 a[240:241], v246 offset:0
ds_read_b64_tr_b16 a[242:243], v246 offset:7168
s_waitcnt lgkmcnt(10)
v_mfma_f32_32x32x16_bf16 v[160:175], a[248:251], v[84:87], v[160:175]
v_add_u32 v247, 0x1c000, v247
ds_read_b64_tr_b16 a[244:245], v247 offset:0
ds_read_b64_tr_b16 a[246:247], v247 offset:7168
v_mfma_f32_32x32x16_bf16 v[176:191], a[252:255], v[84:87], v[176:191]
ds_read_b64_tr_b16 a[248:249], v246 offset:128
ds_read_b64_tr_b16 a[250:251], v246 offset:7296
s_waitcnt lgkmcnt(10)
v_mfma_f32_32x32x16_bf16 v[160:175], a[224:227], v[88:91], v[160:175]
ds_read_b64_tr_b16 a[252:253], v247 offset:128
ds_read_b64_tr_b16 a[254:255], v247 offset:7296
buffer_load_dwordx4 v231, s[20:23], s44 offen offset:3072 nt lds
v_mfma_f32_32x32x16_bf16 v[176:191], a[228:231], v[88:91], v[176:191]
ds_read_b64_tr_b16 a[224:225], v246 offset:256
ds_read_b64_tr_b16 a[226:227], v246 offset:7424
s_waitcnt lgkmcnt(10)
v_mfma_f32_32x32x16_bf16 v[160:175], a[232:235], v[92:95], v[160:175]
ds_read_b64_tr_b16 a[228:229], v247 offset:256
ds_read_b64_tr_b16 a[230:231], v247 offset:7424
v_mfma_f32_32x32x16_bf16 v[176:191], a[236:239], v[92:95], v[176:191]
ds_read_b64_tr_b16 a[232:233], v246 offset:384
ds_read_b64_tr_b16 a[234:235], v246 offset:7552
s_waitcnt vmcnt(16)
s_barrier
s_waitcnt lgkmcnt(10)
v_mfma_f32_32x32x16_bf16 a[0:15], a[240:243], v[200:203], a[0:15]
ds_read_b64_tr_b16 a[236:237], v247 offset:384
ds_read_b64_tr_b16 a[238:239], v247 offset:7552
s_add_u32 m0, s6, 0
s_add_u32 s44, s74, 14336
buffer_load_dwordx4 v232, s[24:27], s44 offen offset:0 lds
v_mfma_f32_32x32x16_bf16 a[16:31], a[244:247], v[200:203], a[16:31]
ds_read_b64_tr_b16 a[240:241], v246 offset:512
ds_read_b64_tr_b16 a[242:243], v246 offset:7680
s_waitcnt lgkmcnt(10)
v_mfma_f32_32x32x16_bf16 a[32:47], a[248:251], v[200:203], a[32:47]
ds_read_b64_tr_b16 a[244:245], v247 offset:512
ds_read_b64_tr_b16 a[246:247], v247 offset:7680
v_mfma_f32_32x32x16_bf16 a[48:63], a[252:255], v[200:203], a[48:63]
ds_read_b64_tr_b16 a[248:249], v246 offset:640
ds_read_b64_tr_b16 a[250:251], v246 offset:7808
buffer_load_dwordx4 v233, s[24:27], s44 offen offset:1024 lds
s_waitcnt lgkmcnt(10)
v_mfma_f32_32x32x16_bf16 a[64:79], a[224:227], v[200:203], a[64:79]
ds_read_b64_tr_b16 a[252:253], v247 offset:640
ds_read_b64_tr_b16 a[254:255], v247 offset:7808
v_mfma_f32_32x32x16_bf16 a[80:95], a[228:231], v[200:203], a[80:95]
ds_read_b64_tr_b16 a[224:225], v246 offset:768
ds_read_b64_tr_b16 a[226:227], v246 offset:7936
s_waitcnt lgkmcnt(10)
v_mfma_f32_32x32x16_bf16 a[96:111], a[232:235], v[200:203], a[96:111]
ds_read_b64_tr_b16 a[228:229], v247 offset:768
ds_read_b64_tr_b16 a[230:231], v247 offset:7936
v_mfma_f32_32x32x16_bf16 a[112:127], a[236:239], v[200:203], a[112:127]
v_add_u32 v246, 0xfffe8000, v246
ds_read_b64_tr_b16 a[232:233], v246 offset:0
ds_read_b64_tr_b16 a[234:235], v246 offset:7168
buffer_load_dwordx4 v234, s[24:27], s44 offen offset:2048 lds
s_waitcnt lgkmcnt(10)
v_mfma_f32_32x32x16_bf16 a[128:143], a[240:243], v[200:203], a[128:143]
v_add_u32 v247, 0xfffe8000, v247
ds_read_b64_tr_b16 a[236:237], v247 offset:0
ds_read_b64_tr_b16 a[238:239], v247 offset:7168
v_mfma_f32_32x32x16_bf16 a[144:159], a[244:247], v[200:203], a[144:159]
ds_read_b64_tr_b16 a[240:241], v246 offset:128
ds_read_b64_tr_b16 a[242:243], v246 offset:7296
s_waitcnt lgkmcnt(10)
v_mfma_f32_32x32x16_bf16 a[160:175], a[248:251], v[200:203], a[160:175]
ds_read_b64_tr_b16 a[244:245], v247 offset:128
ds_read_b64_tr_b16 a[246:247], v247 offset:7296
buffer_load_dwordx4 v235, s[24:27], s44 offen offset:3072 lds
v_mfma_f32_32x32x16_bf16 a[176:191], a[252:255], v[200:203], a[176:191]
ds_read_b64_tr_b16 a[248:249], v246 offset:256
ds_read_b64_tr_b16 a[250:251], v246 offset:7424
s_waitcnt lgkmcnt(10)
v_mfma_f32_32x32x16_bf16 a[192:207], a[224:227], v[200:203], a[192:207]
ds_read_b64_tr_b16 a[252:253], v247 offset:256
ds_read_b64_tr_b16 a[254:255], v247 offset:7424
v_mfma_f32_32x32x16_bf16 a[208:223], a[228:231], v[200:203], a[208:223]
ds_read_b64_tr_b16 a[224:225], v246 offset:384
ds_read_b64_tr_b16 a[226:227], v246 offset:7552
s_barrier
s_waitcnt lgkmcnt(10)
v_mfma_f32_32x32x16_bf16 a[0:15], a[232:235], v[204:207], a[0:15]
ds_read_b64_tr_b16 a[228:229], v247 offset:384
ds_read_b64_tr_b16 a[230:231], v247 offset:7552
v_mfma_f32_32x32x16_bf16 a[16:31], a[236:239], v[204:207], a[16:31]
ds_read_b64_tr_b16 a[232:233], v246 offset:512
ds_read_b64_tr_b16 a[234:235], v246 offset:7680
s_waitcnt lgkmcnt(10)
v_mfma_f32_32x32x16_bf16 a[32:47], a[240:243], v[204:207], a[32:47]
ds_read_b64_tr_b16 a[236:237], v247 offset:512
ds_read_b64_tr_b16 a[238:239], v247 offset:7680
v_mfma_f32_32x32x16_bf16 a[48:63], a[244:247], v[204:207], a[48:63]
ds_read_b64_tr_b16 a[240:241], v246 offset:640
ds_read_b64_tr_b16 a[242:243], v246 offset:7808
s_waitcnt lgkmcnt(10)
v_mfma_f32_32x32x16_bf16 a[64:79], a[248:251], v[204:207], a[64:79]
ds_read_b64_tr_b16 a[244:245], v247 offset:640
ds_read_b64_tr_b16 a[246:247], v247 offset:7808
v_mfma_f32_32x32x16_bf16 a[80:95], a[252:255], v[204:207], a[80:95]
ds_read_b64_tr_b16 a[248:249], v246 offset:768
ds_read_b64_tr_b16 a[250:251], v246 offset:7936
s_waitcnt lgkmcnt(10)
v_mfma_f32_32x32x16_bf16 a[96:111], a[224:227], v[204:207], a[96:111]
ds_read_b64_tr_b16 a[252:253], v247 offset:768
ds_read_b64_tr_b16 a[254:255], v247 offset:7936
v_mfma_f32_32x32x16_bf16 a[112:127], a[228:231], v[204:207], a[112:127]
v_add_u32 v244, 0x14000, v244
ds_read_b64_tr_b16 a[224:225], v244 offset:0
ds_read_b64_tr_b16 a[226:227], v244 offset:1024
s_waitcnt lgkmcnt(10)
v_mfma_f32_32x32x16_bf16 a[128:143], a[232:235], v[204:207], a[128:143]
v_add_u32 v245, 0x14000, v245
ds_read_b64_tr_b16 a[228:229], v245 offset:0
ds_read_b64_tr_b16 a[230:231], v245 offset:1024
v_mfma_f32_32x32x16_bf16 a[144:159], a[236:239], v[204:207], a[144:159]
ds_read_b64_tr_b16 a[232:233], v244 offset:2048
ds_read_b64_tr_b16 a[234:235], v244 offset:3072
s_waitcnt lgkmcnt(10)
v_mfma_f32_32x32x16_bf16 a[160:175], a[240:243], v[204:207], a[160:175]
ds_read_b64_tr_b16 a[236:237], v245 offset:2048
ds_read_b64_tr_b16 a[238:239], v245 offset:3072
v_mfma_f32_32x32x16_bf16 a[176:191], a[244:247], v[204:207], a[176:191]
ds_read_b64_tr_b16 a[240:241], v244 offset:4096
ds_read_b64_tr_b16 a[242:243], v244 offset:5120
s_waitcnt lgkmcnt(10)
v_mfma_f32_32x32x16_bf16 a[192:207], a[248:251], v[204:207], a[192:207]
ds_read_b64_tr_b16 a[244:245], v245 offset:4096
ds_read_b64_tr_b16 a[246:247], v245 offset:5120
v_mfma_f32_32x32x16_bf16 a[208:223], a[252:255], v[204:207], a[208:223]
ds_read_b64_tr_b16 a[248:249], v244 offset:6144
ds_read_b64_tr_b16 a[250:251], v244 offset:7168
s_waitcnt vmcnt(16)
s_barrier
s_waitcnt lgkmcnt(10)
v_mfma_f32_32x32x16_bf16 v[160:175], a[224:227], v[96:99], v[160:175]
ds_read_b64_tr_b16 a[252:253], v245 offset:6144
ds_read_b64_tr_b16 a[254:255], v245 offset:7168
s_add_u32 m0, s6, 16384
s_add_u32 s44, s74, 28672
buffer_load_dwordx4 v232, s[24:27], s44 offen offset:0 lds
v_mfma_f32_32x32x16_bf16 v[176:191], a[228:231], v[96:99], v[176:191]
ds_read_b64_tr_b16 a[224:225], v244 offset:8192
ds_read_b64_tr_b16 a[226:227], v244 offset:9216
s_waitcnt lgkmcnt(10)
v_mfma_f32_32x32x16_bf16 v[160:175], a[232:235], v[100:103], v[160:175]
ds_read_b64_tr_b16 a[228:229], v245 offset:8192
ds_read_b64_tr_b16 a[230:231], v245 offset:9216
buffer_load_dwordx4 v233, s[24:27], s44 offen offset:1024 lds
v_mfma_f32_32x32x16_bf16 v[176:191], a[236:239], v[100:103], v[176:191]
ds_read_b64_tr_b16 a[232:233], v244 offset:10240
ds_read_b64_tr_b16 a[234:235], v244 offset:11264
s_waitcnt lgkmcnt(10)
v_mfma_f32_32x32x16_bf16 v[160:175], a[240:243], v[104:107], v[160:175]
ds_read_b64_tr_b16 a[236:237], v245 offset:10240
ds_read_b64_tr_b16 a[238:239], v245 offset:11264
buffer_load_dwordx4 v234, s[24:27], s44 offen offset:2048 lds
v_mfma_f32_32x32x16_bf16 v[176:191], a[244:247], v[104:107], v[176:191]
ds_read_b64_tr_b16 a[240:241], v244 offset:12288
ds_read_b64_tr_b16 a[242:243], v244 offset:13312
s_waitcnt lgkmcnt(10)
v_mfma_f32_32x32x16_bf16 v[160:175], a[248:251], v[108:111], v[160:175]
ds_read_b64_tr_b16 a[244:245], v245 offset:12288
ds_read_b64_tr_b16 a[246:247], v245 offset:13312
buffer_load_dwordx4 v235, s[24:27], s44 offen offset:3072 lds
v_mfma_f32_32x32x16_bf16 v[176:191], a[252:255], v[108:111], v[176:191]
ds_read_b64_tr_b16 a[248:249], v244 offset:14336
ds_read_b64_tr_b16 a[250:251], v244 offset:15360
s_waitcnt lgkmcnt(10)
v_mfma_f32_32x32x16_bf16 v[160:175], a[224:227], v[112:115], v[160:175]
ds_read_b64_tr_b16 a[252:253], v245 offset:14336
ds_read_b64_tr_b16 a[254:255], v245 offset:15360
s_add_u32 m0, s6, 65536
s_add_u32 s44, s71, 196608
buffer_load_dwordx4 v228, s[20:23], s44 offen offset:0 nt lds
v_mfma_f32_32x32x16_bf16 v[176:191], a[228:231], v[112:115], v[176:191]
v_add_u32 v244, 0xffff0000, v244
ds_read_b64_tr_b16 a[224:225], v244 offset:0
ds_read_b64_tr_b16 a[226:227], v244 offset:1024
s_waitcnt lgkmcnt(10)
v_mfma_f32_32x32x16_bf16 v[160:175], a[232:235], v[116:119], v[160:175]
v_add_u32 v245, 0xffff0000, v245
ds_read_b64_tr_b16 a[228:229], v245 offset:0
ds_read_b64_tr_b16 a[230:231], v245 offset:1024
buffer_load_dwordx4 v229, s[20:23], s44 offen offset:1024 nt lds
v_mfma_f32_32x32x16_bf16 v[176:191], a[236:239], v[116:119], v[176:191]
ds_read_b64_tr_b16 a[232:233], v244 offset:2048
ds_read_b64_tr_b16 a[234:235], v244 offset:3072
s_waitcnt lgkmcnt(10)
v_mfma_f32_32x32x16_bf16 v[160:175], a[240:243], v[120:123], v[160:175]
ds_read_b64_tr_b16 a[236:237], v245 offset:2048
ds_read_b64_tr_b16 a[238:239], v245 offset:3072
buffer_load_dwordx4 v230, s[20:23], s44 offen offset:2048 nt lds
v_mfma_f32_32x32x16_bf16 v[176:191], a[244:247], v[120:123], v[176:191]
ds_read_b64_tr_b16 a[240:241], v244 offset:4096
ds_read_b64_tr_b16 a[242:243], v244 offset:5120
s_waitcnt lgkmcnt(10)
v_mfma_f32_32x32x16_bf16 v[160:175], a[248:251], v[124:127], v[160:175]
ds_read_b64_tr_b16 a[244:245], v245 offset:4096
ds_read_b64_tr_b16 a[246:247], v245 offset:5120
buffer_load_dwordx4 v231, s[20:23], s44 offen offset:3072 nt lds
v_mfma_f32_32x32x16_bf16 v[176:191], a[252:255], v[124:127], v[176:191]
ds_read_b64_tr_b16 a[248:249], v244 offset:6144
ds_read_b64_tr_b16 a[250:251], v244 offset:7168
s_waitcnt vmcnt(16)
s_barrier
s_waitcnt lgkmcnt(10)
v_mfma_f32_32x32x16_bf16 v[128:143], a[224:227], v[0:3], 0
ds_read_b64_tr_b16 a[252:253], v245 offset:6144
ds_read_b64_tr_b16 a[254:255], v245 offset:7168
s_add_u32 m0, s6, 131072
s_add_u32 s44, s74, 43008
buffer_load_dwordx4 v232, s[24:27], s44 offen offset:0 lds
v_mfma_f32_32x32x16_bf16 v[144:159], a[228:231], v[0:3], 0
ds_read_b64_tr_b16 a[224:225], v244 offset:8192
ds_read_b64_tr_b16 a[226:227], v244 offset:9216
s_waitcnt lgkmcnt(10)
v_mfma_f32_32x32x16_bf16 v[128:143], a[232:235], v[4:7], v[128:143]
ds_read_b64_tr_b16 a[228:229], v245 offset:8192
ds_read_b64_tr_b16 a[230:231], v245 offset:9216
buffer_load_dwordx4 v233, s[24:27], s44 offen offset:1024 lds
v_mfma_f32_32x32x16_bf16 v[144:159], a[236:239], v[4:7], v[144:159]
ds_read_b64_tr_b16 a[232:233], v244 offset:10240
ds_read_b64_tr_b16 a[234:235], v244 offset:11264
v_mul_f32 v160, v160, v250
v_mul_f32 v161, v161, v250
v_mul_f32 v162, v162, v250
v_mul_f32 v163, v163, v250
s_waitcnt lgkmcnt(10)
v_mfma_f32_32x32x16_bf16 v[128:143], a[240:243], v[8:11], v[128:143]
ds_read_b64_tr_b16 a[236:237], v245 offset:10240
ds_read_b64_tr_b16 a[238:239], v245 offset:11264
buffer_load_dwordx4 v234, s[24:27], s44 offen offset:2048 lds
v_mul_f32 v164, v164, v250
v_mul_f32 v165, v165, v250
v_mul_f32 v166, v166, v250
v_mul_f32 v167, v167, v250
v_mfma_f32_32x32x16_bf16 v[144:159], a[244:247], v[8:11], v[144:159]
ds_read_b64_tr_b16 a[240:241], v244 offset:12288
ds_read_b64_tr_b16 a[242:243], v244 offset:13312
v_mul_f32 v168, v168, v250
v_mul_f32 v169, v169, v250
v_mul_f32 v170, v170, v250
v_mul_f32 v171, v171, v250
s_waitcnt lgkmcnt(10)
v_mfma_f32_32x32x16_bf16 v[128:143], a[248:251], v[12:15], v[128:143]
ds_read_b64_tr_b16 a[244:245], v245 offset:12288
ds_read_b64_tr_b16 a[246:247], v245 offset:13312
buffer_load_dwordx4 v235, s[24:27], s44 offen offset:3072 lds
v_mul_f32 v172, v172, v250
v_mul_f32 v173, v173, v250
v_mul_f32 v174, v174, v250
v_mul_f32 v175, v175, v250
v_mfma_f32_32x32x16_bf16 v[144:159], a[252:255], v[12:15], v[144:159]
ds_read_b64_tr_b16 a[248:249], v244 offset:14336
ds_read_b64_tr_b16 a[250:251], v244 offset:15360
v_mul_f32 v176, v176, v250
v_mul_f32 v177, v177, v250
v_mul_f32 v178, v178, v250
v_mul_f32 v179, v179, v250
s_waitcnt lgkmcnt(10)
v_mfma_f32_32x32x16_bf16 v[128:143], a[224:227], v[16:19], v[128:143]
ds_read_b64_tr_b16 a[252:253], v245 offset:14336
ds_read_b64_tr_b16 a[254:255], v245 offset:15360
s_add_u32 m0, s6, 32768
s_add_u32 s44, s75, 0
buffer_load_dwordx4 v232, s[24:27], s44 offen offset:0 lds
v_mul_f32 v180, v180, v250
v_mul_f32 v181, v181, v250
v_mul_f32 v182, v182, v250
v_mul_f32 v183, v183, v250
v_mfma_f32_32x32x16_bf16 v[144:159], a[228:231], v[16:19], v[144:159]
v_add_u32 v246, 0x14000, v246
ds_read_b64_tr_b16 a[224:225], v246 offset:0
ds_read_b64_tr_b16 a[226:227], v246 offset:7168
v_mul_f32 v184, v184, v250
v_mul_f32 v185, v185, v250
v_mul_f32 v186, v186, v250
s_waitcnt lgkmcnt(10)
v_mfma_f32_32x32x16_bf16 v[128:143], a[232:235], v[20:23], v[128:143]
v_add_u32 v247, 0x14000, v247
ds_read_b64_tr_b16 a[228:229], v247 offset:0
ds_read_b64_tr_b16 a[230:231], v247 offset:7168
buffer_load_dwordx4 v233, s[24:27], s44 offen offset:1024 lds
v_mul_f32 v187, v187, v250
v_mul_f32 v188, v188, v250
v_mul_f32 v189, v189, v250
v_mul_f32 v190, v190, v250
v_mfma_f32_32x32x16_bf16 v[144:159], a[236:239], v[20:23], v[144:159]
ds_read_b64_tr_b16 a[232:233], v246 offset:128
ds_read_b64_tr_b16 a[234:235], v246 offset:7296
v_mul_f32 v191, v191, v250
v_cvt_pk_bf16_f32 v192, v160, v161
v_cvt_pk_bf16_f32 v193, v162, v163
s_waitcnt lgkmcnt(10)
v_mfma_f32_32x32x16_bf16 v[128:143], a[240:243], v[24:27], v[128:143]
ds_read_b64_tr_b16 a[236:237], v247 offset:128
ds_read_b64_tr_b16 a[238:239], v247 offset:7296
buffer_load_dwordx4 v234, s[24:27], s44 offen offset:2048 lds
v_cvt_pk_bf16_f32 v194, v164, v165
v_cvt_pk_bf16_f32 v195, v166, v167
v_cvt_pk_bf16_f32 v196, v168, v169
v_cvt_pk_bf16_f32 v197, v170, v171
v_mfma_f32_32x32x16_bf16 v[144:159], a[244:247], v[24:27], v[144:159]
ds_read_b64_tr_b16 a[240:241], v246 offset:256
ds_read_b64_tr_b16 a[242:243], v246 offset:7424
v_cvt_pk_bf16_f32 v198, v172, v173
v_cvt_pk_bf16_f32 v199, v174, v175
v_cvt_pk_bf16_f32 v200, v176, v177
s_waitcnt lgkmcnt(10)
v_mfma_f32_32x32x16_bf16 v[128:143], a[248:251], v[28:31], v[128:143]
ds_read_b64_tr_b16 a[244:245], v247 offset:256
ds_read_b64_tr_b16 a[246:247], v247 offset:7424
buffer_load_dwordx4 v235, s[24:27], s44 offen offset:3072 lds
v_cvt_pk_bf16_f32 v201, v178, v179
v_cvt_pk_bf16_f32 v202, v180, v181
v_cvt_pk_bf16_f32 v203, v182, v183
v_cvt_pk_bf16_f32 v204, v184, v185
v_mfma_f32_32x32x16_bf16 v[144:159], a[252:255], v[28:31], v[144:159]
ds_read_b64_tr_b16 a[248:249], v246 offset:384
ds_read_b64_tr_b16 a[250:251], v246 offset:7552
v_cvt_pk_bf16_f32 v205, v186, v187
v_cvt_pk_bf16_f32 v206, v188, v189
v_cvt_pk_bf16_f32 v207, v190, v191
s_barrier
s_waitcnt lgkmcnt(10)
v_mfma_f32_32x32x16_bf16 a[0:15], a[224:227], v[192:195], a[0:15]
ds_read_b64_tr_b16 a[252:253], v247 offset:384
ds_read_b64_tr_b16 a[254:255], v247 offset:7552
s_add_u32 m0, s6, 147456
s_add_u32 s44, s75, 14336
buffer_load_dwordx4 v232, s[24:27], s44 offen offset:0 lds
v_mfma_f32_32x32x16_bf16 a[16:31], a[228:231], v[192:195], a[16:31]
ds_read_b64_tr_b16 a[224:225], v246 offset:512
ds_read_b64_tr_b16 a[226:227], v246 offset:7680
buffer_load_dwordx4 v233, s[24:27], s44 offen offset:1024 lds
s_waitcnt lgkmcnt(10)
v_mfma_f32_32x32x16_bf16 a[32:47], a[232:235], v[192:195], a[32:47]
ds_read_b64_tr_b16 a[228:229], v247 offset:512
ds_read_b64_tr_b16 a[230:231], v247 offset:7680
v_mfma_f32_32x32x16_bf16 a[48:63], a[236:239], v[192:195], a[48:63]
ds_read_b64_tr_b16 a[232:233], v246 offset:640
ds_read_b64_tr_b16 a[234:235], v246 offset:7808
buffer_load_dwordx4 v234, s[24:27], s44 offen offset:2048 lds
s_waitcnt lgkmcnt(10)
v_mfma_f32_32x32x16_bf16 a[64:79], a[240:243], v[192:195], a[64:79]
ds_read_b64_tr_b16 a[236:237], v247 offset:640
ds_read_b64_tr_b16 a[238:239], v247 offset:7808
v_mfma_f32_32x32x16_bf16 a[80:95], a[244:247], v[192:195], a[80:95]
ds_read_b64_tr_b16 a[240:241], v246 offset:768
ds_read_b64_tr_b16 a[242:243], v246 offset:7936
buffer_load_dwordx4 v235, s[24:27], s44 offen offset:3072 lds
s_waitcnt lgkmcnt(10)
v_mfma_f32_32x32x16_bf16 a[96:111], a[248:251], v[192:195], a[96:111]
ds_read_b64_tr_b16 a[244:245], v247 offset:768
ds_read_b64_tr_b16 a[246:247], v247 offset:7936
v_mfma_f32_32x32x16_bf16 a[112:127], a[252:255], v[192:195], a[112:127]
v_add_u32 v244, 0xffff8000, v244
ds_read_b64_tr_b16 a[248:249], v244 offset:0
ds_read_b64_tr_b16 a[250:251], v244 offset:1024
s_add_u32 m0, s6, 81920
s_add_u32 s44, s75, 28672
buffer_load_dwordx4 v232, s[24:27], s44 offen offset:0 lds
s_waitcnt lgkmcnt(10)
v_mfma_f32_32x32x16_bf16 a[128:143], a[224:227], v[192:195], a[128:143]
v_add_u32 v245, 0xffff8000, v245
ds_read_b64_tr_b16 a[252:253], v245 offset:0
ds_read_b64_tr_b16 a[254:255], v245 offset:1024
buffer_load_dwordx4 v233, s[24:27], s44 offen offset:1024 lds
v_mfma_f32_32x32x16_bf16 a[144:159], a[228:231], v[192:195], a[144:159]
ds_read_b64_tr_b16 a[224:225], v244 offset:2048
ds_read_b64_tr_b16 a[226:227], v244 offset:3072
s_waitcnt lgkmcnt(10)
v_mfma_f32_32x32x16_bf16 a[160:175], a[232:235], v[192:195], a[160:175]
ds_read_b64_tr_b16 a[228:229], v245 offset:2048
ds_read_b64_tr_b16 a[230:231], v245 offset:3072
buffer_load_dwordx4 v234, s[24:27], s44 offen offset:2048 lds
v_mfma_f32_32x32x16_bf16 a[176:191], a[236:239], v[192:195], a[176:191]
ds_read_b64_tr_b16 a[232:233], v244 offset:4096
ds_read_b64_tr_b16 a[234:235], v244 offset:5120
s_waitcnt lgkmcnt(10)
v_mfma_f32_32x32x16_bf16 a[192:207], a[240:243], v[192:195], a[192:207]
ds_read_b64_tr_b16 a[236:237], v245 offset:4096
ds_read_b64_tr_b16 a[238:239], v245 offset:5120
buffer_load_dwordx4 v235, s[24:27], s44 offen offset:3072 lds
v_mfma_f32_32x32x16_bf16 a[208:223], a[244:247], v[192:195], a[208:223]
ds_read_b64_tr_b16 a[240:241], v244 offset:6144
ds_read_b64_tr_b16 a[242:243], v244 offset:7168
s_waitcnt vmcnt(24)
s_barrier
s_waitcnt lgkmcnt(10)
v_mfma_f32_32x32x16_bf16 v[128:143], a[248:251], v[32:35], v[128:143]
ds_read_b64_tr_b16 a[244:245], v245 offset:6144
ds_read_b64_tr_b16 a[246:247], v245 offset:7168
s_add_u32 m0, s6, 114688
s_add_u32 s44, s75, 43008
buffer_load_dwordx4 v232, s[24:27], s44 offen offset:0 lds
v_mfma_f32_32x32x16_bf16 v[144:159], a[252:255], v[32:35], v[144:159]
ds_read_b64_tr_b16 a[248:249], v244 offset:8192
ds_read_b64_tr_b16 a[250:251], v244 offset:9216
s_waitcnt lgkmcnt(10)
v_mfma_f32_32x32x16_bf16 v[128:143], a[224:227], v[36:39], v[128:143]
ds_read_b64_tr_b16 a[252:253], v245 offset:8192
ds_read_b64_tr_b16 a[254:255], v245 offset:9216
v_mfma_f32_32x32x16_bf16 v[144:159], a[228:231], v[36:39], v[144:159]
ds_read_b64_tr_b16 a[224:225], v244 offset:10240
ds_read_b64_tr_b16 a[226:227], v244 offset:11264
s_waitcnt lgkmcnt(10)
v_mfma_f32_32x32x16_bf16 v[128:143], a[232:235], v[40:43], v[128:143]
ds_read_b64_tr_b16 a[228:229], v245 offset:10240
ds_read_b64_tr_b16 a[230:231], v245 offset:11264
buffer_load_dwordx4 v233, s[24:27], s44 offen offset:1024 lds
v_mfma_f32_32x32x16_bf16 v[144:159], a[236:239], v[40:43], v[144:159]
ds_read_b64_tr_b16 a[232:233], v244 offset:12288
ds_read_b64_tr_b16 a[234:235], v244 offset:13312
s_waitcnt lgkmcnt(10)
v_mfma_f32_32x32x16_bf16 v[128:143], a[240:243], v[44:47], v[128:143]
ds_read_b64_tr_b16 a[236:237], v245 offset:12288
ds_read_b64_tr_b16 a[238:239], v245 offset:13312
v_mfma_f32_32x32x16_bf16 v[144:159], a[244:247], v[44:47], v[144:159]
ds_read_b64_tr_b16 a[240:241], v244 offset:14336
ds_read_b64_tr_b16 a[242:243], v244 offset:15360
s_waitcnt lgkmcnt(10)
v_mfma_f32_32x32x16_bf16 v[128:143], a[248:251], v[48:51], v[128:143]
ds_read_b64_tr_b16 a[244:245], v245 offset:14336
ds_read_b64_tr_b16 a[246:247], v245 offset:15360
buffer_load_dwordx4 v234, s[24:27], s44 offen offset:2048 lds
v_mfma_f32_32x32x16_bf16 v[144:159], a[252:255], v[48:51], v[144:159]
v_add_u32 v246, 0xfffe4000, v246
ds_read_b64_tr_b16 a[248:249], v246 offset:0
ds_read_b64_tr_b16 a[250:251], v246 offset:7168
s_waitcnt lgkmcnt(10)
v_mfma_f32_32x32x16_bf16 v[128:143], a[224:227], v[52:55], v[128:143]
v_add_u32 v247, 0xfffe4000, v247
ds_read_b64_tr_b16 a[252:253], v247 offset:0
ds_read_b64_tr_b16 a[254:255], v247 offset:7168
v_mfma_f32_32x32x16_bf16 v[144:159], a[228:231], v[52:55], v[144:159]
ds_read_b64_tr_b16 a[224:225], v246 offset:128
ds_read_b64_tr_b16 a[226:227], v246 offset:7296
s_waitcnt lgkmcnt(10)
v_mfma_f32_32x32x16_bf16 v[128:143], a[232:235], v[56:59], v[128:143]
ds_read_b64_tr_b16 a[228:229], v247 offset:128
ds_read_b64_tr_b16 a[230:231], v247 offset:7296
buffer_load_dwordx4 v235, s[24:27], s44 offen offset:3072 lds
v_mfma_f32_32x32x16_bf16 v[144:159], a[236:239], v[56:59], v[144:159]
ds_read_b64_tr_b16 a[232:233], v246 offset:256
ds_read_b64_tr_b16 a[234:235], v246 offset:7424
s_waitcnt lgkmcnt(10)
v_mfma_f32_32x32x16_bf16 v[128:143], a[240:243], v[60:63], v[128:143]
ds_read_b64_tr_b16 a[236:237], v247 offset:256
ds_read_b64_tr_b16 a[238:239], v247 offset:7424
v_mfma_f32_32x32x16_bf16 v[144:159], a[244:247], v[60:63], v[144:159]
ds_read_b64_tr_b16 a[240:241], v246 offset:384
ds_read_b64_tr_b16 a[242:243], v246 offset:7552
s_barrier
s_waitcnt lgkmcnt(10)
v_mfma_f32_32x32x16_bf16 a[0:15], a[248:251], v[196:199], a[0:15]
ds_read_b64_tr_b16 a[244:245], v247 offset:384
ds_read_b64_tr_b16 a[246:247], v247 offset:7552
v_mfma_f32_32x32x16_bf16 a[16:31], a[252:255], v[196:199], a[16:31]
ds_read_b64_tr_b16 a[248:249], v246 offset:512
ds_read_b64_tr_b16 a[250:251], v246 offset:7680
s_waitcnt lgkmcnt(10)
v_mfma_f32_32x32x16_bf16 a[32:47], a[224:227], v[196:199], a[32:47]
ds_read_b64_tr_b16 a[252:253], v247 offset:512
ds_read_b64_tr_b16 a[254:255], v247 offset:7680
v_mfma_f32_32x32x16_bf16 a[48:63], a[228:231], v[196:199], a[48:63]
ds_read_b64_tr_b16 a[224:225], v246 offset:640
ds_read_b64_tr_b16 a[226:227], v246 offset:7808
s_waitcnt lgkmcnt(10)
v_mfma_f32_32x32x16_bf16 a[64:79], a[232:235], v[196:199], a[64:79]
ds_read_b64_tr_b16 a[228:229], v247 offset:640
ds_read_b64_tr_b16 a[230:231], v247 offset:7808
v_mfma_f32_32x32x16_bf16 a[80:95], a[236:239], v[196:199], a[80:95]
ds_read_b64_tr_b16 a[232:233], v246 offset:768
ds_read_b64_tr_b16 a[234:235], v246 offset:7936
s_waitcnt lgkmcnt(10)
v_mfma_f32_32x32x16_bf16 a[96:111], a[240:243], v[196:199], a[96:111]
ds_read_b64_tr_b16 a[236:237], v247 offset:768
ds_read_b64_tr_b16 a[238:239], v247 offset:7936
v_mfma_f32_32x32x16_bf16 a[112:127], a[244:247], v[196:199], a[112:127]
v_add_u32 v244, 0xc000, v244
ds_read_b64_tr_b16 a[240:241], v244 offset:0
ds_read_b64_tr_b16 a[242:243], v244 offset:1024
s_waitcnt lgkmcnt(10)
v_mfma_f32_32x32x16_bf16 a[128:143], a[248:251], v[196:199], a[128:143]
v_add_u32 v245, 0xc000, v245
ds_read_b64_tr_b16 a[244:245], v245 offset:0
ds_read_b64_tr_b16 a[246:247], v245 offset:1024
v_mfma_f32_32x32x16_bf16 a[144:159], a[252:255], v[196:199], a[144:159]
ds_read_b64_tr_b16 a[248:249], v244 offset:2048
ds_read_b64_tr_b16 a[250:251], v244 offset:3072
s_waitcnt lgkmcnt(10)
v_mfma_f32_32x32x16_bf16 a[160:175], a[224:227], v[196:199], a[160:175]
ds_read_b64_tr_b16 a[252:253], v245 offset:2048
ds_read_b64_tr_b16 a[254:255], v245 offset:3072
v_mfma_f32_32x32x16_bf16 a[176:191], a[228:231], v[196:199], a[176:191]
ds_read_b64_tr_b16 a[224:225], v244 offset:4096
ds_read_b64_tr_b16 a[226:227], v244 offset:5120
s_waitcnt lgkmcnt(10)
v_mfma_f32_32x32x16_bf16 a[192:207], a[232:235], v[196:199], a[192:207]
ds_read_b64_tr_b16 a[228:229], v245 offset:4096
ds_read_b64_tr_b16 a[230:231], v245 offset:5120
v_mfma_f32_32x32x16_bf16 a[208:223], a[236:239], v[196:199], a[208:223]
ds_read_b64_tr_b16 a[232:233], v244 offset:6144
ds_read_b64_tr_b16 a[234:235], v244 offset:7168
s_waitcnt vmcnt(24)
s_barrier
s_waitcnt lgkmcnt(10)
v_mfma_f32_32x32x16_bf16 v[128:143], a[240:243], v[64:67], v[128:143]
ds_read_b64_tr_b16 a[236:237], v245 offset:6144
ds_read_b64_tr_b16 a[238:239], v245 offset:7168
v_mfma_f32_32x32x16_bf16 v[144:159], a[244:247], v[64:67], v[144:159]
ds_read_b64_tr_b16 a[240:241], v244 offset:8192
ds_read_b64_tr_b16 a[242:243], v244 offset:9216
s_waitcnt lgkmcnt(10)
v_mfma_f32_32x32x16_bf16 v[128:143], a[248:251], v[68:71], v[128:143]
ds_read_b64_tr_b16 a[244:245], v245 offset:8192
ds_read_b64_tr_b16 a[246:247], v245 offset:9216
v_mfma_f32_32x32x16_bf16 v[144:159], a[252:255], v[68:71], v[144:159]
ds_read_b64_tr_b16 a[248:249], v244 offset:10240
ds_read_b64_tr_b16 a[250:251], v244 offset:11264
s_waitcnt lgkmcnt(10)
v_mfma_f32_32x32x16_bf16 v[128:143], a[224:227], v[72:75], v[128:143]
ds_read_b64_tr_b16 a[252:253], v245 offset:10240
ds_read_b64_tr_b16 a[254:255], v245 offset:11264
v_mfma_f32_32x32x16_bf16 v[144:159], a[228:231], v[72:75], v[144:159]
ds_read_b64_tr_b16 a[224:225], v244 offset:12288
ds_read_b64_tr_b16 a[226:227], v244 offset:13312
s_waitcnt lgkmcnt(10)
v_mfma_f32_32x32x16_bf16 v[128:143], a[232:235], v[76:79], v[128:143]
ds_read_b64_tr_b16 a[228:229], v245 offset:12288
ds_read_b64_tr_b16 a[230:231], v245 offset:13312
v_mfma_f32_32x32x16_bf16 v[144:159], a[236:239], v[76:79], v[144:159]
ds_read_b64_tr_b16 a[232:233], v244 offset:14336
ds_read_b64_tr_b16 a[234:235], v244 offset:15360
s_waitcnt lgkmcnt(10)
v_mfma_f32_32x32x16_bf16 v[128:143], a[240:243], v[80:83], v[128:143]
ds_read_b64_tr_b16 a[236:237], v245 offset:14336
ds_read_b64_tr_b16 a[238:239], v245 offset:15360
v_mfma_f32_32x32x16_bf16 v[144:159], a[244:247], v[80:83], v[144:159]
v_add_u32 v246, 0x4000, v246
ds_read_b64_tr_b16 a[240:241], v246 offset:0
ds_read_b64_tr_b16 a[242:243], v246 offset:7168
s_waitcnt lgkmcnt(10)
v_mfma_f32_32x32x16_bf16 v[128:143], a[248:251], v[84:87], v[128:143]
v_add_u32 v247, 0x4000, v247
ds_read_b64_tr_b16 a[244:245], v247 offset:0
ds_read_b64_tr_b16 a[246:247], v247 offset:7168
v_mfma_f32_32x32x16_bf16 v[144:159], a[252:255], v[84:87], v[144:159]
ds_read_b64_tr_b16 a[248:249], v246 offset:128
ds_read_b64_tr_b16 a[250:251], v246 offset:7296
s_waitcnt lgkmcnt(10)
v_mfma_f32_32x32x16_bf16 v[128:143], a[224:227], v[88:91], v[128:143]
ds_read_b64_tr_b16 a[252:253], v247 offset:128
ds_read_b64_tr_b16 a[254:255], v247 offset:7296
v_mfma_f32_32x32x16_bf16 v[144:159], a[228:231], v[88:91], v[144:159]
ds_read_b64_tr_b16 a[224:225], v246 offset:256
ds_read_b64_tr_b16 a[226:227], v246 offset:7424
s_waitcnt lgkmcnt(10)
v_mfma_f32_32x32x16_bf16 v[128:143], a[232:235], v[92:95], v[128:143]
ds_read_b64_tr_b16 a[228:229], v247 offset:256
ds_read_b64_tr_b16 a[230:231], v247 offset:7424
v_mfma_f32_32x32x16_bf16 v[144:159], a[236:239], v[92:95], v[144:159]
ds_read_b64_tr_b16 a[232:233], v246 offset:384
ds_read_b64_tr_b16 a[234:235], v246 offset:7552
s_waitcnt vmcnt(16)
s_barrier
s_waitcnt lgkmcnt(10)
v_mfma_f32_32x32x16_bf16 a[0:15], a[240:243], v[200:203], a[0:15]
ds_read_b64_tr_b16 a[236:237], v247 offset:384
ds_read_b64_tr_b16 a[238:239], v247 offset:7552
v_mfma_f32_32x32x16_bf16 a[16:31], a[244:247], v[200:203], a[16:31]
ds_read_b64_tr_b16 a[240:241], v246 offset:512
ds_read_b64_tr_b16 a[242:243], v246 offset:7680
s_waitcnt lgkmcnt(10)
v_mfma_f32_32x32x16_bf16 a[32:47], a[248:251], v[200:203], a[32:47]
ds_read_b64_tr_b16 a[244:245], v247 offset:512
ds_read_b64_tr_b16 a[246:247], v247 offset:7680
v_mfma_f32_32x32x16_bf16 a[48:63], a[252:255], v[200:203], a[48:63]
ds_read_b64_tr_b16 a[248:249], v246 offset:640
ds_read_b64_tr_b16 a[250:251], v246 offset:7808
s_waitcnt lgkmcnt(10)
v_mfma_f32_32x32x16_bf16 a[64:79], a[224:227], v[200:203], a[64:79]
ds_read_b64_tr_b16 a[252:253], v247 offset:640
ds_read_b64_tr_b16 a[254:255], v247 offset:7808
v_mfma_f32_32x32x16_bf16 a[80:95], a[228:231], v[200:203], a[80:95]
ds_read_b64_tr_b16 a[224:225], v246 offset:768
ds_read_b64_tr_b16 a[226:227], v246 offset:7936
s_waitcnt lgkmcnt(10)
v_mfma_f32_32x32x16_bf16 a[96:111], a[232:235], v[200:203], a[96:111]
ds_read_b64_tr_b16 a[228:229], v247 offset:768
ds_read_b64_tr_b16 a[230:231], v247 offset:7936
v_mfma_f32_32x32x16_bf16 a[112:127], a[236:239], v[200:203], a[112:127]
v_add_u32 v246, 0x1c000, v246
ds_read_b64_tr_b16 a[232:233], v246 offset:0
ds_read_b64_tr_b16 a[234:235], v246 offset:7168
s_waitcnt lgkmcnt(10)
v_mfma_f32_32x32x16_bf16 a[128:143], a[240:243], v[200:203], a[128:143]
v_add_u32 v247, 0x1c000, v247
ds_read_b64_tr_b16 a[236:237], v247 offset:0
ds_read_b64_tr_b16 a[238:239], v247 offset:7168
v_mfma_f32_32x32x16_bf16 a[144:159], a[244:247], v[200:203], a[144:159]
ds_read_b64_tr_b16 a[240:241], v246 offset:128
ds_read_b64_tr_b16 a[242:243], v246 offset:7296
s_waitcnt lgkmcnt(10)
v_mfma_f32_32x32x16_bf16 a[160:175], a[248:251], v[200:203], a[160:175]
ds_read_b64_tr_b16 a[244:245], v247 offset:128
ds_read_b64_tr_b16 a[246:247], v247 offset:7296
v_mfma_f32_32x32x16_bf16 a[176:191], a[252:255], v[200:203], a[176:191]
ds_read_b64_tr_b16 a[248:249], v246 offset:256
ds_read_b64_tr_b16 a[250:251], v246 offset:7424
s_waitcnt lgkmcnt(10)
v_mfma_f32_32x32x16_bf16 a[192:207], a[224:227], v[200:203], a[192:207]
ds_read_b64_tr_b16 a[252:253], v247 offset:256
ds_read_b64_tr_b16 a[254:255], v247 offset:7424
v_mfma_f32_32x32x16_bf16 a[208:223], a[228:231], v[200:203], a[208:223]
ds_read_b64_tr_b16 a[224:225], v246 offset:384
ds_read_b64_tr_b16 a[226:227], v246 offset:7552
s_barrier
s_waitcnt lgkmcnt(10)
v_mfma_f32_32x32x16_bf16 a[0:15], a[232:235], v[204:207], a[0:15]
ds_read_b64_tr_b16 a[228:229], v247 offset:384
ds_read_b64_tr_b16 a[230:231], v247 offset:7552
v_mfma_f32_32x32x16_bf16 a[16:31], a[236:239], v[204:207], a[16:31]
ds_read_b64_tr_b16 a[232:233], v246 offset:512
ds_read_b64_tr_b16 a[234:235], v246 offset:7680
s_waitcnt lgkmcnt(10)
v_mfma_f32_32x32x16_bf16 a[32:47], a[240:243], v[204:207], a[32:47]
ds_read_b64_tr_b16 a[236:237], v247 offset:512
ds_read_b64_tr_b16 a[238:239], v247 offset:7680
v_mfma_f32_32x32x16_bf16 a[48:63], a[244:247], v[204:207], a[48:63]
ds_read_b64_tr_b16 a[240:241], v246 offset:640
ds_read_b64_tr_b16 a[242:243], v246 offset:7808
s_waitcnt lgkmcnt(10)
v_mfma_f32_32x32x16_bf16 a[64:79], a[248:251], v[204:207], a[64:79]
ds_read_b64_tr_b16 a[244:245], v247 offset:640
ds_read_b64_tr_b16 a[246:247], v247 offset:7808
v_mfma_f32_32x32x16_bf16 a[80:95], a[252:255], v[204:207], a[80:95]
ds_read_b64_tr_b16 a[248:249], v246 offset:768
ds_read_b64_tr_b16 a[250:251], v246 offset:7936
s_waitcnt lgkmcnt(10)
v_mfma_f32_32x32x16_bf16 a[96:111], a[224:227], v[204:207], a[96:111]
ds_read_b64_tr_b16 a[252:253], v247 offset:768
ds_read_b64_tr_b16 a[254:255], v247 offset:7936
v_mfma_f32_32x32x16_bf16 a[112:127], a[228:231], v[204:207], a[112:127]
v_add_u32 v244, 0xffff8000, v244
ds_read_b64_tr_b16 a[224:225], v244 offset:0
ds_read_b64_tr_b16 a[226:227], v244 offset:1024
s_waitcnt lgkmcnt(10)
v_mfma_f32_32x32x16_bf16 a[128:143], a[232:235], v[204:207], a[128:143]
v_add_u32 v245, 0xffff8000, v245
ds_read_b64_tr_b16 a[228:229], v245 offset:0
ds_read_b64_tr_b16 a[230:231], v245 offset:1024
v_mfma_f32_32x32x16_bf16 a[144:159], a[236:239], v[204:207], a[144:159]
ds_read_b64_tr_b16 a[232:233], v244 offset:2048
ds_read_b64_tr_b16 a[234:235], v244 offset:3072
s_waitcnt lgkmcnt(10)
v_mfma_f32_32x32x16_bf16 a[160:175], a[240:243], v[204:207], a[160:175]
ds_read_b64_tr_b16 a[236:237], v245 offset:2048
ds_read_b64_tr_b16 a[238:239], v245 offset:3072
v_mfma_f32_32x32x16_bf16 a[176:191], a[244:247], v[204:207], a[176:191]
ds_read_b64_tr_b16 a[240:241], v244 offset:4096
ds_read_b64_tr_b16 a[242:243], v244 offset:5120
s_waitcnt lgkmcnt(10)
v_mfma_f32_32x32x16_bf16 a[192:207], a[248:251], v[204:207], a[192:207]
ds_read_b64_tr_b16 a[244:245], v245 offset:4096
ds_read_b64_tr_b16 a[246:247], v245 offset:5120
v_mfma_f32_32x32x16_bf16 a[208:223], a[252:255], v[204:207], a[208:223]
ds_read_b64_tr_b16 a[248:249], v244 offset:6144
ds_read_b64_tr_b16 a[250:251], v244 offset:7168
s_waitcnt vmcnt(0)
s_barrier
s_waitcnt lgkmcnt(10)
v_mfma_f32_32x32x16_bf16 v[128:143], a[224:227], v[96:99], v[128:143]
ds_read_b64_tr_b16 a[252:253], v245 offset:6144
ds_read_b64_tr_b16 a[254:255], v245 offset:7168
v_mfma_f32_32x32x16_bf16 v[144:159], a[228:231], v[96:99], v[144:159]
ds_read_b64_tr_b16 a[224:225], v244 offset:8192
ds_read_b64_tr_b16 a[226:227], v244 offset:9216
s_waitcnt lgkmcnt(10)
v_mfma_f32_32x32x16_bf16 v[128:143], a[232:235], v[100:103], v[128:143]
ds_read_b64_tr_b16 a[228:229], v245 offset:8192
ds_read_b64_tr_b16 a[230:231], v245 offset:9216
v_mfma_f32_32x32x16_bf16 v[144:159], a[236:239], v[100:103], v[144:159]
ds_read_b64_tr_b16 a[232:233], v244 offset:10240
ds_read_b64_tr_b16 a[234:235], v244 offset:11264
s_waitcnt lgkmcnt(10)
v_mfma_f32_32x32x16_bf16 v[128:143], a[240:243], v[104:107], v[128:143]
ds_read_b64_tr_b16 a[236:237], v245 offset:10240
ds_read_b64_tr_b16 a[238:239], v245 offset:11264
v_mfma_f32_32x32x16_bf16 v[144:159], a[244:247], v[104:107], v[144:159]
ds_read_b64_tr_b16 a[240:241], v244 offset:12288
ds_read_b64_tr_b16 a[242:243], v244 offset:13312
s_waitcnt lgkmcnt(10)
v_mfma_f32_32x32x16_bf16 v[128:143], a[248:251], v[108:111], v[128:143]
ds_read_b64_tr_b16 a[244:245], v245 offset:12288
ds_read_b64_tr_b16 a[246:247], v245 offset:13312
v_mfma_f32_32x32x16_bf16 v[144:159], a[252:255], v[108:111], v[144:159]
ds_read_b64_tr_b16 a[248:249], v244 offset:14336
ds_read_b64_tr_b16 a[250:251], v244 offset:15360
s_waitcnt lgkmcnt(10)
v_mfma_f32_32x32x16_bf16 v[128:143], a[224:227], v[112:115], v[128:143]
ds_read_b64_tr_b16 a[252:253], v245 offset:14336
ds_read_b64_tr_b16 a[254:255], v245 offset:15360
v_mfma_f32_32x32x16_bf16 v[144:159], a[228:231], v[112:115], v[144:159]
v_add_u32 v246, 0xfffe8000, v246
ds_read_b64_tr_b16 a[224:225], v246 offset:0
ds_read_b64_tr_b16 a[226:227], v246 offset:7168
s_waitcnt lgkmcnt(10)
v_mfma_f32_32x32x16_bf16 v[128:143], a[232:235], v[116:119], v[128:143]
v_add_u32 v246, 0x1c000, v246
ds_read_b64_tr_b16 a[228:229], v246 offset:0
ds_read_b64_tr_b16 a[230:231], v246 offset:7168
v_mfma_f32_32x32x16_bf16 v[144:159], a[236:239], v[116:119], v[144:159]
v_add_u32 v246, 0xffff0000, v246
ds_read_b64_tr_b16 a[232:233], v246 offset:0
ds_read_b64_tr_b16 a[234:235], v246 offset:7168
s_waitcnt lgkmcnt(10)
v_mfma_f32_32x32x16_bf16 v[128:143], a[240:243], v[120:123], v[128:143]
v_add_u32 v246, 0x8000, v246
ds_read_b64_tr_b16 a[236:237], v246 offset:0
ds_read_b64_tr_b16 a[238:239], v246 offset:7168
v_mfma_f32_32x32x16_bf16 v[144:159], a[244:247], v[120:123], v[144:159]
v_add_u32 v247, 0xfffe8000, v247
ds_read_b64_tr_b16 a[240:241], v247 offset:0
ds_read_b64_tr_b16 a[242:243], v247 offset:7168
s_waitcnt lgkmcnt(10)
v_mfma_f32_32x32x16_bf16 v[128:143], a[248:251], v[124:127], v[128:143]
v_add_u32 v247, 0x1c000, v247
ds_read_b64_tr_b16 a[244:245], v247 offset:0
ds_read_b64_tr_b16 a[246:247], v247 offset:7168
v_mfma_f32_32x32x16_bf16 v[144:159], a[252:255], v[124:127], v[144:159]
v_add_u32 v247, 0xffff0000, v247
ds_read_b64_tr_b16 a[248:249], v247 offset:0
ds_read_b64_tr_b16 a[250:251], v247 offset:7168
s_barrier
global_load_dword v227, v226, s[76:77] sc1
s_nop 7
s_nop 3
v_mul_f32 v128, v128, v250
v_mul_f32 v129, v129, v250
v_mul_f32 v130, v130, v250
v_mul_f32 v131, v131, v250
v_mul_f32 v132, v132, v250
v_mul_f32 v133, v133, v250
v_mul_f32 v134, v134, v250
v_mul_f32 v135, v135, v250
v_mul_f32 v136, v136, v250
v_mul_f32 v137, v137, v250
v_mul_f32 v138, v138, v250
v_mul_f32 v139, v139, v250
v_mul_f32 v140, v140, v250
v_mul_f32 v141, v141, v250
v_mul_f32 v142, v142, v250
v_mul_f32 v143, v143, v250
v_mul_f32 v144, v144, v250
v_mul_f32 v145, v145, v250
v_mul_f32 v146, v146, v250
v_mul_f32 v147, v147, v250
v_mul_f32 v148, v148, v250
v_mul_f32 v149, v149, v250
v_mul_f32 v150, v150, v250
v_mul_f32 v151, v151, v250
v_mul_f32 v152, v152, v250
v_mul_f32 v153, v153, v250
v_mul_f32 v154, v154, v250
v_mul_f32 v155, v155, v250
v_mul_f32 v156, v156, v250
v_mul_f32 v157, v157, v250
v_mul_f32 v158, v158, v250
v_mul_f32 v159, v159, v250
v_cvt_pk_bf16_f32 v192, v128, v129
v_cvt_pk_bf16_f32 v193, v130, v131
v_cvt_pk_bf16_f32 v194, v132, v133
v_cvt_pk_bf16_f32 v195, v134, v135
v_cvt_pk_bf16_f32 v196, v136, v137
v_cvt_pk_bf16_f32 v197, v138, v139
v_cvt_pk_bf16_f32 v198, v140, v141
v_cvt_pk_bf16_f32 v199, v142, v143
v_cvt_pk_bf16_f32 v200, v144, v145
v_cvt_pk_bf16_f32 v201, v146, v147
v_cvt_pk_bf16_f32 v202, v148, v149
v_cvt_pk_bf16_f32 v203, v150, v151
v_cvt_pk_bf16_f32 v204, v152, v153
v_cvt_pk_bf16_f32 v205, v154, v155
v_cvt_pk_bf16_f32 v206, v156, v157
v_cvt_pk_bf16_f32 v207, v158, v159
s_nop 1
s_waitcnt lgkmcnt(10)
v_mfma_f32_32x32x16_bf16 a[0:15], a[224:227], v[192:195], a[0:15]
v_add_u32 v247, 0x8000, v247
ds_read_b64_tr_b16 a[252:253], v247 offset:0
ds_read_b64_tr_b16 a[254:255], v247 offset:7168
v_mfma_f32_32x32x16_bf16 a[0:15], a[228:231], v[196:199], a[0:15]
v_add_u32 v246, 0xfffec000, v246
ds_read_b64_tr_b16 a[224:225], v246 offset:128
ds_read_b64_tr_b16 a[226:227], v246 offset:7296
s_waitcnt lgkmcnt(10)
v_mfma_f32_32x32x16_bf16 a[0:15], a[232:235], v[200:203], a[0:15]
v_add_u32 v246, 0x1c000, v246
ds_read_b64_tr_b16 a[228:229], v246 offset:128
ds_read_b64_tr_b16 a[230:231], v246 offset:7296
v_mfma_f32_32x32x16_bf16 a[0:15], a[236:239], v[204:207], a[0:15]
v_add_u32 v246, 0xffff0000, v246
ds_read_b64_tr_b16 a[232:233], v246 offset:128
ds_read_b64_tr_b16 a[234:235], v246 offset:7296
s_waitcnt lgkmcnt(10)
v_mfma_f32_32x32x16_bf16 a[16:31], a[240:243], v[192:195], a[16:31]
v_add_u32 v246, 0x8000, v246
ds_read_b64_tr_b16 a[236:237], v246 offset:128
ds_read_b64_tr_b16 a[238:239], v246 offset:7296
v_mfma_f32_32x32x16_bf16 a[16:31], a[244:247], v[196:199], a[16:31]
v_add_u32 v247, 0xfffec000, v247
ds_read_b64_tr_b16 a[240:241], v247 offset:128
ds_read_b64_tr_b16 a[242:243], v247 offset:7296
s_waitcnt lgkmcnt(10)
v_mfma_f32_32x32x16_bf16 a[16:31], a[248:251], v[200:203], a[16:31]
v_add_u32 v247, 0x1c000, v247
ds_read_b64_tr_b16 a[244:245], v247 offset:128
ds_read_b64_tr_b16 a[246:247], v247 offset:7296
v_mfma_f32_32x32x16_bf16 a[16:31], a[252:255], v[204:207], a[16:31]
v_add_u32 v247, 0xffff0000, v247
ds_read_b64_tr_b16 a[248:249], v247 offset:128
ds_read_b64_tr_b16 a[250:251], v247 offset:7296
v_accvgpr_read_b32 v0, a0
v_accvgpr_read_b32 v1, a1
v_accvgpr_read_b32 v2, a2
v_accvgpr_read_b32 v3, a3
v_accvgpr_read_b32 v4, a4
v_accvgpr_read_b32 v5, a5
v_accvgpr_read_b32 v6, a6
v_accvgpr_read_b32 v7, a7
v_accvgpr_read_b32 v8, a8
v_accvgpr_read_b32 v9, a9
v_accvgpr_read_b32 v10, a10
v_accvgpr_read_b32 v11, a11
v_accvgpr_read_b32 v12, a12
v_accvgpr_read_b32 v13, a13
v_accvgpr_read_b32 v14, a14
v_accvgpr_read_b32 v15, a15
v_cvt_pk_bf16_f32 v64, v0, v1
v_cvt_pk_bf16_f32 v65, v2, v3
v_cvt_pk_bf16_f32 v66, v4, v5
v_cvt_pk_bf16_f32 v67, v6, v7
v_cvt_pk_bf16_f32 v68, v8, v9
v_cvt_pk_bf16_f32 v69, v10, v11
v_cvt_pk_bf16_f32 v70, v12, v13
v_cvt_pk_bf16_f32 v71, v14, v15
s_mov_b32 s44, 0
buffer_store_dwordx4 v[64:67], v224, s[28:31], s44 offen sc1
s_mov_b32 s44, 1024
buffer_store_dwordx4 v[68:71], v224, s[28:31], s44 offen sc1
s_waitcnt lgkmcnt(10)
v_mfma_f32_32x32x16_bf16 a[32:47], a[224:227], v[192:195], a[32:47]
v_add_u32 v247, 0x8000, v247
ds_read_b64_tr_b16 a[252:253], v247 offset:128
ds_read_b64_tr_b16 a[254:255], v247 offset:7296
v_mfma_f32_32x32x16_bf16 a[32:47], a[228:231], v[196:199], a[32:47]
v_add_u32 v246, 0xfffec000, v246
ds_read_b64_tr_b16 a[224:225], v246 offset:256
ds_read_b64_tr_b16 a[226:227], v246 offset:7424
s_waitcnt lgkmcnt(10)
v_mfma_f32_32x32x16_bf16 a[32:47], a[232:235], v[200:203], a[32:47]
v_add_u32 v246, 0x1c000, v246
ds_read_b64_tr_b16 a[228:229], v246 offset:256
ds_read_b64_tr_b16 a[230:231], v246 offset:7424
v_mfma_f32_32x32x16_bf16 a[32:47], a[236:239], v[204:207], a[32:47]
v_add_u32 v246, 0xffff0000, v246
ds_read_b64_tr_b16 a[232:233], v246 offset:256
ds_read_b64_tr_b16 a[234:235], v246 offset:7424
v_accvgpr_read_b32 v16, a16
v_accvgpr_read_b32 v17, a17
v_accvgpr_read_b32 v18, a18
v_accvgpr_read_b32 v19, a19
v_accvgpr_read_b32 v20, a20
v_accvgpr_read_b32 v21, a21
v_accvgpr_read_b32 v22, a22
v_accvgpr_read_b32 v23, a23
v_accvgpr_read_b32 v24, a24
v_accvgpr_read_b32 v25, a25
v_accvgpr_read_b32 v26, a26
v_accvgpr_read_b32 v27, a27
v_accvgpr_read_b32 v28, a28
v_accvgpr_read_b32 v29, a29
v_accvgpr_read_b32 v30, a30
v_accvgpr_read_b32 v31, a31
v_cvt_pk_bf16_f32 v72, v16, v17
v_cvt_pk_bf16_f32 v73, v18, v19
v_cvt_pk_bf16_f32 v74, v20, v21
v_cvt_pk_bf16_f32 v75, v22, v23
v_cvt_pk_bf16_f32 v76, v24, v25
v_cvt_pk_bf16_f32 v77, v26, v27
v_cvt_pk_bf16_f32 v78, v28, v29
v_cvt_pk_bf16_f32 v79, v30, v31
s_mov_b32 s44, 2048
buffer_store_dwordx4 v[72:75], v224, s[28:31], s44 offen sc1
s_mov_b32 s44, 3072
buffer_store_dwordx4 v[76:79], v224, s[28:31], s44 offen sc1
s_waitcnt lgkmcnt(10)
v_mfma_f32_32x32x16_bf16 a[48:63], a[240:243], v[192:195], a[48:63]
v_add_u32 v246, 0x8000, v246
ds_read_b64_tr_b16 a[236:237], v246 offset:256
ds_read_b64_tr_b16 a[238:239], v246 offset:7424
v_mfma_f32_32x32x16_bf16 a[48:63], a[244:247], v[196:199], a[48:63]
v_add_u32 v247, 0xfffec000, v247
ds_read_b64_tr_b16 a[240:241], v247 offset:256
ds_read_b64_tr_b16 a[242:243], v247 offset:7424
s_waitcnt lgkmcnt(10)
v_mfma_f32_32x32x16_bf16 a[48:63], a[248:251], v[200:203], a[48:63]
v_add_u32 v247, 0x1c000, v247
ds_read_b64_tr_b16 a[244:245], v247 offset:256
ds_read_b64_tr_b16 a[246:247], v247 offset:7424
v_mfma_f32_32x32x16_bf16 a[48:63], a[252:255], v[204:207], a[48:63]
v_add_u32 v247, 0xffff0000, v247
ds_read_b64_tr_b16 a[248:249], v247 offset:256
ds_read_b64_tr_b16 a[250:251], v247 offset:7424
v_accvgpr_read_b32 v32, a32
v_accvgpr_read_b32 v33, a33
v_accvgpr_read_b32 v34, a34
v_accvgpr_read_b32 v35, a35
v_accvgpr_read_b32 v36, a36
v_accvgpr_read_b32 v37, a37
v_accvgpr_read_b32 v38, a38
v_accvgpr_read_b32 v39, a39
v_accvgpr_read_b32 v40, a40
v_accvgpr_read_b32 v41, a41
v_accvgpr_read_b32 v42, a42
v_accvgpr_read_b32 v43, a43
v_accvgpr_read_b32 v44, a44
v_accvgpr_read_b32 v45, a45
v_accvgpr_read_b32 v46, a46
v_accvgpr_read_b32 v47, a47
v_cvt_pk_bf16_f32 v80, v32, v33
v_cvt_pk_bf16_f32 v81, v34, v35
v_cvt_pk_bf16_f32 v82, v36, v37
v_cvt_pk_bf16_f32 v83, v38, v39
v_cvt_pk_bf16_f32 v84, v40, v41
v_cvt_pk_bf16_f32 v85, v42, v43
v_cvt_pk_bf16_f32 v86, v44, v45
v_cvt_pk_bf16_f32 v87, v46, v47
s_mov_b32 s44, 4096
buffer_store_dwordx4 v[80:83], v224, s[28:31], s44 offen sc1
s_mov_b32 s44, 5120
buffer_store_dwordx4 v[84:87], v224, s[28:31], s44 offen sc1
s_waitcnt lgkmcnt(10)
v_mfma_f32_32x32x16_bf16 a[64:79], a[224:227], v[192:195], a[64:79]
v_add_u32 v247, 0x8000, v247
ds_read_b64_tr_b16 a[252:253], v247 offset:256
ds_read_b64_tr_b16 a[254:255], v247 offset:7424
v_mfma_f32_32x32x16_bf16 a[64:79], a[228:231], v[196:199], a[64:79]
v_add_u32 v246, 0xfffec000, v246
ds_read_b64_tr_b16 a[224:225], v246 offset:384
ds_read_b64_tr_b16 a[226:227], v246 offset:7552
s_waitcnt lgkmcnt(10)
v_mfma_f32_32x32x16_bf16 a[64:79], a[232:235], v[200:203], a[64:79]
v_add_u32 v246, 0x1c000, v246
ds_read_b64_tr_b16 a[228:229], v246 offset:384
ds_read_b64_tr_b16 a[230:231], v246 offset:7552
v_mfma_f32_32x32x16_bf16 a[64:79], a[236:239], v[204:207], a[64:79]
v_add_u32 v246, 0xffff0000, v246
ds_read_b64_tr_b16 a[232:233], v246 offset:384
ds_read_b64_tr_b16 a[234:235], v246 offset:7552
v_accvgpr_read_b32 v48, a48
v_accvgpr_read_b32 v49, a49
v_accvgpr_read_b32 v50, a50
v_accvgpr_read_b32 v51, a51
v_accvgpr_read_b32 v52, a52
v_accvgpr_read_b32 v53, a53
v_accvgpr_read_b32 v54, a54
v_accvgpr_read_b32 v55, a55
v_accvgpr_read_b32 v56, a56
v_accvgpr_read_b32 v57, a57
v_accvgpr_read_b32 v58, a58
v_accvgpr_read_b32 v59, a59
v_accvgpr_read_b32 v60, a60
v_accvgpr_read_b32 v61, a61
v_accvgpr_read_b32 v62, a62
v_accvgpr_read_b32 v63, a63
v_cvt_pk_bf16_f32 v88, v48, v49
v_cvt_pk_bf16_f32 v89, v50, v51
v_cvt_pk_bf16_f32 v90, v52, v53
v_cvt_pk_bf16_f32 v91, v54, v55
v_cvt_pk_bf16_f32 v92, v56, v57
v_cvt_pk_bf16_f32 v93, v58, v59
v_cvt_pk_bf16_f32 v94, v60, v61
v_cvt_pk_bf16_f32 v95, v62, v63
s_mov_b32 s44, 6144
buffer_store_dwordx4 v[88:91], v224, s[28:31], s44 offen sc1
s_mov_b32 s44, 7168
buffer_store_dwordx4 v[92:95], v224, s[28:31], s44 offen sc1
s_waitcnt lgkmcnt(10)
v_mfma_f32_32x32x16_bf16 a[80:95], a[240:243], v[192:195], a[80:95]
v_add_u32 v246, 0x8000, v246
ds_read_b64_tr_b16 a[236:237], v246 offset:384
ds_read_b64_tr_b16 a[238:239], v246 offset:7552
v_mfma_f32_32x32x16_bf16 a[80:95], a[244:247], v[196:199], a[80:95]
v_add_u32 v247, 0xfffec000, v247
ds_read_b64_tr_b16 a[240:241], v247 offset:384
ds_read_b64_tr_b16 a[242:243], v247 offset:7552
s_waitcnt lgkmcnt(10)
v_mfma_f32_32x32x16_bf16 a[80:95], a[248:251], v[200:203], a[80:95]
v_add_u32 v247, 0x1c000, v247
ds_read_b64_tr_b16 a[244:245], v247 offset:384
ds_read_b64_tr_b16 a[246:247], v247 offset:7552
v_mfma_f32_32x32x16_bf16 a[80:95], a[252:255], v[204:207], a[80:95]
v_add_u32 v247, 0xffff0000, v247
ds_read_b64_tr_b16 a[248:249], v247 offset:384
ds_read_b64_tr_b16 a[250:251], v247 offset:7552
v_accvgpr_read_b32 v0, a64
v_accvgpr_read_b32 v1, a65
v_accvgpr_read_b32 v2, a66
v_accvgpr_read_b32 v3, a67
v_accvgpr_read_b32 v4, a68
v_accvgpr_read_b32 v5, a69
v_accvgpr_read_b32 v6, a70
v_accvgpr_read_b32 v7, a71
v_accvgpr_read_b32 v8, a72
v_accvgpr_read_b32 v9, a73
v_accvgpr_read_b32 v10, a74
v_accvgpr_read_b32 v11, a75
v_accvgpr_read_b32 v12, a76
v_accvgpr_read_b32 v13, a77
v_accvgpr_read_b32 v14, a78
v_accvgpr_read_b32 v15, a79
v_cvt_pk_bf16_f32 v64, v0, v1
v_cvt_pk_bf16_f32 v65, v2, v3
v_cvt_pk_bf16_f32 v66, v4, v5
v_cvt_pk_bf16_f32 v67, v6, v7
v_cvt_pk_bf16_f32 v68, v8, v9
v_cvt_pk_bf16_f32 v69, v10, v11
v_cvt_pk_bf16_f32 v70, v12, v13
v_cvt_pk_bf16_f32 v71, v14, v15
s_mov_b32 s44, 8192
buffer_store_dwordx4 v[64:67], v224, s[28:31], s44 offen sc1
s_mov_b32 s44, 9216
buffer_store_dwordx4 v[68:71], v224, s[28:31], s44 offen sc1
s_waitcnt lgkmcnt(10)
v_mfma_f32_32x32x16_bf16 a[96:111], a[224:227], v[192:195], a[96:111]
v_add_u32 v247, 0x8000, v247
ds_read_b64_tr_b16 a[252:253], v247 offset:384
ds_read_b64_tr_b16 a[254:255], v247 offset:7552
v_mfma_f32_32x32x16_bf16 a[96:111], a[228:231], v[196:199], a[96:111]
v_add_u32 v246, 0xfffec000, v246
ds_read_b64_tr_b16 a[224:225], v246 offset:512
ds_read_b64_tr_b16 a[226:227], v246 offset:7680
s_waitcnt lgkmcnt(10)
v_mfma_f32_32x32x16_bf16 a[96:111], a[232:235], v[200:203], a[96:111]
v_add_u32 v246, 0x1c000, v246
ds_read_b64_tr_b16 a[228:229], v246 offset:512
ds_read_b64_tr_b16 a[230:231], v246 offset:7680
v_mfma_f32_32x32x16_bf16 a[96:111], a[236:239], v[204:207], a[96:111]
v_add_u32 v246, 0xffff0000, v246
ds_read_b64_tr_b16 a[232:233], v246 offset:512
ds_read_b64_tr_b16 a[234:235], v246 offset:7680
v_accvgpr_read_b32 v16, a80
v_accvgpr_read_b32 v17, a81
v_accvgpr_read_b32 v18, a82
v_accvgpr_read_b32 v19, a83
v_accvgpr_read_b32 v20, a84
v_accvgpr_read_b32 v21, a85
v_accvgpr_read_b32 v22, a86
v_accvgpr_read_b32 v23, a87
v_accvgpr_read_b32 v24, a88
v_accvgpr_read_b32 v25, a89
v_accvgpr_read_b32 v26, a90
v_accvgpr_read_b32 v27, a91
v_accvgpr_read_b32 v28, a92
v_accvgpr_read_b32 v29, a93
v_accvgpr_read_b32 v30, a94
v_accvgpr_read_b32 v31, a95
v_cvt_pk_bf16_f32 v72, v16, v17
v_cvt_pk_bf16_f32 v73, v18, v19
v_cvt_pk_bf16_f32 v74, v20, v21
v_cvt_pk_bf16_f32 v75, v22, v23
v_cvt_pk_bf16_f32 v76, v24, v25
v_cvt_pk_bf16_f32 v77, v26, v27
v_cvt_pk_bf16_f32 v78, v28, v29
v_cvt_pk_bf16_f32 v79, v30, v31
s_mov_b32 s44, 10240
buffer_store_dwordx4 v[72:75], v224, s[28:31], s44 offen sc1
s_mov_b32 s44, 11264
buffer_store_dwordx4 v[76:79], v224, s[28:31], s44 offen sc1
s_waitcnt lgkmcnt(10)
v_mfma_f32_32x32x16_bf16 a[112:127], a[240:243], v[192:195], a[112:127]
v_add_u32 v246, 0x8000, v246
ds_read_b64_tr_b16 a[236:237], v246 offset:512
ds_read_b64_tr_b16 a[238:239], v246 offset:7680
v_mfma_f32_32x32x16_bf16 a[112:127], a[244:247], v[196:199], a[112:127]
v_add_u32 v247, 0xfffec000, v247
ds_read_b64_tr_b16 a[240:241], v247 offset:512
ds_read_b64_tr_b16 a[242:243], v247 offset:7680
s_waitcnt lgkmcnt(10)
v_mfma_f32_32x32x16_bf16 a[112:127], a[248:251], v[200:203], a[112:127]
v_add_u32 v247, 0x1c000, v247
ds_read_b64_tr_b16 a[244:245], v247 offset:512
ds_read_b64_tr_b16 a[246:247], v247 offset:7680
v_mfma_f32_32x32x16_bf16 a[112:127], a[252:255], v[204:207], a[112:127]
v_add_u32 v247, 0xffff0000, v247
ds_read_b64_tr_b16 a[248:249], v247 offset:512
ds_read_b64_tr_b16 a[250:251], v247 offset:7680
v_accvgpr_read_b32 v32, a96
v_accvgpr_read_b32 v33, a97
v_accvgpr_read_b32 v34, a98
v_accvgpr_read_b32 v35, a99
v_accvgpr_read_b32 v36, a100
v_accvgpr_read_b32 v37, a101
v_accvgpr_read_b32 v38, a102
v_accvgpr_read_b32 v39, a103
v_accvgpr_read_b32 v40, a104
v_accvgpr_read_b32 v41, a105
v_accvgpr_read_b32 v42, a106
v_accvgpr_read_b32 v43, a107
v_accvgpr_read_b32 v44, a108
v_accvgpr_read_b32 v45, a109
v_accvgpr_read_b32 v46, a110
v_accvgpr_read_b32 v47, a111
v_cvt_pk_bf16_f32 v80, v32, v33
v_cvt_pk_bf16_f32 v81, v34, v35
v_cvt_pk_bf16_f32 v82, v36, v37
v_cvt_pk_bf16_f32 v83, v38, v39
v_cvt_pk_bf16_f32 v84, v40, v41
v_cvt_pk_bf16_f32 v85, v42, v43
v_cvt_pk_bf16_f32 v86, v44, v45
v_cvt_pk_bf16_f32 v87, v46, v47
s_mov_b32 s44, 12288
buffer_store_dwordx4 v[80:83], v224, s[28:31], s44 offen sc1
s_mov_b32 s44, 13312
buffer_store_dwordx4 v[84:87], v224, s[28:31], s44 offen sc1
s_waitcnt lgkmcnt(10)
v_mfma_f32_32x32x16_bf16 a[128:143], a[224:227], v[192:195], a[128:143]
v_add_u32 v247, 0x8000, v247
ds_read_b64_tr_b16 a[252:253], v247 offset:512
ds_read_b64_tr_b16 a[254:255], v247 offset:7680
v_mfma_f32_32x32x16_bf16 a[128:143], a[228:231], v[196:199], a[128:143]
v_add_u32 v246, 0xfffec000, v246
ds_read_b64_tr_b16 a[224:225], v246 offset:640
ds_read_b64_tr_b16 a[226:227], v246 offset:7808
s_waitcnt lgkmcnt(10)
v_mfma_f32_32x32x16_bf16 a[128:143], a[232:235], v[200:203], a[128:143]
v_add_u32 v246, 0x1c000, v246
ds_read_b64_tr_b16 a[228:229], v246 offset:640
ds_read_b64_tr_b16 a[230:231], v246 offset:7808
v_mfma_f32_32x32x16_bf16 a[128:143], a[236:239], v[204:207], a[128:143]
v_add_u32 v246, 0xffff0000, v246
ds_read_b64_tr_b16 a[232:233], v246 offset:640
ds_read_b64_tr_b16 a[234:235], v246 offset:7808
v_accvgpr_read_b32 v48, a112
v_accvgpr_read_b32 v49, a113
v_accvgpr_read_b32 v50, a114
v_accvgpr_read_b32 v51, a115
v_accvgpr_read_b32 v52, a116
v_accvgpr_read_b32 v53, a117
v_accvgpr_read_b32 v54, a118
v_accvgpr_read_b32 v55, a119
v_accvgpr_read_b32 v56, a120
v_accvgpr_read_b32 v57, a121
v_accvgpr_read_b32 v58, a122
v_accvgpr_read_b32 v59, a123
v_accvgpr_read_b32 v60, a124
v_accvgpr_read_b32 v61, a125
v_accvgpr_read_b32 v62, a126
v_accvgpr_read_b32 v63, a127
v_cvt_pk_bf16_f32 v88, v48, v49
v_cvt_pk_bf16_f32 v89, v50, v51
v_cvt_pk_bf16_f32 v90, v52, v53
v_cvt_pk_bf16_f32 v91, v54, v55
v_cvt_pk_bf16_f32 v92, v56, v57
v_cvt_pk_bf16_f32 v93, v58, v59
v_cvt_pk_bf16_f32 v94, v60, v61
v_cvt_pk_bf16_f32 v95, v62, v63
s_mov_b32 s44, 14336
buffer_store_dwordx4 v[88:91], v224, s[28:31], s44 offen sc1
s_mov_b32 s44, 15360
buffer_store_dwordx4 v[92:95], v224, s[28:31], s44 offen sc1
s_waitcnt lgkmcnt(10)
v_mfma_f32_32x32x16_bf16 a[144:159], a[240:243], v[192:195], a[144:159]
v_add_u32 v246, 0x8000, v246
ds_read_b64_tr_b16 a[236:237], v246 offset:640
ds_read_b64_tr_b16 a[238:239], v246 offset:7808
v_mfma_f32_32x32x16_bf16 a[144:159], a[244:247], v[196:199], a[144:159]
v_add_u32 v247, 0xfffec000, v247
ds_read_b64_tr_b16 a[240:241], v247 offset:640
ds_read_b64_tr_b16 a[242:243], v247 offset:7808
s_waitcnt lgkmcnt(10)
v_mfma_f32_32x32x16_bf16 a[144:159], a[248:251], v[200:203], a[144:159]
v_add_u32 v247, 0x1c000, v247
ds_read_b64_tr_b16 a[244:245], v247 offset:640
ds_read_b64_tr_b16 a[246:247], v247 offset:7808
v_mfma_f32_32x32x16_bf16 a[144:159], a[252:255], v[204:207], a[144:159]
v_add_u32 v247, 0xffff0000, v247
ds_read_b64_tr_b16 a[248:249], v247 offset:640
ds_read_b64_tr_b16 a[250:251], v247 offset:7808
v_accvgpr_read_b32 v0, a128
v_accvgpr_read_b32 v1, a129
v_accvgpr_read_b32 v2, a130
v_accvgpr_read_b32 v3, a131
v_accvgpr_read_b32 v4, a132
v_accvgpr_read_b32 v5, a133
v_accvgpr_read_b32 v6, a134
v_accvgpr_read_b32 v7, a135
v_accvgpr_read_b32 v8, a136
v_accvgpr_read_b32 v9, a137
v_accvgpr_read_b32 v10, a138
v_accvgpr_read_b32 v11, a139
v_accvgpr_read_b32 v12, a140
v_accvgpr_read_b32 v13, a141
v_accvgpr_read_b32 v14, a142
v_accvgpr_read_b32 v15, a143
v_cvt_pk_bf16_f32 v64, v0, v1
v_cvt_pk_bf16_f32 v65, v2, v3
v_cvt_pk_bf16_f32 v66, v4, v5
v_cvt_pk_bf16_f32 v67, v6, v7
v_cvt_pk_bf16_f32 v68, v8, v9
v_cvt_pk_bf16_f32 v69, v10, v11
v_cvt_pk_bf16_f32 v70, v12, v13
v_cvt_pk_bf16_f32 v71, v14, v15
s_mov_b32 s44, 16384
buffer_store_dwordx4 v[64:67], v224, s[28:31], s44 offen sc1
s_mov_b32 s44, 17408
buffer_store_dwordx4 v[68:71], v224, s[28:31], s44 offen sc1
s_waitcnt lgkmcnt(10)
v_mfma_f32_32x32x16_bf16 a[160:175], a[224:227], v[192:195], a[160:175]
v_add_u32 v247, 0x8000, v247
ds_read_b64_tr_b16 a[252:253], v247 offset:640
ds_read_b64_tr_b16 a[254:255], v247 offset:7808
v_mfma_f32_32x32x16_bf16 a[160:175], a[228:231], v[196:199], a[160:175]
v_add_u32 v246, 0xfffec000, v246
ds_read_b64_tr_b16 a[224:225], v246 offset:768
ds_read_b64_tr_b16 a[226:227], v246 offset:7936
s_waitcnt lgkmcnt(10)
v_mfma_f32_32x32x16_bf16 a[160:175], a[232:235], v[200:203], a[160:175]
v_add_u32 v246, 0x1c000, v246
ds_read_b64_tr_b16 a[228:229], v246 offset:768
ds_read_b64_tr_b16 a[230:231], v246 offset:7936
v_mfma_f32_32x32x16_bf16 a[160:175], a[236:239], v[204:207], a[160:175]
v_add_u32 v246, 0xffff0000, v246
ds_read_b64_tr_b16 a[232:233], v246 offset:768
ds_read_b64_tr_b16 a[234:235], v246 offset:7936
v_accvgpr_read_b32 v16, a144
v_accvgpr_read_b32 v17, a145
v_accvgpr_read_b32 v18, a146
v_accvgpr_read_b32 v19, a147
v_accvgpr_read_b32 v20, a148
v_accvgpr_read_b32 v21, a149
v_accvgpr_read_b32 v22, a150
v_accvgpr_read_b32 v23, a151
v_accvgpr_read_b32 v24, a152
v_accvgpr_read_b32 v25, a153
v_accvgpr_read_b32 v26, a154
v_accvgpr_read_b32 v27, a155
v_accvgpr_read_b32 v28, a156
v_accvgpr_read_b32 v29, a157
v_accvgpr_read_b32 v30, a158
v_accvgpr_read_b32 v31, a159
v_cvt_pk_bf16_f32 v72, v16, v17
v_cvt_pk_bf16_f32 v73, v18, v19
v_cvt_pk_bf16_f32 v74, v20, v21
v_cvt_pk_bf16_f32 v75, v22, v23
v_cvt_pk_bf16_f32 v76, v24, v25
v_cvt_pk_bf16_f32 v77, v26, v27
v_cvt_pk_bf16_f32 v78, v28, v29
v_cvt_pk_bf16_f32 v79, v30, v31
s_mov_b32 s44, 18432
buffer_store_dwordx4 v[72:75], v224, s[28:31], s44 offen sc1
s_mov_b32 s44, 19456
buffer_store_dwordx4 v[76:79], v224, s[28:31], s44 offen sc1
s_waitcnt lgkmcnt(10)
v_mfma_f32_32x32x16_bf16 a[176:191], a[240:243], v[192:195], a[176:191]
v_add_u32 v246, 0x8000, v246
ds_read_b64_tr_b16 a[236:237], v246 offset:768
ds_read_b64_tr_b16 a[238:239], v246 offset:7936
v_mfma_f32_32x32x16_bf16 a[176:191], a[244:247], v[196:199], a[176:191]
v_add_u32 v247, 0xfffec000, v247
ds_read_b64_tr_b16 a[240:241], v247 offset:768
ds_read_b64_tr_b16 a[242:243], v247 offset:7936
s_waitcnt lgkmcnt(10)
v_mfma_f32_32x32x16_bf16 a[176:191], a[248:251], v[200:203], a[176:191]
v_add_u32 v247, 0x1c000, v247
ds_read_b64_tr_b16 a[244:245], v247 offset:768
ds_read_b64_tr_b16 a[246:247], v247 offset:7936
v_mfma_f32_32x32x16_bf16 a[176:191], a[252:255], v[204:207], a[176:191]
v_add_u32 v247, 0xffff0000, v247
ds_read_b64_tr_b16 a[248:249], v247 offset:768
ds_read_b64_tr_b16 a[250:251], v247 offset:7936
v_accvgpr_read_b32 v32, a160
v_accvgpr_read_b32 v33, a161
v_accvgpr_read_b32 v34, a162
v_accvgpr_read_b32 v35, a163
v_accvgpr_read_b32 v36, a164
v_accvgpr_read_b32 v37, a165
v_accvgpr_read_b32 v38, a166
v_accvgpr_read_b32 v39, a167
v_accvgpr_read_b32 v40, a168
v_accvgpr_read_b32 v41, a169
v_accvgpr_read_b32 v42, a170
v_accvgpr_read_b32 v43, a171
v_accvgpr_read_b32 v44, a172
v_accvgpr_read_b32 v45, a173
v_accvgpr_read_b32 v46, a174
v_accvgpr_read_b32 v47, a175
v_cvt_pk_bf16_f32 v80, v32, v33
v_cvt_pk_bf16_f32 v81, v34, v35
v_cvt_pk_bf16_f32 v82, v36, v37
v_cvt_pk_bf16_f32 v83, v38, v39
v_cvt_pk_bf16_f32 v84, v40, v41
v_cvt_pk_bf16_f32 v85, v42, v43
v_cvt_pk_bf16_f32 v86, v44, v45
v_cvt_pk_bf16_f32 v87, v46, v47
s_mov_b32 s44, 20480
buffer_store_dwordx4 v[80:83], v224, s[28:31], s44 offen sc1
s_mov_b32 s44, 21504
buffer_store_dwordx4 v[84:87], v224, s[28:31], s44 offen sc1
s_waitcnt lgkmcnt(10)
v_mfma_f32_32x32x16_bf16 a[192:207], a[224:227], v[192:195], a[192:207]
v_add_u32 v247, 0x8000, v247
ds_read_b64_tr_b16 a[252:253], v247 offset:768
ds_read_b64_tr_b16 a[254:255], v247 offset:7936
v_mfma_f32_32x32x16_bf16 a[192:207], a[228:231], v[196:199], a[192:207]
s_waitcnt lgkmcnt(8)
v_mfma_f32_32x32x16_bf16 a[192:207], a[232:235], v[200:203], a[192:207]
v_mfma_f32_32x32x16_bf16 a[192:207], a[236:239], v[204:207], a[192:207]
v_accvgpr_read_b32 v48, a176
v_accvgpr_read_b32 v49, a177
v_accvgpr_read_b32 v50, a178
v_accvgpr_read_b32 v51, a179
v_accvgpr_read_b32 v52, a180
v_accvgpr_read_b32 v53, a181
v_accvgpr_read_b32 v54, a182
v_accvgpr_read_b32 v55, a183
v_accvgpr_read_b32 v56, a184
v_accvgpr_read_b32 v57, a185
v_accvgpr_read_b32 v58, a186
v_accvgpr_read_b32 v59, a187
v_accvgpr_read_b32 v60, a188
v_accvgpr_read_b32 v61, a189
v_accvgpr_read_b32 v62, a190
v_accvgpr_read_b32 v63, a191
v_cvt_pk_bf16_f32 v88, v48, v49
v_cvt_pk_bf16_f32 v89, v50, v51
v_cvt_pk_bf16_f32 v90, v52, v53
v_cvt_pk_bf16_f32 v91, v54, v55
v_cvt_pk_bf16_f32 v92, v56, v57
v_cvt_pk_bf16_f32 v93, v58, v59
v_cvt_pk_bf16_f32 v94, v60, v61
v_cvt_pk_bf16_f32 v95, v62, v63
s_mov_b32 s44, 22528
buffer_store_dwordx4 v[88:91], v224, s[28:31], s44 offen sc1
s_mov_b32 s44, 23552
buffer_store_dwordx4 v[92:95], v224, s[28:31], s44 offen sc1
s_waitcnt lgkmcnt(4)
v_mfma_f32_32x32x16_bf16 a[208:223], a[240:243], v[192:195], a[208:223]
v_mfma_f32_32x32x16_bf16 a[208:223], a[244:247], v[196:199], a[208:223]
s_waitcnt lgkmcnt(0)
v_mfma_f32_32x32x16_bf16 a[208:223], a[248:251], v[200:203], a[208:223]
v_mfma_f32_32x32x16_bf16 a[208:223], a[252:255], v[204:207], a[208:223]
v_accvgpr_read_b32 v0, a192
v_accvgpr_read_b32 v1, a193
v_accvgpr_read_b32 v2, a194
v_accvgpr_read_b32 v3, a195
v_accvgpr_read_b32 v4, a196
v_accvgpr_read_b32 v5, a197
v_accvgpr_read_b32 v6, a198
v_accvgpr_read_b32 v7, a199
v_accvgpr_read_b32 v8, a200
v_accvgpr_read_b32 v9, a201
v_accvgpr_read_b32 v10, a202
v_accvgpr_read_b32 v11, a203
v_accvgpr_read_b32 v12, a204
v_accvgpr_read_b32 v13, a205
v_accvgpr_read_b32 v14, a206
v_accvgpr_read_b32 v15, a207
v_cvt_pk_bf16_f32 v64, v0, v1
v_cvt_pk_bf16_f32 v65, v2, v3
v_cvt_pk_bf16_f32 v66, v4, v5
v_cvt_pk_bf16_f32 v67, v6, v7
v_cvt_pk_bf16_f32 v68, v8, v9
v_cvt_pk_bf16_f32 v69, v10, v11
v_cvt_pk_bf16_f32 v70, v12, v13
v_cvt_pk_bf16_f32 v71, v14, v15
s_mov_b32 s44, 24576
buffer_store_dwordx4 v[64:67], v224, s[28:31], s44 offen sc1
s_mov_b32 s44, 25600
buffer_store_dwordx4 v[68:71], v224, s[28:31], s44 offen sc1
s_nop 7
s_nop 3
v_accvgpr_read_b32 v16, a208
v_accvgpr_read_b32 v17, a209
v_accvgpr_read_b32 v18, a210
v_accvgpr_read_b32 v19, a211
v_accvgpr_read_b32 v20, a212
v_accvgpr_read_b32 v21, a213
v_accvgpr_read_b32 v22, a214
v_accvgpr_read_b32 v23, a215
v_accvgpr_read_b32 v24, a216
v_accvgpr_read_b32 v25, a217
v_accvgpr_read_b32 v26, a218
v_accvgpr_read_b32 v27, a219
v_accvgpr_read_b32 v28, a220
v_accvgpr_read_b32 v29, a221
v_accvgpr_read_b32 v30, a222
v_accvgpr_read_b32 v31, a223
v_cvt_pk_bf16_f32 v72, v16, v17
v_cvt_pk_bf16_f32 v73, v18, v19
v_cvt_pk_bf16_f32 v74, v20, v21
v_cvt_pk_bf16_f32 v75, v22, v23
v_cvt_pk_bf16_f32 v76, v24, v25
v_cvt_pk_bf16_f32 v77, v26, v27
v_cvt_pk_bf16_f32 v78, v28, v29
v_cvt_pk_bf16_f32 v79, v30, v31
s_mov_b32 s44, 26624
buffer_store_dwordx4 v[72:75], v224, s[28:31], s44 offen sc1
s_mov_b32 s44, 27648
buffer_store_dwordx4 v[76:79], v224, s[28:31], s44 offen sc1
s_and_b32 s7, s5, 3
s_lshr_b32 s46, s5, 2
s_mul_i32 s46, s46, 7
s_add_u32 s46, s46, s3
s_mul_i32 s47, s7, 28672
s_lshl_b32 s55, s46, 10
s_add_u32 s55, s55, s47
v_lshlrev_b32 v8, 4, v255
v_add_u32 v8, s55, v8
v_and_b32 v9, 31, v255
s_lshl_b32 s55, s7, 5
v_add_u32 v9, s55, v9
v_cmp_gt_u32 vcc, 112, v9
v_mov_b32 v10, 0x40000000
v_mul_u32_u24 v11, 896, v9
v_cndmask_b32 v8, v10, v8, vcc
v_lshrrev_b32 v12, 5, v255
v_lshl_add_u32 v11, v12, 4, v11
s_lshl_b32 s55, s46, 5
v_add_u32 v11, s55, v11
v_cndmask_b32 v11, v10, v11, vcc
v_lshlrev_b32 v5, 7, v255
v_cmp_gt_u32 vcc, 16, v255
s_mov_b32 s58, 0x00003f80
s_mov_b32 s59, 0x3f800000
v_cndmask_b32 v5, v10, v5, vcc
s_cmp_eq_u32 s3, 3
s_cselect_b32 s55, 0x40000000, 4096
v_add_u32 v9, s55, v8
s_cselect_b32 s55, 0x40000000, 128
v_add_u32 v12, s55, v11
s_lshl_b32 s55, s5, 7
v_mov_b32 v4, s55
s_waitcnt vmcnt(0)
v_readfirstlane_b32 s52, v227
s_cmp_eq_u32 s52, 0
s_cbranch_scc1 L_nonce_slow
L_nonce_back:
v_mov_b32 v3, s52
s_barrier
s_cmp_lg_u32 s3, 0
s_cbranch_scc1 L_polled5
s_mov_b64 exec, 1
buffer_store_dword v3, v4, s[36:39], 0 offen sc1
s_mov_b64 exec, -1
s_mov_b32 s53, 0
L_poll5:
buffer_load_dword v6, v5, s[36:39], 0 offen sc1
s_add_u32 s53, s53, 1
s_waitcnt vmcnt(0)
v_cmp_eq_u32 vcc, v6, v3
s_cmp_ge_u32 s53, 100000
s_cbranch_scc1 L_polled5
s_cmp_eq_u32 vcc_lo, 0xffff
s_cbranch_scc0 L_poll5
L_polled5:
s_barrier
s_mov_b32 s44, 0
buffer_load_dwordx4 v[16:19], v8, s[28:31], s44 offen sc1
buffer_load_dwordx4 v[80:83], v9, s[28:31], s44 offen sc1
s_mov_b32 s44, 114688
buffer_load_dwordx4 v[20:23], v8, s[28:31], s44 offen sc1
buffer_load_dwordx4 v[84:87], v9, s[28:31], s44 offen sc1
s_mov_b32 s44, 229376
buffer_load_dwordx4 v[24:27], v8, s[28:31], s44 offen sc1
buffer_load_dwordx4 v[88:91], v9, s[28:31], s44 offen sc1
s_mov_b32 s44, 344064
buffer_load_dwordx4 v[28:31], v8, s[28:31], s44 offen sc1
buffer_load_dwordx4 v[92:95], v9, s[28:31], s44 offen sc1
s_mov_b32 s44, 458752
buffer_load_dwordx4 v[32:35], v8, s[28:31], s44 offen sc1
buffer_load_dwordx4 v[96:99], v9, s[28:31], s44 offen sc1
s_mov_b32 s44, 573440
buffer_load_dwordx4 v[36:39], v8, s[28:31], s44 offen sc1
buffer_load_dwordx4 v[100:103], v9, s[28:31], s44 offen sc1
s_mov_b32 s44, 688128
buffer_load_dwordx4 v[40:43], v8, s[28:31], s44 offen sc1
buffer_load_dwordx4 v[104:107], v9, s[28:31], s44 offen sc1
s_mov_b32 s44, 802816
buffer_load_dwordx4 v[44:47], v8, s[28:31], s44 offen sc1
buffer_load_dwordx4 v[108:111], v9, s[28:31], s44 offen sc1
s_mov_b32 s44, 917504
buffer_load_dwordx4 v[48:51], v8, s[28:31], s44 offen sc1
buffer_load_dwordx4 v[112:115], v9, s[28:31], s44 offen sc1
s_mov_b32 s44, 1032192
buffer_load_dwordx4 v[52:55], v8, s[28:31], s44 offen sc1
buffer_load_dwordx4 v[116:119], v9, s[28:31], s44 offen sc1
s_mov_b32 s44, 1146880
buffer_load_dwordx4 v[56:59], v8, s[28:31], s44 offen sc1
buffer_load_dwordx4 v[120:123], v9, s[28:31], s44 offen sc1
s_mov_b32 s44, 1261568
buffer_load_dwordx4 v[60:63], v8, s[28:31], s44 offen sc1
buffer_load_dwordx4 v[124:127], v9, s[28:31], s44 offen sc1
s_mov_b32 s44, 1376256
buffer_load_dwordx4 v[64:67], v8, s[28:31], s44 offen sc1
buffer_load_dwordx4 v[128:131], v9, s[28:31], s44 offen sc1
s_mov_b32 s44, 1490944
buffer_load_dwordx4 v[68:71], v8, s[28:31], s44 offen sc1
buffer_load_dwordx4 v[132:135], v9, s[28:31], s44 offen sc1
s_mov_b32 s44, 1605632
buffer_load_dwordx4 v[72:75], v8, s[28:31], s44 offen sc1
buffer_load_dwordx4 v[136:139], v9, s[28:31], s44 offen sc1
s_mov_b32 s44, 1720320
buffer_load_dwordx4 v[76:79], v8, s[28:31], s44 offen sc1
buffer_load_dwordx4 v[140:143], v9, s[28:31], s44 offen sc1
s_waitcnt vmcnt(30)
v_dot2_f32_bf16 v144, v16, s58, 0
v_dot2_f32_bf16 v145, v16, s59, 0
v_dot2_f32_bf16 v146, v17, s58, 0
v_dot2_f32_bf16 v147, v17, s59, 0
v_dot2_f32_bf16 v148, v18, s58, 0
v_dot2_f32_bf16 v149, v18, s59, 0
v_dot2_f32_bf16 v150, v19, s58, 0
v_dot2_f32_bf16 v151, v19, s59, 0
v_dot2_f32_bf16 v152, v80, s58, 0
v_dot2_f32_bf16 v153, v80, s59, 0
v_dot2_f32_bf16 v154, v81, s58, 0
v_dot2_f32_bf16 v155, v81, s59, 0
v_dot2_f32_bf16 v156, v82, s58, 0
v_dot2_f32_bf16 v157, v82, s59, 0
v_dot2_f32_bf16 v158, v83, s58, 0
v_dot2_f32_bf16 v159, v83, s59, 0
s_waitcnt vmcnt(28)
v_dot2_f32_bf16 v144, v20, s58, v144
v_dot2_f32_bf16 v145, v20, s59, v145
v_dot2_f32_bf16 v146, v21, s58, v146
v_dot2_f32_bf16 v147, v21, s59, v147
v_dot2_f32_bf16 v148, v22, s58, v148
v_dot2_f32_bf16 v149, v22, s59, v149
v_dot2_f32_bf16 v150, v23, s58, v150
v_dot2_f32_bf16 v151, v23, s59, v151
v_dot2_f32_bf16 v152, v84, s58, v152
v_dot2_f32_bf16 v153, v84, s59, v153
v_dot2_f32_bf16 v154, v85, s58, v154
v_dot2_f32_bf16 v155, v85, s59, v155
v_dot2_f32_bf16 v156, v86, s58, v156
v_dot2_f32_bf16 v157, v86, s59, v157
v_dot2_f32_bf16 v158, v87, s58, v158
v_dot2_f32_bf16 v159, v87, s59, v159
s_waitcnt vmcnt(26)
v_dot2_f32_bf16 v144, v24, s58, v144
v_dot2_f32_bf16 v145, v24, s59, v145
v_dot2_f32_bf16 v146, v25, s58, v146
v_dot2_f32_bf16 v147, v25, s59, v147
v_dot2_f32_bf16 v148, v26, s58, v148
v_dot2_f32_bf16 v149, v26, s59, v149
v_dot2_f32_bf16 v150, v27, s58, v150
v_dot2_f32_bf16 v151, v27, s59, v151
v_dot2_f32_bf16 v152, v88, s58, v152
v_dot2_f32_bf16 v153, v88, s59, v153
v_dot2_f32_bf16 v154, v89, s58, v154
v_dot2_f32_bf16 v155, v89, s59, v155
v_dot2_f32_bf16 v156, v90, s58, v156
v_dot2_f32_bf16 v157, v90, s59, v157
v_dot2_f32_bf16 v158, v91, s58, v158
v_dot2_f32_bf16 v159, v91, s59, v159
s_waitcnt vmcnt(24)
v_dot2_f32_bf16 v144, v28, s58, v144
v_dot2_f32_bf16 v145, v28, s59, v145
v_dot2_f32_bf16 v146, v29, s58, v146
v_dot2_f32_bf16 v147, v29, s59, v147
v_dot2_f32_bf16 v148, v30, s58, v148
v_dot2_f32_bf16 v149, v30, s59, v149
v_dot2_f32_bf16 v150, v31, s58, v150
v_dot2_f32_bf16 v151, v31, s59, v151
v_dot2_f32_bf16 v152, v92, s58, v152
v_dot2_f32_bf16 v153, v92, s59, v153
v_dot2_f32_bf16 v154, v93, s58, v154
v_dot2_f32_bf16 v155, v93, s59, v155
v_dot2_f32_bf16 v156, v94, s58, v156
v_dot2_f32_bf16 v157, v94, s59, v157
v_dot2_f32_bf16 v158, v95, s58, v158
v_dot2_f32_bf16 v159, v95, s59, v159
s_waitcnt vmcnt(22)
v_dot2_f32_bf16 v144, v32, s58, v144
v_dot2_f32_bf16 v145, v32, s59, v145
v_dot2_f32_bf16 v146, v33, s58, v146
v_dot2_f32_bf16 v147, v33, s59, v147
v_dot2_f32_bf16 v148, v34, s58, v148
v_dot2_f32_bf16 v149, v34, s59, v149
v_dot2_f32_bf16 v150, v35, s58, v150
v_dot2_f32_bf16 v151, v35, s59, v151
v_dot2_f32_bf16 v152, v96, s58, v152
v_dot2_f32_bf16 v153, v96, s59, v153
v_dot2_f32_bf16 v154, v97, s58, v154
v_dot2_f32_bf16 v155, v97, s59, v155
v_dot2_f32_bf16 v156, v98, s58, v156
v_dot2_f32_bf16 v157, v98, s59, v157
v_dot2_f32_bf16 v158, v99, s58, v158
v_dot2_f32_bf16 v159, v99, s59, v159
s_waitcnt vmcnt(20)
v_dot2_f32_bf16 v144, v36, s58, v144
v_dot2_f32_bf16 v145, v36, s59, v145
v_dot2_f32_bf16 v146, v37, s58, v146
v_dot2_f32_bf16 v147, v37, s59, v147
v_dot2_f32_bf16 v148, v38, s58, v148
v_dot2_f32_bf16 v149, v38, s59, v149
v_dot2_f32_bf16 v150, v39, s58, v150
v_dot2_f32_bf16 v151, v39, s59, v151
v_dot2_f32_bf16 v152, v100, s58, v152
v_dot2_f32_bf16 v153, v100, s59, v153
v_dot2_f32_bf16 v154, v101, s58, v154
v_dot2_f32_bf16 v155, v101, s59, v155
v_dot2_f32_bf16 v156, v102, s58, v156
v_dot2_f32_bf16 v157, v102, s59, v157
v_dot2_f32_bf16 v158, v103, s58, v158
v_dot2_f32_bf16 v159, v103, s59, v159
s_waitcnt vmcnt(18)
v_dot2_f32_bf16 v144, v40, s58, v144
v_dot2_f32_bf16 v145, v40, s59, v145
v_dot2_f32_bf16 v146, v41, s58, v146
v_dot2_f32_bf16 v147, v41, s59, v147
v_dot2_f32_bf16 v148, v42, s58, v148
v_dot2_f32_bf16 v149, v42, s59, v149
v_dot2_f32_bf16 v150, v43, s58, v150
v_dot2_f32_bf16 v151, v43, s59, v151
v_dot2_f32_bf16 v152, v104, s58, v152
v_dot2_f32_bf16 v153, v104, s59, v153
v_dot2_f32_bf16 v154, v105, s58, v154
v_dot2_f32_bf16 v155, v105, s59, v155
v_dot2_f32_bf16 v156, v106, s58, v156
v_dot2_f32_bf16 v157, v106, s59, v157
v_dot2_f32_bf16 v158, v107, s58, v158
v_dot2_f32_bf16 v159, v107, s59, v159
s_waitcnt vmcnt(16)
v_dot2_f32_bf16 v144, v44, s58, v144
v_dot2_f32_bf16 v145, v44, s59, v145
v_dot2_f32_bf16 v146, v45, s58, v146
v_dot2_f32_bf16 v147, v45, s59, v147
v_dot2_f32_bf16 v148, v46, s58, v148
v_dot2_f32_bf16 v149, v46, s59, v149
v_dot2_f32_bf16 v150, v47, s58, v150
v_dot2_f32_bf16 v151, v47, s59, v151
v_dot2_f32_bf16 v152, v108, s58, v152
v_dot2_f32_bf16 v153, v108, s59, v153
v_dot2_f32_bf16 v154, v109, s58, v154
v_dot2_f32_bf16 v155, v109, s59, v155
v_dot2_f32_bf16 v156, v110, s58, v156
v_dot2_f32_bf16 v157, v110, s59, v157
v_dot2_f32_bf16 v158, v111, s58, v158
v_dot2_f32_bf16 v159, v111, s59, v159
s_waitcnt vmcnt(14)
v_dot2_f32_bf16 v144, v48, s58, v144
v_dot2_f32_bf16 v145, v48, s59, v145
v_dot2_f32_bf16 v146, v49, s58, v146
v_dot2_f32_bf16 v147, v49, s59, v147
v_dot2_f32_bf16 v148, v50, s58, v148
v_dot2_f32_bf16 v149, v50, s59, v149
v_dot2_f32_bf16 v150, v51, s58, v150
v_dot2_f32_bf16 v151, v51, s59, v151
v_dot2_f32_bf16 v152, v112, s58, v152
v_dot2_f32_bf16 v153, v112, s59, v153
v_dot2_f32_bf16 v154, v113, s58, v154
v_dot2_f32_bf16 v155, v113, s59, v155
v_dot2_f32_bf16 v156, v114, s58, v156
v_dot2_f32_bf16 v157, v114, s59, v157
v_dot2_f32_bf16 v158, v115, s58, v158
v_dot2_f32_bf16 v159, v115, s59, v159
s_waitcnt vmcnt(12)
v_dot2_f32_bf16 v144, v52, s58, v144
v_dot2_f32_bf16 v145, v52, s59, v145
v_dot2_f32_bf16 v146, v53, s58, v146
v_dot2_f32_bf16 v147, v53, s59, v147
v_dot2_f32_bf16 v148, v54, s58, v148
v_dot2_f32_bf16 v149, v54, s59, v149
v_dot2_f32_bf16 v150, v55, s58, v150
v_dot2_f32_bf16 v151, v55, s59, v151
v_dot2_f32_bf16 v152, v116, s58, v152
v_dot2_f32_bf16 v153, v116, s59, v153
v_dot2_f32_bf16 v154, v117, s58, v154
v_dot2_f32_bf16 v155, v117, s59, v155
v_dot2_f32_bf16 v156, v118, s58, v156
v_dot2_f32_bf16 v157, v118, s59, v157
v_dot2_f32_bf16 v158, v119, s58, v158
v_dot2_f32_bf16 v159, v119, s59, v159
s_waitcnt vmcnt(10)
v_dot2_f32_bf16 v144, v56, s58, v144
v_dot2_f32_bf16 v145, v56, s59, v145
v_dot2_f32_bf16 v146, v57, s58, v146
v_dot2_f32_bf16 v147, v57, s59, v147
v_dot2_f32_bf16 v148, v58, s58, v148
v_dot2_f32_bf16 v149, v58, s59, v149
v_dot2_f32_bf16 v150, v59, s58, v150
v_dot2_f32_bf16 v151, v59, s59, v151
v_dot2_f32_bf16 v152, v120, s58, v152
v_dot2_f32_bf16 v153, v120, s59, v153
v_dot2_f32_bf16 v154, v121, s58, v154
v_dot2_f32_bf16 v155, v121, s59, v155
v_dot2_f32_bf16 v156, v122, s58, v156
v_dot2_f32_bf16 v157, v122, s59, v157
v_dot2_f32_bf16 v158, v123, s58, v158
v_dot2_f32_bf16 v159, v123, s59, v159
s_waitcnt vmcnt(8)
v_dot2_f32_bf16 v144, v60, s58, v144
v_dot2_f32_bf16 v145, v60, s59, v145
v_dot2_f32_bf16 v146, v61, s58, v146
v_dot2_f32_bf16 v147, v61, s59, v147
v_dot2_f32_bf16 v148, v62, s58, v148
v_dot2_f32_bf16 v149, v62, s59, v149
v_dot2_f32_bf16 v150, v63, s58, v150
v_dot2_f32_bf16 v151, v63, s59, v151
v_dot2_f32_bf16 v152, v124, s58, v152
v_dot2_f32_bf16 v153, v124, s59, v153
v_dot2_f32_bf16 v154, v125, s58, v154
v_dot2_f32_bf16 v155, v125, s59, v155
v_dot2_f32_bf16 v156, v126, s58, v156
v_dot2_f32_bf16 v157, v126, s59, v157
v_dot2_f32_bf16 v158, v127, s58, v158
v_dot2_f32_bf16 v159, v127, s59, v159
s_waitcnt vmcnt(6)
v_dot2_f32_bf16 v144, v64, s58, v144
v_dot2_f32_bf16 v145, v64, s59, v145
v_dot2_f32_bf16 v146, v65, s58, v146
v_dot2_f32_bf16 v147, v65, s59, v147
v_dot2_f32_bf16 v148, v66, s58, v148
v_dot2_f32_bf16 v149, v66, s59, v149
v_dot2_f32_bf16 v150, v67, s58, v150
v_dot2_f32_bf16 v151, v67, s59, v151
v_dot2_f32_bf16 v152, v128, s58, v152
v_dot2_f32_bf16 v153, v128, s59, v153
v_dot2_f32_bf16 v154, v129, s58, v154
v_dot2_f32_bf16 v155, v129, s59, v155
v_dot2_f32_bf16 v156, v130, s58, v156
v_dot2_f32_bf16 v157, v130, s59, v157
v_dot2_f32_bf16 v158, v131, s58, v158
v_dot2_f32_bf16 v159, v131, s59, v159
s_waitcnt vmcnt(4)
v_dot2_f32_bf16 v144, v68, s58, v144
v_dot2_f32_bf16 v145, v68, s59, v145
v_dot2_f32_bf16 v146, v69, s58, v146
v_dot2_f32_bf16 v147, v69, s59, v147
v_dot2_f32_bf16 v148, v70, s58, v148
v_dot2_f32_bf16 v149, v70, s59, v149
v_dot2_f32_bf16 v150, v71, s58, v150
v_dot2_f32_bf16 v151, v71, s59, v151
v_dot2_f32_bf16 v152, v132, s58, v152
v_dot2_f32_bf16 v153, v132, s59, v153
v_dot2_f32_bf16 v154, v133, s58, v154
v_dot2_f32_bf16 v155, v133, s59, v155
v_dot2_f32_bf16 v156, v134, s58, v156
v_dot2_f32_bf16 v157, v134, s59, v157
v_dot2_f32_bf16 v158, v135, s58, v158
v_dot2_f32_bf16 v159, v135, s59, v159
s_waitcnt vmcnt(2)
v_dot2_f32_bf16 v144, v72, s58, v144
v_dot2_f32_bf16 v145, v72, s59, v145
v_dot2_f32_bf16 v146, v73, s58, v146
v_dot2_f32_bf16 v147, v73, s59, v147
v_dot2_f32_bf16 v148, v74, s58, v148
v_dot2_f32_bf16 v149, v74, s59, v149
v_dot2_f32_bf16 v150, v75, s58, v150
v_dot2_f32_bf16 v151, v75, s59, v151
v_dot2_f32_bf16 v152, v136, s58, v152
v_dot2_f32_bf16 v153, v136, s59, v153
v_dot2_f32_bf16 v154, v137, s58, v154
v_dot2_f32_bf16 v155, v137, s59, v155
v_dot2_f32_bf16 v156, v138, s58, v156
v_dot2_f32_bf16 v157, v138, s59, v157
v_dot2_f32_bf16 v158, v139, s58, v158
v_dot2_f32_bf16 v159, v139, s59, v159
s_waitcnt vmcnt(0)
v_dot2_f32_bf16 v144, v76, s58, v144
v_dot2_f32_bf16 v145, v76, s59, v145
v_dot2_f32_bf16 v146, v77, s58, v146
v_dot2_f32_bf16 v147, v77, s59, v147
v_dot2_f32_bf16 v148, v78, s58, v148
v_dot2_f32_bf16 v149, v78, s59, v149
v_dot2_f32_bf16 v150, v79, s58, v150
v_dot2_f32_bf16 v151, v79, s59, v151
v_dot2_f32_bf16 v152, v140, s58, v152
v_dot2_f32_bf16 v153, v140, s59, v153
v_dot2_f32_bf16 v154, v141, s58, v154
v_dot2_f32_bf16 v155, v141, s59, v155
v_dot2_f32_bf16 v156, v142, s58, v156
v_dot2_f32_bf16 v157, v142, s59, v157
v_dot2_f32_bf16 v158, v143, s58, v158
v_dot2_f32_bf16 v159, v143, s59, v159
s_nop 2
v_cvt_pk_bf16_f32 v160, v144, v145
v_cvt_pk_bf16_f32 v161, v146, v147
v_cvt_pk_bf16_f32 v162, v148, v149
v_cvt_pk_bf16_f32 v163, v150, v151
buffer_store_dwordx4 v[160:163], v11, s[32:35], 0 offen
v_cvt_pk_bf16_f32 v164, v152, v153
v_cvt_pk_bf16_f32 v165, v154, v155
v_cvt_pk_bf16_f32 v166, v156, v157
v_cvt_pk_bf16_f32 v167, v158, v159
buffer_store_dwordx4 v[164:167], v12, s[32:35], 0 offen
L_end:
s_endpgm
L_rare1:
s_call_b64 s[48:49], L_rare_s1
v_cvt_pk_bf16_f32 v8, v192, v193
v_cvt_pk_bf16_f32 v9, v194, v195
v_cvt_pk_bf16_f32 v10, v196, v197
v_cvt_pk_bf16_f32 v11, v198, v199
v_cvt_pk_bf16_f32 v12, v200, v201
v_cvt_pk_bf16_f32 v13, v202, v203
v_cvt_pk_bf16_f32 v14, v204, v205
v_cvt_pk_bf16_f32 v15, v206, v207
s_branch L_back1
L_rare2:
s_call_b64 s[48:49], L_rare_s0
v_cvt_pk_bf16_f32 v16, v192, v193
v_cvt_pk_bf16_f32 v17, v194, v195
v_cvt_pk_bf16_f32 v18, v196, v197
v_cvt_pk_bf16_f32 v19, v198, v199
v_cvt_pk_bf16_f32 v20, v200, v201
v_cvt_pk_bf16_f32 v21, v202, v203
v_cvt_pk_bf16_f32 v22, v204, v205
v_cvt_pk_bf16_f32 v23, v206, v207
s_branch L_back2
L_rare3:
s_call_b64 s[48:49], L_rare_s1
v_cvt_pk_bf16_f32 v24, v192, v193
v_cvt_pk_bf16_f32 v25, v194, v195
v_cvt_pk_bf16_f32 v26, v196, v197
v_cvt_pk_bf16_f32 v27, v198, v199
v_cvt_pk_bf16_f32 v28, v200, v201
v_cvt_pk_bf16_f32 v29, v202, v203
v_cvt_pk_bf16_f32 v30, v204, v205
v_cvt_pk_bf16_f32 v31, v206, v207
s_branch L_back3
L_rare4:
s_call_b64 s[48:49], L_rare_s0
v_cvt_pk_bf16_f32 v32, v192, v193
v_cvt_pk_bf16_f32 v33, v194, v195
v_cvt_pk_bf16_f32 v34, v196, v197
v_cvt_pk_bf16_f32 v35, v198, v199
v_cvt_pk_bf16_f32 v36, v200, v201
v_cvt_pk_bf16_f32 v37, v202, v203
v_cvt_pk_bf16_f32 v38, v204, v205
v_cvt_pk_bf16_f32 v39, v206, v207
s_branch L_back4
L_rare5:
s_call_b64 s[48:49], L_rare_s1
v_cvt_pk_bf16_f32 v40, v192, v193
v_cvt_pk_bf16_f32 v41, v194, v195
v_cvt_pk_bf16_f32 v42, v196, v197
v_cvt_pk_bf16_f32 v43, v198, v199
v_cvt_pk_bf16_f32 v44, v200, v201
v_cvt_pk_bf16_f32 v45, v202, v203
v_cvt_pk_bf16_f32 v46, v204, v205
v_cvt_pk_bf16_f32 v47, v206, v207
s_branch L_back5
L_rare6:
s_call_b64 s[48:49], L_rare_s0
v_cvt_pk_bf16_f32 v48, v192, v193
v_cvt_pk_bf16_f32 v49, v194, v195
v_cvt_pk_bf16_f32 v50, v196, v197
v_cvt_pk_bf16_f32 v51, v198, v199
v_cvt_pk_bf16_f32 v52, v200, v201
v_cvt_pk_bf16_f32 v53, v202, v203
v_cvt_pk_bf16_f32 v54, v204, v205
v_cvt_pk_bf16_f32 v55, v206, v207
s_branch L_back6
L_rare7:
s_call_b64 s[48:49], L_rare_s1
v_cvt_pk_bf16_f32 v56, v192, v193
v_cvt_pk_bf16_f32 v57, v194, v195
v_cvt_pk_bf16_f32 v58, v196, v197
v_cvt_pk_bf16_f32 v59, v198, v199
v_cvt_pk_bf16_f32 v60, v200, v201
v_cvt_pk_bf16_f32 v61, v202, v203
v_cvt_pk_bf16_f32 v62, v204, v205
v_cvt_pk_bf16_f32 v63, v206, v207
s_branch L_back7
L_rare8:
s_call_b64 s[48:49], L_rare_s0
v_cvt_pk_bf16_f32 v64, v192, v193
v_cvt_pk_bf16_f32 v65, v194, v195
v_cvt_pk_bf16_f32 v66, v196, v197
v_cvt_pk_bf16_f32 v67, v198, v199
v_cvt_pk_bf16_f32 v68, v200, v201
v_cvt_pk_bf16_f32 v69, v202, v203
v_cvt_pk_bf16_f32 v70, v204, v205
v_cvt_pk_bf16_f32 v71, v206, v207
s_branch L_back8
L_rare9:
s_call_b64 s[48:49], L_rare_s1
v_cvt_pk_bf16_f32 v72, v192, v193
v_cvt_pk_bf16_f32 v73, v194, v195
v_cvt_pk_bf16_f32 v74, v196, v197
v_cvt_pk_bf16_f32 v75, v198, v199
v_cvt_pk_bf16_f32 v76, v200, v201
v_cvt_pk_bf16_f32 v77, v202, v203
v_cvt_pk_bf16_f32 v78, v204, v205
v_cvt_pk_bf16_f32 v79, v206, v207
s_branch L_back9
L_rare10:
s_call_b64 s[48:49], L_rare_s0
v_cvt_pk_bf16_f32 v80, v192, v193
v_cvt_pk_bf16_f32 v81, v194, v195
v_cvt_pk_bf16_f32 v82, v196, v197
v_cvt_pk_bf16_f32 v83, v198, v199
v_cvt_pk_bf16_f32 v84, v200, v201
v_cvt_pk_bf16_f32 v85, v202, v203
v_cvt_pk_bf16_f32 v86, v204, v205
v_cvt_pk_bf16_f32 v87, v206, v207
s_branch L_back10
L_rare11:
s_call_b64 s[48:49], L_rare_s1
v_cvt_pk_bf16_f32 v88, v192, v193
v_cvt_pk_bf16_f32 v89, v194, v195
v_cvt_pk_bf16_f32 v90, v196, v197
v_cvt_pk_bf16_f32 v91, v198, v199
v_cvt_pk_bf16_f32 v92, v200, v201
v_cvt_pk_bf16_f32 v93, v202, v203
v_cvt_pk_bf16_f32 v94, v204, v205
v_cvt_pk_bf16_f32 v95, v206, v207
s_branch L_back11
L_rare12:
s_call_b64 s[48:49], L_rare_s0
v_cvt_pk_bf16_f32 v96, v192, v193
v_cvt_pk_bf16_f32 v97, v194, v195
v_cvt_pk_bf16_f32 v98, v196, v197
v_cvt_pk_bf16_f32 v99, v198, v199
v_cvt_pk_bf16_f32 v100, v200, v201
v_cvt_pk_bf16_f32 v101, v202, v203
v_cvt_pk_bf16_f32 v102, v204, v205
v_cvt_pk_bf16_f32 v103, v206, v207
s_branch L_back12
L_rare13:
s_call_b64 s[48:49], L_rare_s1
v_cvt_pk_bf16_f32 v104, v192, v193
v_cvt_pk_bf16_f32 v105, v194, v195
v_cvt_pk_bf16_f32 v106, v196, v197
v_cvt_pk_bf16_f32 v107, v198, v199
v_cvt_pk_bf16_f32 v108, v200, v201
v_cvt_pk_bf16_f32 v109, v202, v203
v_cvt_pk_bf16_f32 v110, v204, v205
v_cvt_pk_bf16_f32 v111, v206, v207
s_branch L_back13
L_rare14:
s_call_b64 s[48:49], L_rare_s0
v_cvt_pk_bf16_f32 v112, v192, v193
v_cvt_pk_bf16_f32 v113, v194, v195
v_cvt_pk_bf16_f32 v114, v196, v197
v_cvt_pk_bf16_f32 v115, v198, v199
v_cvt_pk_bf16_f32 v116, v200, v201
v_cvt_pk_bf16_f32 v117, v202, v203
v_cvt_pk_bf16_f32 v118, v204, v205
v_cvt_pk_bf16_f32 v119, v206, v207
s_branch L_back14
L_rare15:
s_call_b64 s[48:49], L_rare_s1
v_mul_f32 v160, v160, v254
v_mul_f32 v161, v161, v254
v_mul_f32 v162, v162, v254
v_mul_f32 v163, v163, v254
v_mul_f32 v164, v164, v254
v_mul_f32 v165, v165, v254
v_mul_f32 v166, v166, v254
v_mul_f32 v167, v167, v254
v_mul_f32 v168, v168, v254
v_mul_f32 v169, v169, v254
v_mul_f32 v170, v170, v254
v_mul_f32 v171, v171, v254
v_mul_f32 v172, v172, v254
v_mul_f32 v173, v173, v254
v_mul_f32 v174, v174, v254
v_mul_f32 v175, v175, v254
v_mul_f32 v176, v176, v254
v_mul_f32 v177, v177, v254
v_mul_f32 v178, v178, v254
v_mul_f32 v179, v179, v254
v_mul_f32 v180, v180, v254
v_mul_f32 v181, v181, v254
v_mul_f32 v182, v182, v254
v_mul_f32 v183, v183, v254
v_mul_f32 v184, v184, v254
v_mul_f32 v185, v185, v254
v_mul_f32 v186, v186, v254
v_mul_f32 v187, v187, v254
v_mul_f32 v188, v188, v254
v_mul_f32 v189, v189, v254
v_mul_f32 v190, v190, v254
v_mul_f32 v191, v191, v254
v_cvt_pk_bf16_f32 v120, v192, v193
v_cvt_pk_bf16_f32 v121, v194, v195
v_cvt_pk_bf16_f32 v122, v196, v197
v_cvt_pk_bf16_f32 v123, v198, v199
v_cvt_pk_bf16_f32 v124, v200, v201
v_cvt_pk_bf16_f32 v125, v202, v203
v_cvt_pk_bf16_f32 v126, v204, v205
v_cvt_pk_bf16_f32 v127, v206, v207
s_branch L_back15
L_rare_s0:
s_nop 7
s_nop 7
v_max3_f32 v253, v128, v129, v130
v_max3_f32 v253, v253, v131, v132
v_max3_f32 v253, v253, v133, v134
v_max3_f32 v253, v253, v135, v136
v_max3_f32 v253, v253, v137, v138
v_max3_f32 v253, v253, v139, v140
v_max3_f32 v253, v253, v141, v142
v_max_f32 v253, v253, v143
v_mov_b32 v254, v253
s_nop 1
v_permlane32_swap_b32 v253, v254
v_max_f32 v253, v253, v254
v_ceil_f32 v253, v253
v_max_f32 v253, 0, v253
v_exp_f32 v254, -v253
v_sub_f32 v249, v249, v253
v_mul_f32 v248, v248, v254
v_mov_b32 v208, v249
v_sub_f32 v128, v128, v253
v_sub_f32 v144, v144, v253
v_mov_b32 v209, v249
v_sub_f32 v129, v129, v253
v_sub_f32 v145, v145, v253
v_mov_b32 v210, v249
v_sub_f32 v130, v130, v253
v_sub_f32 v146, v146, v253
v_mov_b32 v211, v249
v_sub_f32 v131, v131, v253
v_sub_f32 v147, v147, v253
v_mov_b32 v212, v249
v_sub_f32 v132, v132, v253
v_sub_f32 v148, v148, v253
v_mov_b32 v213, v249
v_sub_f32 v133, v133, v253
v_sub_f32 v149, v149, v253
v_mov_b32 v214, v249
v_sub_f32 v134, v134, v253
v_sub_f32 v150, v150, v253
v_mov_b32 v215, v249
v_sub_f32 v135, v135, v253
v_sub_f32 v151, v151, v253
v_mov_b32 v216, v249
v_sub_f32 v136, v136, v253
v_sub_f32 v152, v152, v253
v_mov_b32 v217, v249
v_sub_f32 v137, v137, v253
v_sub_f32 v153, v153, v253
v_mov_b32 v218, v249
v_sub_f32 v138, v138, v253
v_sub_f32 v154, v154, v253
v_mov_b32 v219, v249
v_sub_f32 v139, v139, v253
v_sub_f32 v155, v155, v253
v_mov_b32 v220, v249
v_sub_f32 v140, v140, v253
v_sub_f32 v156, v156, v253
v_mov_b32 v221, v249
v_sub_f32 v141, v141, v253
v_sub_f32 v157, v157, v253
v_mov_b32 v222, v249
v_sub_f32 v142, v142, v253
v_sub_f32 v158, v158, v253
v_mov_b32 v223, v249
v_sub_f32 v143, v143, v253
v_sub_f32 v159, v159, v253
v_lshlrev_b32 v251, 16, v0
v_and_b32 v252, 0xffff0000, v0
v_mul_f32 v251, v251, v254
v_mul_f32 v252, v252, v254
v_cvt_pk_bf16_f32 v0, v251, v252
v_lshlrev_b32 v251, 16, v1
v_and_b32 v252, 0xffff0000, v1
v_mul_f32 v251, v251, v254
v_mul_f32 v252, v252, v254
v_cvt_pk_bf16_f32 v1, v251, v252
v_lshlrev_b32 v251, 16, v2
v_and_b32 v252, 0xffff0000, v2
v_mul_f32 v251, v251, v254
v_mul_f32 v252, v252, v254
v_cvt_pk_bf16_f32 v2, v251, v252
v_lshlrev_b32 v251, 16, v3
v_and_b32 v252, 0xffff0000, v3
v_mul_f32 v251, v251, v254
v_mul_f32 v252, v252, v254
v_cvt_pk_bf16_f32 v3, v251, v252
v_lshlrev_b32 v251, 16, v4
v_and_b32 v252, 0xffff0000, v4
v_mul_f32 v251, v251, v254
v_mul_f32 v252, v252, v254
v_cvt_pk_bf16_f32 v4, v251, v252
v_lshlrev_b32 v251, 16, v5
v_and_b32 v252, 0xffff0000, v5
v_mul_f32 v251, v251, v254
v_mul_f32 v252, v252, v254
v_cvt_pk_bf16_f32 v5, v251, v252
v_lshlrev_b32 v251, 16, v6
v_and_b32 v252, 0xffff0000, v6
v_mul_f32 v251, v251, v254
v_mul_f32 v252, v252, v254
v_cvt_pk_bf16_f32 v6, v251, v252
v_lshlrev_b32 v251, 16, v7
v_and_b32 v252, 0xffff0000, v7
v_mul_f32 v251, v251, v254
v_mul_f32 v252, v252, v254
v_cvt_pk_bf16_f32 v7, v251, v252
v_lshlrev_b32 v251, 16, v8
v_and_b32 v252, 0xffff0000, v8
v_mul_f32 v251, v251, v254
v_mul_f32 v252, v252, v254
v_cvt_pk_bf16_f32 v8, v251, v252
v_lshlrev_b32 v251, 16, v9
v_and_b32 v252, 0xffff0000, v9
v_mul_f32 v251, v251, v254
v_mul_f32 v252, v252, v254
v_cvt_pk_bf16_f32 v9, v251, v252
v_lshlrev_b32 v251, 16, v10
v_and_b32 v252, 0xffff0000, v10
v_mul_f32 v251, v251, v254
v_mul_f32 v252, v252, v254
v_cvt_pk_bf16_f32 v10, v251, v252
v_lshlrev_b32 v251, 16, v11
v_and_b32 v252, 0xffff0000, v11
v_mul_f32 v251, v251, v254
v_mul_f32 v252, v252, v254
v_cvt_pk_bf16_f32 v11, v251, v252
v_lshlrev_b32 v251, 16, v12
v_and_b32 v252, 0xffff0000, v12
v_mul_f32 v251, v251, v254
v_mul_f32 v252, v252, v254
v_cvt_pk_bf16_f32 v12, v251, v252
v_lshlrev_b32 v251, 16, v13
v_and_b32 v252, 0xffff0000, v13
v_mul_f32 v251, v251, v254
v_mul_f32 v252, v252, v254
v_cvt_pk_bf16_f32 v13, v251, v252
v_lshlrev_b32 v251, 16, v14
v_and_b32 v252, 0xffff0000, v14
v_mul_f32 v251, v251, v254
v_mul_f32 v252, v252, v254
v_cvt_pk_bf16_f32 v14, v251, v252
v_lshlrev_b32 v251, 16, v15
v_and_b32 v252, 0xffff0000, v15
v_mul_f32 v251, v251, v254
v_mul_f32 v252, v252, v254
v_cvt_pk_bf16_f32 v15, v251, v252
v_lshlrev_b32 v251, 16, v16
v_and_b32 v252, 0xffff0000, v16
v_mul_f32 v251, v251, v254
v_mul_f32 v252, v252, v254
v_cvt_pk_bf16_f32 v16, v251, v252
v_lshlrev_b32 v251, 16, v17
v_and_b32 v252, 0xffff0000, v17
v_mul_f32 v251, v251, v254
v_mul_f32 v252, v252, v254
v_cvt_pk_bf16_f32 v17, v251, v252
v_lshlrev_b32 v251, 16, v18
v_and_b32 v252, 0xffff0000, v18
v_mul_f32 v251, v251, v254
v_mul_f32 v252, v252, v254
v_cvt_pk_bf16_f32 v18, v251, v252
v_lshlrev_b32 v251, 16, v19
v_and_b32 v252, 0xffff0000, v19
v_mul_f32 v251, v251, v254
v_mul_f32 v252, v252, v254
v_cvt_pk_bf16_f32 v19, v251, v252
v_lshlrev_b32 v251, 16, v20
v_and_b32 v252, 0xffff0000, v20
v_mul_f32 v251, v251, v254
v_mul_f32 v252, v252, v254
v_cvt_pk_bf16_f32 v20, v251, v252
v_lshlrev_b32 v251, 16, v21
v_and_b32 v252, 0xffff0000, v21
v_mul_f32 v251, v251, v254
v_mul_f32 v252, v252, v254
v_cvt_pk_bf16_f32 v21, v251, v252
v_lshlrev_b32 v251, 16, v22
v_and_b32 v252, 0xffff0000, v22
v_mul_f32 v251, v251, v254
v_mul_f32 v252, v252, v254
v_cvt_pk_bf16_f32 v22, v251, v252
v_lshlrev_b32 v251, 16, v23
v_and_b32 v252, 0xffff0000, v23
v_mul_f32 v251, v251, v254
v_mul_f32 v252, v252, v254
v_cvt_pk_bf16_f32 v23, v251, v252
v_lshlrev_b32 v251, 16, v24
v_and_b32 v252, 0xffff0000, v24
v_mul_f32 v251, v251, v254
v_mul_f32 v252, v252, v254
v_cvt_pk_bf16_f32 v24, v251, v252
v_lshlrev_b32 v251, 16, v25
v_and_b32 v252, 0xffff0000, v25
v_mul_f32 v251, v251, v254
v_mul_f32 v252, v252, v254
v_cvt_pk_bf16_f32 v25, v251, v252
v_lshlrev_b32 v251, 16, v26
v_and_b32 v252, 0xffff0000, v26
v_mul_f32 v251, v251, v254
v_mul_f32 v252, v252, v254
v_cvt_pk_bf16_f32 v26, v251, v252
v_lshlrev_b32 v251, 16, v27
v_and_b32 v252, 0xffff0000, v27
v_mul_f32 v251, v251, v254
v_mul_f32 v252, v252, v254
v_cvt_pk_bf16_f32 v27, v251, v252
v_lshlrev_b32 v251, 16, v28
v_and_b32 v252, 0xffff0000, v28
v_mul_f32 v251, v251, v254
v_mul_f32 v252, v252, v254
v_cvt_pk_bf16_f32 v28, v251, v252
v_lshlrev_b32 v251, 16, v29
v_and_b32 v252, 0xffff0000, v29
v_mul_f32 v251, v251, v254
v_mul_f32 v252, v252, v254
v_cvt_pk_bf16_f32 v29, v251, v252
v_lshlrev_b32 v251, 16, v30
v_and_b32 v252, 0xffff0000, v30
v_mul_f32 v251, v251, v254
v_mul_f32 v252, v252, v254
v_cvt_pk_bf16_f32 v30, v251, v252
v_lshlrev_b32 v251, 16, v31
v_and_b32 v252, 0xffff0000, v31
v_mul_f32 v251, v251, v254
v_mul_f32 v252, v252, v254
v_cvt_pk_bf16_f32 v31, v251, v252
v_lshlrev_b32 v251, 16, v32
v_and_b32 v252, 0xffff0000, v32
v_mul_f32 v251, v251, v254
v_mul_f32 v252, v252, v254
v_cvt_pk_bf16_f32 v32, v251, v252
v_lshlrev_b32 v251, 16, v33
v_and_b32 v252, 0xffff0000, v33
v_mul_f32 v251, v251, v254
v_mul_f32 v252, v252, v254
v_cvt_pk_bf16_f32 v33, v251, v252
v_lshlrev_b32 v251, 16, v34
v_and_b32 v252, 0xffff0000, v34
v_mul_f32 v251, v251, v254
v_mul_f32 v252, v252, v254
v_cvt_pk_bf16_f32 v34, v251, v252
v_lshlrev_b32 v251, 16, v35
v_and_b32 v252, 0xffff0000, v35
v_mul_f32 v251, v251, v254
v_mul_f32 v252, v252, v254
v_cvt_pk_bf16_f32 v35, v251, v252
v_lshlrev_b32 v251, 16, v36
v_and_b32 v252, 0xffff0000, v36
v_mul_f32 v251, v251, v254
v_mul_f32 v252, v252, v254
v_cvt_pk_bf16_f32 v36, v251, v252
v_lshlrev_b32 v251, 16, v37
v_and_b32 v252, 0xffff0000, v37
v_mul_f32 v251, v251, v254
v_mul_f32 v252, v252, v254
v_cvt_pk_bf16_f32 v37, v251, v252
v_lshlrev_b32 v251, 16, v38
v_and_b32 v252, 0xffff0000, v38
v_mul_f32 v251, v251, v254
v_mul_f32 v252, v252, v254
v_cvt_pk_bf16_f32 v38, v251, v252
v_lshlrev_b32 v251, 16, v39
v_and_b32 v252, 0xffff0000, v39
v_mul_f32 v251, v251, v254
v_mul_f32 v252, v252, v254
v_cvt_pk_bf16_f32 v39, v251, v252
v_lshlrev_b32 v251, 16, v40
v_and_b32 v252, 0xffff0000, v40
v_mul_f32 v251, v251, v254
v_mul_f32 v252, v252, v254
v_cvt_pk_bf16_f32 v40, v251, v252
v_lshlrev_b32 v251, 16, v41
v_and_b32 v252, 0xffff0000, v41
v_mul_f32 v251, v251, v254
v_mul_f32 v252, v252, v254
v_cvt_pk_bf16_f32 v41, v251, v252
v_lshlrev_b32 v251, 16, v42
v_and_b32 v252, 0xffff0000, v42
v_mul_f32 v251, v251, v254
v_mul_f32 v252, v252, v254
v_cvt_pk_bf16_f32 v42, v251, v252
v_lshlrev_b32 v251, 16, v43
v_and_b32 v252, 0xffff0000, v43
v_mul_f32 v251, v251, v254
v_mul_f32 v252, v252, v254
v_cvt_pk_bf16_f32 v43, v251, v252
v_lshlrev_b32 v251, 16, v44
v_and_b32 v252, 0xffff0000, v44
v_mul_f32 v251, v251, v254
v_mul_f32 v252, v252, v254
v_cvt_pk_bf16_f32 v44, v251, v252
v_lshlrev_b32 v251, 16, v45
v_and_b32 v252, 0xffff0000, v45
v_mul_f32 v251, v251, v254
v_mul_f32 v252, v252, v254
v_cvt_pk_bf16_f32 v45, v251, v252
v_lshlrev_b32 v251, 16, v46
v_and_b32 v252, 0xffff0000, v46
v_mul_f32 v251, v251, v254
v_mul_f32 v252, v252, v254
v_cvt_pk_bf16_f32 v46, v251, v252
v_lshlrev_b32 v251, 16, v47
v_and_b32 v252, 0xffff0000, v47
v_mul_f32 v251, v251, v254
v_mul_f32 v252, v252, v254
v_cvt_pk_bf16_f32 v47, v251, v252
v_lshlrev_b32 v251, 16, v48
v_and_b32 v252, 0xffff0000, v48
v_mul_f32 v251, v251, v254
v_mul_f32 v252, v252, v254
v_cvt_pk_bf16_f32 v48, v251, v252
v_lshlrev_b32 v251, 16, v49
v_and_b32 v252, 0xffff0000, v49
v_mul_f32 v251, v251, v254
v_mul_f32 v252, v252, v254
v_cvt_pk_bf16_f32 v49, v251, v252
v_lshlrev_b32 v251, 16, v50
v_and_b32 v252, 0xffff0000, v50
v_mul_f32 v251, v251, v254
v_mul_f32 v252, v252, v254
v_cvt_pk_bf16_f32 v50, v251, v252
v_lshlrev_b32 v251, 16, v51
v_and_b32 v252, 0xffff0000, v51
v_mul_f32 v251, v251, v254
v_mul_f32 v252, v252, v254
v_cvt_pk_bf16_f32 v51, v251, v252
v_lshlrev_b32 v251, 16, v52
v_and_b32 v252, 0xffff0000, v52
v_mul_f32 v251, v251, v254
v_mul_f32 v252, v252, v254
v_cvt_pk_bf16_f32 v52, v251, v252
v_lshlrev_b32 v251, 16, v53
v_and_b32 v252, 0xffff0000, v53
v_mul_f32 v251, v251, v254
v_mul_f32 v252, v252, v254
v_cvt_pk_bf16_f32 v53, v251, v252
v_lshlrev_b32 v251, 16, v54
v_and_b32 v252, 0xffff0000, v54
v_mul_f32 v251, v251, v254
v_mul_f32 v252, v252, v254
v_cvt_pk_bf16_f32 v54, v251, v252
v_lshlrev_b32 v251, 16, v55
v_and_b32 v252, 0xffff0000, v55
v_mul_f32 v251, v251, v254
v_mul_f32 v252, v252, v254
v_cvt_pk_bf16_f32 v55, v251, v252
v_lshlrev_b32 v251, 16, v56
v_and_b32 v252, 0xffff0000, v56
v_mul_f32 v251, v251, v254
v_mul_f32 v252, v252, v254
v_cvt_pk_bf16_f32 v56, v251, v252
v_lshlrev_b32 v251, 16, v57
v_and_b32 v252, 0xffff0000, v57
v_mul_f32 v251, v251, v254
v_mul_f32 v252, v252, v254
v_cvt_pk_bf16_f32 v57, v251, v252
v_lshlrev_b32 v251, 16, v58
v_and_b32 v252, 0xffff0000, v58
v_mul_f32 v251, v251, v254
v_mul_f32 v252, v252, v254
v_cvt_pk_bf16_f32 v58, v251, v252
v_lshlrev_b32 v251, 16, v59
v_and_b32 v252, 0xffff0000, v59
v_mul_f32 v251, v251, v254
v_mul_f32 v252, v252, v254
v_cvt_pk_bf16_f32 v59, v251, v252
v_lshlrev_b32 v251, 16, v60
v_and_b32 v252, 0xffff0000, v60
v_mul_f32 v251, v251, v254
v_mul_f32 v252, v252, v254
v_cvt_pk_bf16_f32 v60, v251, v252
v_lshlrev_b32 v251, 16, v61
v_and_b32 v252, 0xffff0000, v61
v_mul_f32 v251, v251, v254
v_mul_f32 v252, v252, v254
v_cvt_pk_bf16_f32 v61, v251, v252
v_lshlrev_b32 v251, 16, v62
v_and_b32 v252, 0xffff0000, v62
v_mul_f32 v251, v251, v254
v_mul_f32 v252, v252, v254
v_cvt_pk_bf16_f32 v62, v251, v252
v_lshlrev_b32 v251, 16, v63
v_and_b32 v252, 0xffff0000, v63
v_mul_f32 v251, v251, v254
v_mul_f32 v252, v252, v254
v_cvt_pk_bf16_f32 v63, v251, v252
v_lshlrev_b32 v251, 16, v64
v_and_b32 v252, 0xffff0000, v64
v_mul_f32 v251, v251, v254
v_mul_f32 v252, v252, v254
v_cvt_pk_bf16_f32 v64, v251, v252
v_lshlrev_b32 v251, 16, v65
v_and_b32 v252, 0xffff0000, v65
v_mul_f32 v251, v251, v254
v_mul_f32 v252, v252, v254
v_cvt_pk_bf16_f32 v65, v251, v252
v_lshlrev_b32 v251, 16, v66
v_and_b32 v252, 0xffff0000, v66
v_mul_f32 v251, v251, v254
v_mul_f32 v252, v252, v254
v_cvt_pk_bf16_f32 v66, v251, v252
v_lshlrev_b32 v251, 16, v67
v_and_b32 v252, 0xffff0000, v67
v_mul_f32 v251, v251, v254
v_mul_f32 v252, v252, v254
v_cvt_pk_bf16_f32 v67, v251, v252
v_lshlrev_b32 v251, 16, v68
v_and_b32 v252, 0xffff0000, v68
v_mul_f32 v251, v251, v254
v_mul_f32 v252, v252, v254
v_cvt_pk_bf16_f32 v68, v251, v252
v_lshlrev_b32 v251, 16, v69
v_and_b32 v252, 0xffff0000, v69
v_mul_f32 v251, v251, v254
v_mul_f32 v252, v252, v254
v_cvt_pk_bf16_f32 v69, v251, v252
v_lshlrev_b32 v251, 16, v70
v_and_b32 v252, 0xffff0000, v70
v_mul_f32 v251, v251, v254
v_mul_f32 v252, v252, v254
v_cvt_pk_bf16_f32 v70, v251, v252
v_lshlrev_b32 v251, 16, v71
v_and_b32 v252, 0xffff0000, v71
v_mul_f32 v251, v251, v254
v_mul_f32 v252, v252, v254
v_cvt_pk_bf16_f32 v71, v251, v252
v_lshlrev_b32 v251, 16, v72
v_and_b32 v252, 0xffff0000, v72
v_mul_f32 v251, v251, v254
v_mul_f32 v252, v252, v254
v_cvt_pk_bf16_f32 v72, v251, v252
v_lshlrev_b32 v251, 16, v73
v_and_b32 v252, 0xffff0000, v73
v_mul_f32 v251, v251, v254
v_mul_f32 v252, v252, v254
v_cvt_pk_bf16_f32 v73, v251, v252
v_lshlrev_b32 v251, 16, v74
v_and_b32 v252, 0xffff0000, v74
v_mul_f32 v251, v251, v254
v_mul_f32 v252, v252, v254
v_cvt_pk_bf16_f32 v74, v251, v252
v_lshlrev_b32 v251, 16, v75
v_and_b32 v252, 0xffff0000, v75
v_mul_f32 v251, v251, v254
v_mul_f32 v252, v252, v254
v_cvt_pk_bf16_f32 v75, v251, v252
v_lshlrev_b32 v251, 16, v76
v_and_b32 v252, 0xffff0000, v76
v_mul_f32 v251, v251, v254
v_mul_f32 v252, v252, v254
v_cvt_pk_bf16_f32 v76, v251, v252
v_lshlrev_b32 v251, 16, v77
v_and_b32 v252, 0xffff0000, v77
v_mul_f32 v251, v251, v254
v_mul_f32 v252, v252, v254
v_cvt_pk_bf16_f32 v77, v251, v252
v_lshlrev_b32 v251, 16, v78
v_and_b32 v252, 0xffff0000, v78
v_mul_f32 v251, v251, v254
v_mul_f32 v252, v252, v254
v_cvt_pk_bf16_f32 v78, v251, v252
v_lshlrev_b32 v251, 16, v79
v_and_b32 v252, 0xffff0000, v79
v_mul_f32 v251, v251, v254
v_mul_f32 v252, v252, v254
v_cvt_pk_bf16_f32 v79, v251, v252
v_lshlrev_b32 v251, 16, v80
v_and_b32 v252, 0xffff0000, v80
v_mul_f32 v251, v251, v254
v_mul_f32 v252, v252, v254
v_cvt_pk_bf16_f32 v80, v251, v252
v_lshlrev_b32 v251, 16, v81
v_and_b32 v252, 0xffff0000, v81
v_mul_f32 v251, v251, v254
v_mul_f32 v252, v252, v254
v_cvt_pk_bf16_f32 v81, v251, v252
v_lshlrev_b32 v251, 16, v82
v_and_b32 v252, 0xffff0000, v82
v_mul_f32 v251, v251, v254
v_mul_f32 v252, v252, v254
v_cvt_pk_bf16_f32 v82, v251, v252
v_lshlrev_b32 v251, 16, v83
v_and_b32 v252, 0xffff0000, v83
v_mul_f32 v251, v251, v254
v_mul_f32 v252, v252, v254
v_cvt_pk_bf16_f32 v83, v251, v252
v_lshlrev_b32 v251, 16, v84
v_and_b32 v252, 0xffff0000, v84
v_mul_f32 v251, v251, v254
v_mul_f32 v252, v252, v254
v_cvt_pk_bf16_f32 v84, v251, v252
v_lshlrev_b32 v251, 16, v85
v_and_b32 v252, 0xffff0000, v85
v_mul_f32 v251, v251, v254
v_mul_f32 v252, v252, v254
v_cvt_pk_bf16_f32 v85, v251, v252
v_lshlrev_b32 v251, 16, v86
v_and_b32 v252, 0xffff0000, v86
v_mul_f32 v251, v251, v254
v_mul_f32 v252, v252, v254
v_cvt_pk_bf16_f32 v86, v251, v252
v_lshlrev_b32 v251, 16, v87
v_and_b32 v252, 0xffff0000, v87
v_mul_f32 v251, v251, v254
v_mul_f32 v252, v252, v254
v_cvt_pk_bf16_f32 v87, v251, v252
v_lshlrev_b32 v251, 16, v88
v_and_b32 v252, 0xffff0000, v88
v_mul_f32 v251, v251, v254
v_mul_f32 v252, v252, v254
v_cvt_pk_bf16_f32 v88, v251, v252
v_lshlrev_b32 v251, 16, v89
v_and_b32 v252, 0xffff0000, v89
v_mul_f32 v251, v251, v254
v_mul_f32 v252, v252, v254
v_cvt_pk_bf16_f32 v89, v251, v252
v_lshlrev_b32 v251, 16, v90
v_and_b32 v252, 0xffff0000, v90
v_mul_f32 v251, v251, v254
v_mul_f32 v252, v252, v254
v_cvt_pk_bf16_f32 v90, v251, v252
v_lshlrev_b32 v251, 16, v91
v_and_b32 v252, 0xffff0000, v91
v_mul_f32 v251, v251, v254
v_mul_f32 v252, v252, v254
v_cvt_pk_bf16_f32 v91, v251, v252
v_lshlrev_b32 v251, 16, v92
v_and_b32 v252, 0xffff0000, v92
v_mul_f32 v251, v251, v254
v_mul_f32 v252, v252, v254
v_cvt_pk_bf16_f32 v92, v251, v252
v_lshlrev_b32 v251, 16, v93
v_and_b32 v252, 0xffff0000, v93
v_mul_f32 v251, v251, v254
v_mul_f32 v252, v252, v254
v_cvt_pk_bf16_f32 v93, v251, v252
v_lshlrev_b32 v251, 16, v94
v_and_b32 v252, 0xffff0000, v94
v_mul_f32 v251, v251, v254
v_mul_f32 v252, v252, v254
v_cvt_pk_bf16_f32 v94, v251, v252
v_lshlrev_b32 v251, 16, v95
v_and_b32 v252, 0xffff0000, v95
v_mul_f32 v251, v251, v254
v_mul_f32 v252, v252, v254
v_cvt_pk_bf16_f32 v95, v251, v252
v_lshlrev_b32 v251, 16, v96
v_and_b32 v252, 0xffff0000, v96
v_mul_f32 v251, v251, v254
v_mul_f32 v252, v252, v254
v_cvt_pk_bf16_f32 v96, v251, v252
v_lshlrev_b32 v251, 16, v97
v_and_b32 v252, 0xffff0000, v97
v_mul_f32 v251, v251, v254
v_mul_f32 v252, v252, v254
v_cvt_pk_bf16_f32 v97, v251, v252
v_lshlrev_b32 v251, 16, v98
v_and_b32 v252, 0xffff0000, v98
v_mul_f32 v251, v251, v254
v_mul_f32 v252, v252, v254
v_cvt_pk_bf16_f32 v98, v251, v252
v_lshlrev_b32 v251, 16, v99
v_and_b32 v252, 0xffff0000, v99
v_mul_f32 v251, v251, v254
v_mul_f32 v252, v252, v254
v_cvt_pk_bf16_f32 v99, v251, v252
v_lshlrev_b32 v251, 16, v100
v_and_b32 v252, 0xffff0000, v100
v_mul_f32 v251, v251, v254
v_mul_f32 v252, v252, v254
v_cvt_pk_bf16_f32 v100, v251, v252
v_lshlrev_b32 v251, 16, v101
v_and_b32 v252, 0xffff0000, v101
v_mul_f32 v251, v251, v254
v_mul_f32 v252, v252, v254
v_cvt_pk_bf16_f32 v101, v251, v252
v_lshlrev_b32 v251, 16, v102
v_and_b32 v252, 0xffff0000, v102
v_mul_f32 v251, v251, v254
v_mul_f32 v252, v252, v254
v_cvt_pk_bf16_f32 v102, v251, v252
v_lshlrev_b32 v251, 16, v103
v_and_b32 v252, 0xffff0000, v103
v_mul_f32 v251, v251, v254
v_mul_f32 v252, v252, v254
v_cvt_pk_bf16_f32 v103, v251, v252
v_lshlrev_b32 v251, 16, v104
v_and_b32 v252, 0xffff0000, v104
v_mul_f32 v251, v251, v254
v_mul_f32 v252, v252, v254
v_cvt_pk_bf16_f32 v104, v251, v252
v_lshlrev_b32 v251, 16, v105
v_and_b32 v252, 0xffff0000, v105
v_mul_f32 v251, v251, v254
v_mul_f32 v252, v252, v254
v_cvt_pk_bf16_f32 v105, v251, v252
v_lshlrev_b32 v251, 16, v106
v_and_b32 v252, 0xffff0000, v106
v_mul_f32 v251, v251, v254
v_mul_f32 v252, v252, v254
v_cvt_pk_bf16_f32 v106, v251, v252
v_lshlrev_b32 v251, 16, v107
v_and_b32 v252, 0xffff0000, v107
v_mul_f32 v251, v251, v254
v_mul_f32 v252, v252, v254
v_cvt_pk_bf16_f32 v107, v251, v252
v_lshlrev_b32 v251, 16, v108
v_and_b32 v252, 0xffff0000, v108
v_mul_f32 v251, v251, v254
v_mul_f32 v252, v252, v254
v_cvt_pk_bf16_f32 v108, v251, v252
v_lshlrev_b32 v251, 16, v109
v_and_b32 v252, 0xffff0000, v109
v_mul_f32 v251, v251, v254
v_mul_f32 v252, v252, v254
v_cvt_pk_bf16_f32 v109, v251, v252
v_lshlrev_b32 v251, 16, v110
v_and_b32 v252, 0xffff0000, v110
v_mul_f32 v251, v251, v254
v_mul_f32 v252, v252, v254
v_cvt_pk_bf16_f32 v110, v251, v252
v_lshlrev_b32 v251, 16, v111
v_and_b32 v252, 0xffff0000, v111
v_mul_f32 v251, v251, v254
v_mul_f32 v252, v252, v254
v_cvt_pk_bf16_f32 v111, v251, v252
v_lshlrev_b32 v251, 16, v112
v_and_b32 v252, 0xffff0000, v112
v_mul_f32 v251, v251, v254
v_mul_f32 v252, v252, v254
v_cvt_pk_bf16_f32 v112, v251, v252
v_lshlrev_b32 v251, 16, v113
v_and_b32 v252, 0xffff0000, v113
v_mul_f32 v251, v251, v254
v_mul_f32 v252, v252, v254
v_cvt_pk_bf16_f32 v113, v251, v252
v_lshlrev_b32 v251, 16, v114
v_and_b32 v252, 0xffff0000, v114
v_mul_f32 v251, v251, v254
v_mul_f32 v252, v252, v254
v_cvt_pk_bf16_f32 v114, v251, v252
v_lshlrev_b32 v251, 16, v115
v_and_b32 v252, 0xffff0000, v115
v_mul_f32 v251, v251, v254
v_mul_f32 v252, v252, v254
v_cvt_pk_bf16_f32 v115, v251, v252
v_lshlrev_b32 v251, 16, v116
v_and_b32 v252, 0xffff0000, v116
v_mul_f32 v251, v251, v254
v_mul_f32 v252, v252, v254
v_cvt_pk_bf16_f32 v116, v251, v252
v_lshlrev_b32 v251, 16, v117
v_and_b32 v252, 0xffff0000, v117
v_mul_f32 v251, v251, v254
v_mul_f32 v252, v252, v254
v_cvt_pk_bf16_f32 v117, v251, v252
v_lshlrev_b32 v251, 16, v118
v_and_b32 v252, 0xffff0000, v118
v_mul_f32 v251, v251, v254
v_mul_f32 v252, v252, v254
v_cvt_pk_bf16_f32 v118, v251, v252
v_lshlrev_b32 v251, 16, v119
v_and_b32 v252, 0xffff0000, v119
v_mul_f32 v251, v251, v254
v_mul_f32 v252, v252, v254
v_cvt_pk_bf16_f32 v119, v251, v252
v_lshlrev_b32 v251, 16, v120
v_and_b32 v252, 0xffff0000, v120
v_mul_f32 v251, v251, v254
v_mul_f32 v252, v252, v254
v_cvt_pk_bf16_f32 v120, v251, v252
v_lshlrev_b32 v251, 16, v121
v_and_b32 v252, 0xffff0000, v121
v_mul_f32 v251, v251, v254
v_mul_f32 v252, v252, v254
v_cvt_pk_bf16_f32 v121, v251, v252
v_lshlrev_b32 v251, 16, v122
v_and_b32 v252, 0xffff0000, v122
v_mul_f32 v251, v251, v254
v_mul_f32 v252, v252, v254
v_cvt_pk_bf16_f32 v122, v251, v252
v_lshlrev_b32 v251, 16, v123
v_and_b32 v252, 0xffff0000, v123
v_mul_f32 v251, v251, v254
v_mul_f32 v252, v252, v254
v_cvt_pk_bf16_f32 v123, v251, v252
v_lshlrev_b32 v251, 16, v124
v_and_b32 v252, 0xffff0000, v124
v_mul_f32 v251, v251, v254
v_mul_f32 v252, v252, v254
v_cvt_pk_bf16_f32 v124, v251, v252
v_lshlrev_b32 v251, 16, v125
v_and_b32 v252, 0xffff0000, v125
v_mul_f32 v251, v251, v254
v_mul_f32 v252, v252, v254
v_cvt_pk_bf16_f32 v125, v251, v252
v_lshlrev_b32 v251, 16, v126
v_and_b32 v252, 0xffff0000, v126
v_mul_f32 v251, v251, v254
v_mul_f32 v252, v252, v254
v_cvt_pk_bf16_f32 v126, v251, v252
v_lshlrev_b32 v251, 16, v127
v_and_b32 v252, 0xffff0000, v127
v_mul_f32 v251, v251, v254
v_mul_f32 v252, v252, v254
v_cvt_pk_bf16_f32 v127, v251, v252
v_exp_f32 v192, v128
v_exp_f32 v193, v129
v_exp_f32 v194, v130
v_exp_f32 v195, v131
v_exp_f32 v196, v132
v_exp_f32 v197, v133
v_exp_f32 v198, v134
v_exp_f32 v199, v135
v_exp_f32 v200, v136
v_exp_f32 v201, v137
v_exp_f32 v202, v138
v_exp_f32 v203, v139
v_exp_f32 v204, v140
v_exp_f32 v205, v141
v_exp_f32 v206, v142
v_exp_f32 v207, v143
s_nop 0
v_add_f32 v251, v192, v193
v_add_f32 v251, v251, v194
v_add_f32 v251, v251, v195
v_add_f32 v251, v251, v196
v_add_f32 v251, v251, v197
v_add_f32 v251, v251, v198
v_add_f32 v251, v251, v199
v_add_f32 v251, v251, v200
v_add_f32 v251, v251, v201
v_add_f32 v251, v251, v202
v_add_f32 v251, v251, v203
v_add_f32 v251, v251, v204
v_add_f32 v251, v251, v205
v_add_f32 v251, v251, v206
v_add_f32 v251, v251, v207
s_nop 1
s_setpc_b64 s[48:49]
L_rare_s1:
s_nop 7
s_nop 7
v_max3_f32 v253, v144, v145, v146
v_max3_f32 v253, v253, v147, v148
v_max3_f32 v253, v253, v149, v150
v_max3_f32 v253, v253, v151, v152
v_max3_f32 v253, v253, v153, v154
v_max3_f32 v253, v253, v155, v156
v_max3_f32 v253, v253, v157, v158
v_max_f32 v253, v253, v159
v_mov_b32 v254, v253
s_nop 1
v_permlane32_swap_b32 v253, v254
v_max_f32 v253, v253, v254
v_ceil_f32 v253, v253
v_max_f32 v253, 0, v253
v_exp_f32 v254, -v253
v_sub_f32 v249, v249, v253
v_mul_f32 v248, v248, v254
v_mov_b32 v208, v249
v_sub_f32 v144, v144, v253
v_sub_f32 v128, v128, v253
v_mov_b32 v209, v249
v_sub_f32 v145, v145, v253
v_sub_f32 v129, v129, v253
v_mov_b32 v210, v249
v_sub_f32 v146, v146, v253
v_sub_f32 v130, v130, v253
v_mov_b32 v211, v249
v_sub_f32 v147, v147, v253
v_sub_f32 v131, v131, v253
v_mov_b32 v212, v249
v_sub_f32 v148, v148, v253
v_sub_f32 v132, v132, v253
v_mov_b32 v213, v249
v_sub_f32 v149, v149, v253
v_sub_f32 v133, v133, v253
v_mov_b32 v214, v249
v_sub_f32 v150, v150, v253
v_sub_f32 v134, v134, v253
v_mov_b32 v215, v249
v_sub_f32 v151, v151, v253
v_sub_f32 v135, v135, v253
v_mov_b32 v216, v249
v_sub_f32 v152, v152, v253
v_sub_f32 v136, v136, v253
v_mov_b32 v217, v249
v_sub_f32 v153, v153, v253
v_sub_f32 v137, v137, v253
v_mov_b32 v218, v249
v_sub_f32 v154, v154, v253
v_sub_f32 v138, v138, v253
v_mov_b32 v219, v249
v_sub_f32 v155, v155, v253
v_sub_f32 v139, v139, v253
v_mov_b32 v220, v249
v_sub_f32 v156, v156, v253
v_sub_f32 v140, v140, v253
v_mov_b32 v221, v249
v_sub_f32 v157, v157, v253
v_sub_f32 v141, v141, v253
v_mov_b32 v222, v249
v_sub_f32 v158, v158, v253
v_sub_f32 v142, v142, v253
v_mov_b32 v223, v249
v_sub_f32 v159, v159, v253
v_sub_f32 v143, v143, v253
v_lshlrev_b32 v251, 16, v0
v_and_b32 v252, 0xffff0000, v0
v_mul_f32 v251, v251, v254
v_mul_f32 v252, v252, v254
v_cvt_pk_bf16_f32 v0, v251, v252
v_lshlrev_b32 v251, 16, v1
v_and_b32 v252, 0xffff0000, v1
v_mul_f32 v251, v251, v254
v_mul_f32 v252, v252, v254
v_cvt_pk_bf16_f32 v1, v251, v252
v_lshlrev_b32 v251, 16, v2
v_and_b32 v252, 0xffff0000, v2
v_mul_f32 v251, v251, v254
v_mul_f32 v252, v252, v254
v_cvt_pk_bf16_f32 v2, v251, v252
v_lshlrev_b32 v251, 16, v3
v_and_b32 v252, 0xffff0000, v3
v_mul_f32 v251, v251, v254
v_mul_f32 v252, v252, v254
v_cvt_pk_bf16_f32 v3, v251, v252
v_lshlrev_b32 v251, 16, v4
v_and_b32 v252, 0xffff0000, v4
v_mul_f32 v251, v251, v254
v_mul_f32 v252, v252, v254
v_cvt_pk_bf16_f32 v4, v251, v252
v_lshlrev_b32 v251, 16, v5
v_and_b32 v252, 0xffff0000, v5
v_mul_f32 v251, v251, v254
v_mul_f32 v252, v252, v254
v_cvt_pk_bf16_f32 v5, v251, v252
v_lshlrev_b32 v251, 16, v6
v_and_b32 v252, 0xffff0000, v6
v_mul_f32 v251, v251, v254
v_mul_f32 v252, v252, v254
v_cvt_pk_bf16_f32 v6, v251, v252
v_lshlrev_b32 v251, 16, v7
v_and_b32 v252, 0xffff0000, v7
v_mul_f32 v251, v251, v254
v_mul_f32 v252, v252, v254
v_cvt_pk_bf16_f32 v7, v251, v252
v_lshlrev_b32 v251, 16, v8
v_and_b32 v252, 0xffff0000, v8
v_mul_f32 v251, v251, v254
v_mul_f32 v252, v252, v254
v_cvt_pk_bf16_f32 v8, v251, v252
v_lshlrev_b32 v251, 16, v9
v_and_b32 v252, 0xffff0000, v9
v_mul_f32 v251, v251, v254
v_mul_f32 v252, v252, v254
v_cvt_pk_bf16_f32 v9, v251, v252
v_lshlrev_b32 v251, 16, v10
v_and_b32 v252, 0xffff0000, v10
v_mul_f32 v251, v251, v254
v_mul_f32 v252, v252, v254
v_cvt_pk_bf16_f32 v10, v251, v252
v_lshlrev_b32 v251, 16, v11
v_and_b32 v252, 0xffff0000, v11
v_mul_f32 v251, v251, v254
v_mul_f32 v252, v252, v254
v_cvt_pk_bf16_f32 v11, v251, v252
v_lshlrev_b32 v251, 16, v12
v_and_b32 v252, 0xffff0000, v12
v_mul_f32 v251, v251, v254
v_mul_f32 v252, v252, v254
v_cvt_pk_bf16_f32 v12, v251, v252
v_lshlrev_b32 v251, 16, v13
v_and_b32 v252, 0xffff0000, v13
v_mul_f32 v251, v251, v254
v_mul_f32 v252, v252, v254
v_cvt_pk_bf16_f32 v13, v251, v252
v_lshlrev_b32 v251, 16, v14
v_and_b32 v252, 0xffff0000, v14
v_mul_f32 v251, v251, v254
v_mul_f32 v252, v252, v254
v_cvt_pk_bf16_f32 v14, v251, v252
v_lshlrev_b32 v251, 16, v15
v_and_b32 v252, 0xffff0000, v15
v_mul_f32 v251, v251, v254
v_mul_f32 v252, v252, v254
v_cvt_pk_bf16_f32 v15, v251, v252
v_lshlrev_b32 v251, 16, v16
v_and_b32 v252, 0xffff0000, v16
v_mul_f32 v251, v251, v254
v_mul_f32 v252, v252, v254
v_cvt_pk_bf16_f32 v16, v251, v252
v_lshlrev_b32 v251, 16, v17
v_and_b32 v252, 0xffff0000, v17
v_mul_f32 v251, v251, v254
v_mul_f32 v252, v252, v254
v_cvt_pk_bf16_f32 v17, v251, v252
v_lshlrev_b32 v251, 16, v18
v_and_b32 v252, 0xffff0000, v18
v_mul_f32 v251, v251, v254
v_mul_f32 v252, v252, v254
v_cvt_pk_bf16_f32 v18, v251, v252
v_lshlrev_b32 v251, 16, v19
v_and_b32 v252, 0xffff0000, v19
v_mul_f32 v251, v251, v254
v_mul_f32 v252, v252, v254
v_cvt_pk_bf16_f32 v19, v251, v252
v_lshlrev_b32 v251, 16, v20
v_and_b32 v252, 0xffff0000, v20
v_mul_f32 v251, v251, v254
v_mul_f32 v252, v252, v254
v_cvt_pk_bf16_f32 v20, v251, v252
v_lshlrev_b32 v251, 16, v21
v_and_b32 v252, 0xffff0000, v21
v_mul_f32 v251, v251, v254
v_mul_f32 v252, v252, v254
v_cvt_pk_bf16_f32 v21, v251, v252
v_lshlrev_b32 v251, 16, v22
v_and_b32 v252, 0xffff0000, v22
v_mul_f32 v251, v251, v254
v_mul_f32 v252, v252, v254
v_cvt_pk_bf16_f32 v22, v251, v252
v_lshlrev_b32 v251, 16, v23
v_and_b32 v252, 0xffff0000, v23
v_mul_f32 v251, v251, v254
v_mul_f32 v252, v252, v254
v_cvt_pk_bf16_f32 v23, v251, v252
v_lshlrev_b32 v251, 16, v24
v_and_b32 v252, 0xffff0000, v24
v_mul_f32 v251, v251, v254
v_mul_f32 v252, v252, v254
v_cvt_pk_bf16_f32 v24, v251, v252
v_lshlrev_b32 v251, 16, v25
v_and_b32 v252, 0xffff0000, v25
v_mul_f32 v251, v251, v254
v_mul_f32 v252, v252, v254
v_cvt_pk_bf16_f32 v25, v251, v252
v_lshlrev_b32 v251, 16, v26
v_and_b32 v252, 0xffff0000, v26
v_mul_f32 v251, v251, v254
v_mul_f32 v252, v252, v254
v_cvt_pk_bf16_f32 v26, v251, v252
v_lshlrev_b32 v251, 16, v27
v_and_b32 v252, 0xffff0000, v27
v_mul_f32 v251, v251, v254
v_mul_f32 v252, v252, v254
v_cvt_pk_bf16_f32 v27, v251, v252
v_lshlrev_b32 v251, 16, v28
v_and_b32 v252, 0xffff0000, v28
v_mul_f32 v251, v251, v254
v_mul_f32 v252, v252, v254
v_cvt_pk_bf16_f32 v28, v251, v252
v_lshlrev_b32 v251, 16, v29
v_and_b32 v252, 0xffff0000, v29
v_mul_f32 v251, v251, v254
v_mul_f32 v252, v252, v254
v_cvt_pk_bf16_f32 v29, v251, v252
v_lshlrev_b32 v251, 16, v30
v_and_b32 v252, 0xffff0000, v30
v_mul_f32 v251, v251, v254
v_mul_f32 v252, v252, v254
v_cvt_pk_bf16_f32 v30, v251, v252
v_lshlrev_b32 v251, 16, v31
v_and_b32 v252, 0xffff0000, v31
v_mul_f32 v251, v251, v254
v_mul_f32 v252, v252, v254
v_cvt_pk_bf16_f32 v31, v251, v252
v_lshlrev_b32 v251, 16, v32
v_and_b32 v252, 0xffff0000, v32
v_mul_f32 v251, v251, v254
v_mul_f32 v252, v252, v254
v_cvt_pk_bf16_f32 v32, v251, v252
v_lshlrev_b32 v251, 16, v33
v_and_b32 v252, 0xffff0000, v33
v_mul_f32 v251, v251, v254
v_mul_f32 v252, v252, v254
v_cvt_pk_bf16_f32 v33, v251, v252
v_lshlrev_b32 v251, 16, v34
v_and_b32 v252, 0xffff0000, v34
v_mul_f32 v251, v251, v254
v_mul_f32 v252, v252, v254
v_cvt_pk_bf16_f32 v34, v251, v252
v_lshlrev_b32 v251, 16, v35
v_and_b32 v252, 0xffff0000, v35
v_mul_f32 v251, v251, v254
v_mul_f32 v252, v252, v254
v_cvt_pk_bf16_f32 v35, v251, v252
v_lshlrev_b32 v251, 16, v36
v_and_b32 v252, 0xffff0000, v36
v_mul_f32 v251, v251, v254
v_mul_f32 v252, v252, v254
v_cvt_pk_bf16_f32 v36, v251, v252
v_lshlrev_b32 v251, 16, v37
v_and_b32 v252, 0xffff0000, v37
v_mul_f32 v251, v251, v254
v_mul_f32 v252, v252, v254
v_cvt_pk_bf16_f32 v37, v251, v252
v_lshlrev_b32 v251, 16, v38
v_and_b32 v252, 0xffff0000, v38
v_mul_f32 v251, v251, v254
v_mul_f32 v252, v252, v254
v_cvt_pk_bf16_f32 v38, v251, v252
v_lshlrev_b32 v251, 16, v39
v_and_b32 v252, 0xffff0000, v39
v_mul_f32 v251, v251, v254
v_mul_f32 v252, v252, v254
v_cvt_pk_bf16_f32 v39, v251, v252
v_lshlrev_b32 v251, 16, v40
v_and_b32 v252, 0xffff0000, v40
v_mul_f32 v251, v251, v254
v_mul_f32 v252, v252, v254
v_cvt_pk_bf16_f32 v40, v251, v252
v_lshlrev_b32 v251, 16, v41
v_and_b32 v252, 0xffff0000, v41
v_mul_f32 v251, v251, v254
v_mul_f32 v252, v252, v254
v_cvt_pk_bf16_f32 v41, v251, v252
v_lshlrev_b32 v251, 16, v42
v_and_b32 v252, 0xffff0000, v42
v_mul_f32 v251, v251, v254
v_mul_f32 v252, v252, v254
v_cvt_pk_bf16_f32 v42, v251, v252
v_lshlrev_b32 v251, 16, v43
v_and_b32 v252, 0xffff0000, v43
v_mul_f32 v251, v251, v254
v_mul_f32 v252, v252, v254
v_cvt_pk_bf16_f32 v43, v251, v252
v_lshlrev_b32 v251, 16, v44
v_and_b32 v252, 0xffff0000, v44
v_mul_f32 v251, v251, v254
v_mul_f32 v252, v252, v254
v_cvt_pk_bf16_f32 v44, v251, v252
v_lshlrev_b32 v251, 16, v45
v_and_b32 v252, 0xffff0000, v45
v_mul_f32 v251, v251, v254
v_mul_f32 v252, v252, v254
v_cvt_pk_bf16_f32 v45, v251, v252
v_lshlrev_b32 v251, 16, v46
v_and_b32 v252, 0xffff0000, v46
v_mul_f32 v251, v251, v254
v_mul_f32 v252, v252, v254
v_cvt_pk_bf16_f32 v46, v251, v252
v_lshlrev_b32 v251, 16, v47
v_and_b32 v252, 0xffff0000, v47
v_mul_f32 v251, v251, v254
v_mul_f32 v252, v252, v254
v_cvt_pk_bf16_f32 v47, v251, v252
v_lshlrev_b32 v251, 16, v48
v_and_b32 v252, 0xffff0000, v48
v_mul_f32 v251, v251, v254
v_mul_f32 v252, v252, v254
v_cvt_pk_bf16_f32 v48, v251, v252
v_lshlrev_b32 v251, 16, v49
v_and_b32 v252, 0xffff0000, v49
v_mul_f32 v251, v251, v254
v_mul_f32 v252, v252, v254
v_cvt_pk_bf16_f32 v49, v251, v252
v_lshlrev_b32 v251, 16, v50
v_and_b32 v252, 0xffff0000, v50
v_mul_f32 v251, v251, v254
v_mul_f32 v252, v252, v254
v_cvt_pk_bf16_f32 v50, v251, v252
v_lshlrev_b32 v251, 16, v51
v_and_b32 v252, 0xffff0000, v51
v_mul_f32 v251, v251, v254
v_mul_f32 v252, v252, v254
v_cvt_pk_bf16_f32 v51, v251, v252
v_lshlrev_b32 v251, 16, v52
v_and_b32 v252, 0xffff0000, v52
v_mul_f32 v251, v251, v254
v_mul_f32 v252, v252, v254
v_cvt_pk_bf16_f32 v52, v251, v252
v_lshlrev_b32 v251, 16, v53
v_and_b32 v252, 0xffff0000, v53
v_mul_f32 v251, v251, v254
v_mul_f32 v252, v252, v254
v_cvt_pk_bf16_f32 v53, v251, v252
v_lshlrev_b32 v251, 16, v54
v_and_b32 v252, 0xffff0000, v54
v_mul_f32 v251, v251, v254
v_mul_f32 v252, v252, v254
v_cvt_pk_bf16_f32 v54, v251, v252
v_lshlrev_b32 v251, 16, v55
v_and_b32 v252, 0xffff0000, v55
v_mul_f32 v251, v251, v254
v_mul_f32 v252, v252, v254
v_cvt_pk_bf16_f32 v55, v251, v252
v_lshlrev_b32 v251, 16, v56
v_and_b32 v252, 0xffff0000, v56
v_mul_f32 v251, v251, v254
v_mul_f32 v252, v252, v254
v_cvt_pk_bf16_f32 v56, v251, v252
v_lshlrev_b32 v251, 16, v57
v_and_b32 v252, 0xffff0000, v57
v_mul_f32 v251, v251, v254
v_mul_f32 v252, v252, v254
v_cvt_pk_bf16_f32 v57, v251, v252
v_lshlrev_b32 v251, 16, v58
v_and_b32 v252, 0xffff0000, v58
v_mul_f32 v251, v251, v254
v_mul_f32 v252, v252, v254
v_cvt_pk_bf16_f32 v58, v251, v252
v_lshlrev_b32 v251, 16, v59
v_and_b32 v252, 0xffff0000, v59
v_mul_f32 v251, v251, v254
v_mul_f32 v252, v252, v254
v_cvt_pk_bf16_f32 v59, v251, v252
v_lshlrev_b32 v251, 16, v60
v_and_b32 v252, 0xffff0000, v60
v_mul_f32 v251, v251, v254
v_mul_f32 v252, v252, v254
v_cvt_pk_bf16_f32 v60, v251, v252
v_lshlrev_b32 v251, 16, v61
v_and_b32 v252, 0xffff0000, v61
v_mul_f32 v251, v251, v254
v_mul_f32 v252, v252, v254
v_cvt_pk_bf16_f32 v61, v251, v252
v_lshlrev_b32 v251, 16, v62
v_and_b32 v252, 0xffff0000, v62
v_mul_f32 v251, v251, v254
v_mul_f32 v252, v252, v254
v_cvt_pk_bf16_f32 v62, v251, v252
v_lshlrev_b32 v251, 16, v63
v_and_b32 v252, 0xffff0000, v63
v_mul_f32 v251, v251, v254
v_mul_f32 v252, v252, v254
v_cvt_pk_bf16_f32 v63, v251, v252
v_lshlrev_b32 v251, 16, v64
v_and_b32 v252, 0xffff0000, v64
v_mul_f32 v251, v251, v254
v_mul_f32 v252, v252, v254
v_cvt_pk_bf16_f32 v64, v251, v252
v_lshlrev_b32 v251, 16, v65
v_and_b32 v252, 0xffff0000, v65
v_mul_f32 v251, v251, v254
v_mul_f32 v252, v252, v254
v_cvt_pk_bf16_f32 v65, v251, v252
v_lshlrev_b32 v251, 16, v66
v_and_b32 v252, 0xffff0000, v66
v_mul_f32 v251, v251, v254
v_mul_f32 v252, v252, v254
v_cvt_pk_bf16_f32 v66, v251, v252
v_lshlrev_b32 v251, 16, v67
v_and_b32 v252, 0xffff0000, v67
v_mul_f32 v251, v251, v254
v_mul_f32 v252, v252, v254
v_cvt_pk_bf16_f32 v67, v251, v252
v_lshlrev_b32 v251, 16, v68
v_and_b32 v252, 0xffff0000, v68
v_mul_f32 v251, v251, v254
v_mul_f32 v252, v252, v254
v_cvt_pk_bf16_f32 v68, v251, v252
v_lshlrev_b32 v251, 16, v69
v_and_b32 v252, 0xffff0000, v69
v_mul_f32 v251, v251, v254
v_mul_f32 v252, v252, v254
v_cvt_pk_bf16_f32 v69, v251, v252
v_lshlrev_b32 v251, 16, v70
v_and_b32 v252, 0xffff0000, v70
v_mul_f32 v251, v251, v254
v_mul_f32 v252, v252, v254
v_cvt_pk_bf16_f32 v70, v251, v252
v_lshlrev_b32 v251, 16, v71
v_and_b32 v252, 0xffff0000, v71
v_mul_f32 v251, v251, v254
v_mul_f32 v252, v252, v254
v_cvt_pk_bf16_f32 v71, v251, v252
v_lshlrev_b32 v251, 16, v72
v_and_b32 v252, 0xffff0000, v72
v_mul_f32 v251, v251, v254
v_mul_f32 v252, v252, v254
v_cvt_pk_bf16_f32 v72, v251, v252
v_lshlrev_b32 v251, 16, v73
v_and_b32 v252, 0xffff0000, v73
v_mul_f32 v251, v251, v254
v_mul_f32 v252, v252, v254
v_cvt_pk_bf16_f32 v73, v251, v252
v_lshlrev_b32 v251, 16, v74
v_and_b32 v252, 0xffff0000, v74
v_mul_f32 v251, v251, v254
v_mul_f32 v252, v252, v254
v_cvt_pk_bf16_f32 v74, v251, v252
v_lshlrev_b32 v251, 16, v75
v_and_b32 v252, 0xffff0000, v75
v_mul_f32 v251, v251, v254
v_mul_f32 v252, v252, v254
v_cvt_pk_bf16_f32 v75, v251, v252
v_lshlrev_b32 v251, 16, v76
v_and_b32 v252, 0xffff0000, v76
v_mul_f32 v251, v251, v254
v_mul_f32 v252, v252, v254
v_cvt_pk_bf16_f32 v76, v251, v252
v_lshlrev_b32 v251, 16, v77
v_and_b32 v252, 0xffff0000, v77
v_mul_f32 v251, v251, v254
v_mul_f32 v252, v252, v254
v_cvt_pk_bf16_f32 v77, v251, v252
v_lshlrev_b32 v251, 16, v78
v_and_b32 v252, 0xffff0000, v78
v_mul_f32 v251, v251, v254
v_mul_f32 v252, v252, v254
v_cvt_pk_bf16_f32 v78, v251, v252
v_lshlrev_b32 v251, 16, v79
v_and_b32 v252, 0xffff0000, v79
v_mul_f32 v251, v251, v254
v_mul_f32 v252, v252, v254
v_cvt_pk_bf16_f32 v79, v251, v252
v_lshlrev_b32 v251, 16, v80
v_and_b32 v252, 0xffff0000, v80
v_mul_f32 v251, v251, v254
v_mul_f32 v252, v252, v254
v_cvt_pk_bf16_f32 v80, v251, v252
v_lshlrev_b32 v251, 16, v81
v_and_b32 v252, 0xffff0000, v81
v_mul_f32 v251, v251, v254
v_mul_f32 v252, v252, v254
v_cvt_pk_bf16_f32 v81, v251, v252
v_lshlrev_b32 v251, 16, v82
v_and_b32 v252, 0xffff0000, v82
v_mul_f32 v251, v251, v254
v_mul_f32 v252, v252, v254
v_cvt_pk_bf16_f32 v82, v251, v252
v_lshlrev_b32 v251, 16, v83
v_and_b32 v252, 0xffff0000, v83
v_mul_f32 v251, v251, v254
v_mul_f32 v252, v252, v254
v_cvt_pk_bf16_f32 v83, v251, v252
v_lshlrev_b32 v251, 16, v84
v_and_b32 v252, 0xffff0000, v84
v_mul_f32 v251, v251, v254
v_mul_f32 v252, v252, v254
v_cvt_pk_bf16_f32 v84, v251, v252
v_lshlrev_b32 v251, 16, v85
v_and_b32 v252, 0xffff0000, v85
v_mul_f32 v251, v251, v254
v_mul_f32 v252, v252, v254
v_cvt_pk_bf16_f32 v85, v251, v252
v_lshlrev_b32 v251, 16, v86
v_and_b32 v252, 0xffff0000, v86
v_mul_f32 v251, v251, v254
v_mul_f32 v252, v252, v254
v_cvt_pk_bf16_f32 v86, v251, v252
v_lshlrev_b32 v251, 16, v87
v_and_b32 v252, 0xffff0000, v87
v_mul_f32 v251, v251, v254
v_mul_f32 v252, v252, v254
v_cvt_pk_bf16_f32 v87, v251, v252
v_lshlrev_b32 v251, 16, v88
v_and_b32 v252, 0xffff0000, v88
v_mul_f32 v251, v251, v254
v_mul_f32 v252, v252, v254
v_cvt_pk_bf16_f32 v88, v251, v252
v_lshlrev_b32 v251, 16, v89
v_and_b32 v252, 0xffff0000, v89
v_mul_f32 v251, v251, v254
v_mul_f32 v252, v252, v254
v_cvt_pk_bf16_f32 v89, v251, v252
v_lshlrev_b32 v251, 16, v90
v_and_b32 v252, 0xffff0000, v90
v_mul_f32 v251, v251, v254
v_mul_f32 v252, v252, v254
v_cvt_pk_bf16_f32 v90, v251, v252
v_lshlrev_b32 v251, 16, v91
v_and_b32 v252, 0xffff0000, v91
v_mul_f32 v251, v251, v254
v_mul_f32 v252, v252, v254
v_cvt_pk_bf16_f32 v91, v251, v252
v_lshlrev_b32 v251, 16, v92
v_and_b32 v252, 0xffff0000, v92
v_mul_f32 v251, v251, v254
v_mul_f32 v252, v252, v254
v_cvt_pk_bf16_f32 v92, v251, v252
v_lshlrev_b32 v251, 16, v93
v_and_b32 v252, 0xffff0000, v93
v_mul_f32 v251, v251, v254
v_mul_f32 v252, v252, v254
v_cvt_pk_bf16_f32 v93, v251, v252
v_lshlrev_b32 v251, 16, v94
v_and_b32 v252, 0xffff0000, v94
v_mul_f32 v251, v251, v254
v_mul_f32 v252, v252, v254
v_cvt_pk_bf16_f32 v94, v251, v252
v_lshlrev_b32 v251, 16, v95
v_and_b32 v252, 0xffff0000, v95
v_mul_f32 v251, v251, v254
v_mul_f32 v252, v252, v254
v_cvt_pk_bf16_f32 v95, v251, v252
v_lshlrev_b32 v251, 16, v96
v_and_b32 v252, 0xffff0000, v96
v_mul_f32 v251, v251, v254
v_mul_f32 v252, v252, v254
v_cvt_pk_bf16_f32 v96, v251, v252
v_lshlrev_b32 v251, 16, v97
v_and_b32 v252, 0xffff0000, v97
v_mul_f32 v251, v251, v254
v_mul_f32 v252, v252, v254
v_cvt_pk_bf16_f32 v97, v251, v252
v_lshlrev_b32 v251, 16, v98
v_and_b32 v252, 0xffff0000, v98
v_mul_f32 v251, v251, v254
v_mul_f32 v252, v252, v254
v_cvt_pk_bf16_f32 v98, v251, v252
v_lshlrev_b32 v251, 16, v99
v_and_b32 v252, 0xffff0000, v99
v_mul_f32 v251, v251, v254
v_mul_f32 v252, v252, v254
v_cvt_pk_bf16_f32 v99, v251, v252
v_lshlrev_b32 v251, 16, v100
v_and_b32 v252, 0xffff0000, v100
v_mul_f32 v251, v251, v254
v_mul_f32 v252, v252, v254
v_cvt_pk_bf16_f32 v100, v251, v252
v_lshlrev_b32 v251, 16, v101
v_and_b32 v252, 0xffff0000, v101
v_mul_f32 v251, v251, v254
v_mul_f32 v252, v252, v254
v_cvt_pk_bf16_f32 v101, v251, v252
v_lshlrev_b32 v251, 16, v102
v_and_b32 v252, 0xffff0000, v102
v_mul_f32 v251, v251, v254
v_mul_f32 v252, v252, v254
v_cvt_pk_bf16_f32 v102, v251, v252
v_lshlrev_b32 v251, 16, v103
v_and_b32 v252, 0xffff0000, v103
v_mul_f32 v251, v251, v254
v_mul_f32 v252, v252, v254
v_cvt_pk_bf16_f32 v103, v251, v252
v_lshlrev_b32 v251, 16, v104
v_and_b32 v252, 0xffff0000, v104
v_mul_f32 v251, v251, v254
v_mul_f32 v252, v252, v254
v_cvt_pk_bf16_f32 v104, v251, v252
v_lshlrev_b32 v251, 16, v105
v_and_b32 v252, 0xffff0000, v105
v_mul_f32 v251, v251, v254
v_mul_f32 v252, v252, v254
v_cvt_pk_bf16_f32 v105, v251, v252
v_lshlrev_b32 v251, 16, v106
v_and_b32 v252, 0xffff0000, v106
v_mul_f32 v251, v251, v254
v_mul_f32 v252, v252, v254
v_cvt_pk_bf16_f32 v106, v251, v252
v_lshlrev_b32 v251, 16, v107
v_and_b32 v252, 0xffff0000, v107
v_mul_f32 v251, v251, v254
v_mul_f32 v252, v252, v254
v_cvt_pk_bf16_f32 v107, v251, v252
v_lshlrev_b32 v251, 16, v108
v_and_b32 v252, 0xffff0000, v108
v_mul_f32 v251, v251, v254
v_mul_f32 v252, v252, v254
v_cvt_pk_bf16_f32 v108, v251, v252
v_lshlrev_b32 v251, 16, v109
v_and_b32 v252, 0xffff0000, v109
v_mul_f32 v251, v251, v254
v_mul_f32 v252, v252, v254
v_cvt_pk_bf16_f32 v109, v251, v252
v_lshlrev_b32 v251, 16, v110
v_and_b32 v252, 0xffff0000, v110
v_mul_f32 v251, v251, v254
v_mul_f32 v252, v252, v254
v_cvt_pk_bf16_f32 v110, v251, v252
v_lshlrev_b32 v251, 16, v111
v_and_b32 v252, 0xffff0000, v111
v_mul_f32 v251, v251, v254
v_mul_f32 v252, v252, v254
v_cvt_pk_bf16_f32 v111, v251, v252
v_lshlrev_b32 v251, 16, v112
v_and_b32 v252, 0xffff0000, v112
v_mul_f32 v251, v251, v254
v_mul_f32 v252, v252, v254
v_cvt_pk_bf16_f32 v112, v251, v252
v_lshlrev_b32 v251, 16, v113
v_and_b32 v252, 0xffff0000, v113
v_mul_f32 v251, v251, v254
v_mul_f32 v252, v252, v254
v_cvt_pk_bf16_f32 v113, v251, v252
v_lshlrev_b32 v251, 16, v114
v_and_b32 v252, 0xffff0000, v114
v_mul_f32 v251, v251, v254
v_mul_f32 v252, v252, v254
v_cvt_pk_bf16_f32 v114, v251, v252
v_lshlrev_b32 v251, 16, v115
v_and_b32 v252, 0xffff0000, v115
v_mul_f32 v251, v251, v254
v_mul_f32 v252, v252, v254
v_cvt_pk_bf16_f32 v115, v251, v252
v_lshlrev_b32 v251, 16, v116
v_and_b32 v252, 0xffff0000, v116
v_mul_f32 v251, v251, v254
v_mul_f32 v252, v252, v254
v_cvt_pk_bf16_f32 v116, v251, v252
v_lshlrev_b32 v251, 16, v117
v_and_b32 v252, 0xffff0000, v117
v_mul_f32 v251, v251, v254
v_mul_f32 v252, v252, v254
v_cvt_pk_bf16_f32 v117, v251, v252
v_lshlrev_b32 v251, 16, v118
v_and_b32 v252, 0xffff0000, v118
v_mul_f32 v251, v251, v254
v_mul_f32 v252, v252, v254
v_cvt_pk_bf16_f32 v118, v251, v252
v_lshlrev_b32 v251, 16, v119
v_and_b32 v252, 0xffff0000, v119
v_mul_f32 v251, v251, v254
v_mul_f32 v252, v252, v254
v_cvt_pk_bf16_f32 v119, v251, v252
v_lshlrev_b32 v251, 16, v120
v_and_b32 v252, 0xffff0000, v120
v_mul_f32 v251, v251, v254
v_mul_f32 v252, v252, v254
v_cvt_pk_bf16_f32 v120, v251, v252
v_lshlrev_b32 v251, 16, v121
v_and_b32 v252, 0xffff0000, v121
v_mul_f32 v251, v251, v254
v_mul_f32 v252, v252, v254
v_cvt_pk_bf16_f32 v121, v251, v252
v_lshlrev_b32 v251, 16, v122
v_and_b32 v252, 0xffff0000, v122
v_mul_f32 v251, v251, v254
v_mul_f32 v252, v252, v254
v_cvt_pk_bf16_f32 v122, v251, v252
v_lshlrev_b32 v251, 16, v123
v_and_b32 v252, 0xffff0000, v123
v_mul_f32 v251, v251, v254
v_mul_f32 v252, v252, v254
v_cvt_pk_bf16_f32 v123, v251, v252
v_lshlrev_b32 v251, 16, v124
v_and_b32 v252, 0xffff0000, v124
v_mul_f32 v251, v251, v254
v_mul_f32 v252, v252, v254
v_cvt_pk_bf16_f32 v124, v251, v252
v_lshlrev_b32 v251, 16, v125
v_and_b32 v252, 0xffff0000, v125
v_mul_f32 v251, v251, v254
v_mul_f32 v252, v252, v254
v_cvt_pk_bf16_f32 v125, v251, v252
v_lshlrev_b32 v251, 16, v126
v_and_b32 v252, 0xffff0000, v126
v_mul_f32 v251, v251, v254
v_mul_f32 v252, v252, v254
v_cvt_pk_bf16_f32 v126, v251, v252
v_lshlrev_b32 v251, 16, v127
v_and_b32 v252, 0xffff0000, v127
v_mul_f32 v251, v251, v254
v_mul_f32 v252, v252, v254
v_cvt_pk_bf16_f32 v127, v251, v252
v_exp_f32 v192, v144
v_exp_f32 v193, v145
v_exp_f32 v194, v146
v_exp_f32 v195, v147
v_exp_f32 v196, v148
v_exp_f32 v197, v149
v_exp_f32 v198, v150
v_exp_f32 v199, v151
v_exp_f32 v200, v152
v_exp_f32 v201, v153
v_exp_f32 v202, v154
v_exp_f32 v203, v155
v_exp_f32 v204, v156
v_exp_f32 v205, v157
v_exp_f32 v206, v158
v_exp_f32 v207, v159
s_nop 0
v_add_f32 v251, v192, v193
v_add_f32 v251, v251, v194
v_add_f32 v251, v251, v195
v_add_f32 v251, v251, v196
v_add_f32 v251, v251, v197
v_add_f32 v251, v251, v198
v_add_f32 v251, v251, v199
v_add_f32 v251, v251, v200
v_add_f32 v251, v251, v201
v_add_f32 v251, v251, v202
v_add_f32 v251, v251, v203
v_add_f32 v251, v251, v204
v_add_f32 v251, v251, v205
v_add_f32 v251, v251, v206
v_add_f32 v251, v251, v207
s_nop 1
s_setpc_b64 s[48:49]
L_nonce_slow:
s_mov_b32 s53, 0
L_nonce:
global_load_dword v227, v226, s[76:77] sc1
s_add_u32 s53, s53, 1
s_waitcnt vmcnt(0)
v_readfirstlane_b32 s52, v227
s_cmp_ge_u32 s53, 100000
s_cbranch_scc1 L_nonce_back
s_cmp_eq_u32 s52, 0
s_cbranch_scc1 L_nonce
s_branch L_nonce_back
L_code_end:
.section .rodata,"a"
.p2align 6
.amdhsa_kernel standalone__mha_block_cached__near_ridge_kernel
  .amdhsa_next_free_vgpr 512
  .amdhsa_next_free_sgpr 102
  .amdhsa_accum_offset 256
  .amdhsa_group_segment_fixed_size 0
  .amdhsa_kernarg_size 64
  .amdhsa_user_sgpr_count 2
  .amdhsa_user_sgpr_kernarg_segment_ptr 1
  .amdhsa_system_sgpr_workgroup_id_x 1
.end_amdhsa_kernel
```
